```python
import torch

def _softmax(x, axis=-1):
    return torch.softmax(x, dim=axis)
def _gelu(x):
    return torch.nn.functional.gelu(x, approximate="tanh")
def _silu(x):
    return torch.nn.functional.silu(x)
def _sigmoid(x):
    return torch.sigmoid(x)
def _layernorm(x, axis=-1, eps=1e-5):
    m = x.mean(dim=axis, keepdim=True)
    v = x.var(dim=axis, keepdim=True, unbiased=False)
    return (x - m) / torch.sqrt(v + eps)
def _scatter_add(tgt, idx, src, axis=0):
    return tgt.clone().index_add_(axis, idx, src)
def _segment_sum(src, seg, n):
    out = torch.zeros((n,) + src.shape[1:], dtype=src.dtype)
    return out.index_add_(0, seg, src)
def _pad(x, pw):
    flat = tuple(v for pair in reversed(pw) for v in pair)
    return torch.nn.functional.pad(x, flat)

kernel_name = 'standalone__gqa_softmax__near_ridge'

def setup_inputs():

    _w = (lambda a: (lambda t: t.to(torch.bfloat16) if t.is_floating_point() else t)(torch.as_tensor(a)))
    B, Hq, Hkv, Sq, Sk, D = 8, 32, 8, 512, 512, 128
    return {
        "q": _w((lambda *s: torch.randn(*s, dtype=torch.bfloat16) * 0.8)(B, Hq, Sq, D)),
        "k": _w((lambda *s: torch.randn(*s, dtype=torch.bfloat16) * 0.8)(B, Hkv, Sk, D)),
        "v": _w((lambda *s: torch.randn(*s, dtype=torch.bfloat16) * 0.05)(B, Hkv, Sk, D)),
    }

def reference(q, k, v):
    B, Hq, Sq, D = q.shape
    Hkv = k.shape[1]
    rep = Hq // Hkv
    k = (lambda x, n, axis: torch.repeat_interleave(x, n, dim=axis))(k, rep, axis=1)
    v = (lambda x, n, axis: torch.repeat_interleave(x, n, dim=axis))(v, rep, axis=1)
    scale = D ** -0.5
    scores = torch.einsum("bhqd,bhkd->bhqk", q, k) * scale
    p = _softmax(scores, axis=-1)
    return torch.einsum("bhqk,bhkd->bhqd", p, v)
```

```asm
; @launch grid=(256,1,1) block=(256,1,1) lds=163840
.amdgcn_target "amdgcn-amd-amdhsa--gfx950"
.text
.globl standalone__gqa_softmax__near_ridge_kernel
.p2align 8
.type standalone__gqa_softmax__near_ridge_kernel,@function
standalone__gqa_softmax__near_ridge_kernel:
s_cmp_ge_u32 s2, 256
s_cbranch_scc1 L_end
s_load_dwordx4 s[4:7], s[0:1], 0
s_load_dwordx4 s[8:11], s[0:1], 16
v_lshrrev_b32 v64, 6, v0
s_lshr_b32 s42, s2, 3
s_getpc_b64 s[44:45]
L_pc:
v_lshl_add_u32 v72, s42, 2, v64
v_mul_u32_u24 v72, (L_slow-L_pc+383)/384, v72
v_mad_u64_u32 v[94:95], vcc, v72, 1, s[44:45]
global_load_ubyte a232, v[94:95], off
v_and_b32 v65, 15, v0
v_bfe_u32 v66, v0, 4, 2
v_lshlrev_b32 v70, 8, v65
v_lshl_add_u32 v12, v66, 4, v70
s_and_b32 s3, s2, 7
s_lshl_b32 s3, s3, 5
s_add_u32 s3, s3, s42
s_lshl_b32 s31, s3, 17
v_lshl_add_u32 v71, v64, 12, v12
v_add_u32 v71, s31, v71
s_waitcnt lgkmcnt(0)
global_load_dwordx4 v[32:35], v71, s[4:5] offset:0
global_load_dwordx4 v[36:39], v71, s[4:5] offset:64
global_load_dwordx4 v[40:43], v71, s[4:5] offset:128
global_load_dwordx4 v[44:47], v71, s[4:5] offset:192
v_readfirstlane_b32 s28, v64
s_nop 1
v_lshl_add_u32 v67, v64, 2, v66
v_xor_b32 v68, v65, v67
v_lshlrev_b32 v67, 8, v67
v_lshl_add_u32 v9, v68, 4, v67
v_add_u32 v10, 0x1000, v9
s_lshr_b32 s42, s3, 2
s_lshl_b32 s42, s42, 17
s_lshl_b32 s29, s28, 10
s_add_u32 s20, s6, s42
s_addc_u32 s21, s7, 0
s_add_u32 s24, s20, 0
s_addc_u32 s25, s21, 0
s_add_u32 m0, s29, 0
s_nop 0
global_load_lds_dwordx4 v9, s[24:25] offset:0
s_add_u32 m0, s29, 4096
s_nop 0
global_load_lds_dwordx4 v10, s[24:25] offset:0
s_lshl_b32 s43, s28, 12
s_add_u32 s31, s31, s43
s_mov_b32 s12, s4
s_mov_b32 s13, s5
s_mov_b32 s14, 0x2000000
s_mov_b32 s15, 0x20000
s_add_u32 s61, s31, 16384
buffer_load_dwordx4 v[48:51], v12, s[12:15], s61 offen offset:0
buffer_load_dwordx4 v[52:55], v12, s[12:15], s61 offen offset:64
buffer_load_dwordx4 v[56:59], v12, s[12:15], s61 offen offset:128
buffer_load_dwordx4 v[60:63], v12, s[12:15], s61 offen offset:192
v_lshlrev_b32 v67, 2, v66
v_xor_b32 v67, v65, v67
v_lshlrev_b32 v67, 4, v67
v_lshl_add_u32 v67, v66, 8, v67
v_lshl_add_u32 v11, v64, 11, v67
s_mul_i32 s30, s28, 2064
s_add_u32 s22, s8, s42
s_addc_u32 s23, s9, 0
s_add_u32 s24, s20, 8192
s_addc_u32 s25, s21, 0
s_add_u32 m0, s29, 8192
s_nop 0
global_load_lds_dwordx4 v9, s[24:25] offset:0
s_add_u32 m0, s29, 12288
s_nop 0
global_load_lds_dwordx4 v10, s[24:25] offset:0
s_add_u32 s60, s31, 0
s_add_u32 s62, s31, 32768
s_add_u32 s63, s31, 49152
s_add_u32 s64, s31, 65536
s_add_u32 s65, s31, 81920
s_add_u32 s66, s31, 98304
s_add_u32 s67, s31, 114688
s_mov_b32 s88, ((L_slow-L_pc+383)/384)*128
s_mov_b32 s18, 0x2000000
s_mov_b32 s19, 0x20000
s_mov_b32 s16, s10
s_mov_b32 s17, s11
s_mov_b32 s34, 0x3e0293ee
s_mov_b32 s35, 0xffff0000
s_mov_b32 s36, 0x2b800000
s_mov_b32 s33, 0x28000000
s_mov_b32 s37, 0xbe0293ee
s_mov_b64 s[38:39], 0
v_add_u32 v67, 0, v66
v_xor_b32 v67, v65, v67
v_lshl_add_u32 v1, v67, 4, v70
v_add_u32 v67, 4, v66
v_xor_b32 v67, v65, v67
v_lshl_add_u32 v2, v67, 4, v70
v_add_u32 v67, 8, v66
v_xor_b32 v67, v65, v67
v_lshl_add_u32 v3, v67, 4, v70
v_add_u32 v67, 12, v66
v_xor_b32 v67, v65, v67
v_lshl_add_u32 v4, v67, 4, v70
v_bfe_u32 v67, v0, 2, 2
v_and_b32 v68, 3, v0
v_mul_u32_u24 v69, 1032, v66
v_lshl_add_u32 v69, v67, 8, v69
v_lshl_add_u32 v69, v68, 4, v69
v_add_u32 v69, 0x18000, v69
v_mul_u32_u24 v90, 0x104, v68
v_add_u32 v90, 0x27c00, v90
v_xor_b32 v68, 0, v67
v_lshl_add_u32 v5, v68, 6, v69
v_xor_b32 v68, 1, v67
v_lshl_add_u32 v6, v68, 6, v69
v_xor_b32 v68, 2, v67
v_lshl_add_u32 v7, v68, 6, v69
v_xor_b32 v68, 3, v67
v_lshl_add_u32 v8, v68, 6, v69
v_mov_b32 v67, 0x3f803f80
v_and_b32 v68, 3, v0
v_cmp_eq_u32 vcc, 0, v68
s_nop 1
v_cndmask_b32 v67, 0, v67, vcc
v_accvgpr_write_b32 a228, v67
v_accvgpr_write_b32 a229, v67
v_accvgpr_write_b32 a230, v67
v_accvgpr_write_b32 a231, v67
v_lshlrev_b32 v0, 2, v0
v_add_u32 v0, 0x27c00, v0
v_mov_b32 v92, 0
ds_write_b32 v0, v92
v_mov_b32 v92, 1
s_waitcnt vmcnt(11)
v_lshlrev_b32 v13, 16, v32
v_and_b32 v14, s35, v32
v_mul_f32 v13, s34, v13
v_mul_f32 v14, s34, v14
v_cvt_pk_bf16_f32 v32, v13, v14
v_accvgpr_write_b32 a128, v32
v_lshlrev_b32 v13, 16, v33
v_and_b32 v14, s35, v33
v_mul_f32 v13, s34, v13
v_mul_f32 v14, s34, v14
v_cvt_pk_bf16_f32 v33, v13, v14
v_accvgpr_write_b32 a129, v33
v_lshlrev_b32 v13, 16, v34
v_and_b32 v14, s35, v34
v_mul_f32 v13, s34, v13
v_mul_f32 v14, s34, v14
v_cvt_pk_bf16_f32 v34, v13, v14
v_accvgpr_write_b32 a130, v34
v_lshlrev_b32 v13, 16, v35
v_and_b32 v14, s35, v35
v_mul_f32 v13, s34, v13
v_mul_f32 v14, s34, v14
v_cvt_pk_bf16_f32 v35, v13, v14
v_accvgpr_write_b32 a131, v35
s_add_u32 s24, s20, 16384
s_addc_u32 s25, s21, 0
s_add_u32 m0, s29, 16384
s_nop 0
global_load_lds_dwordx4 v9, s[24:25] offset:0
s_add_u32 m0, s29, 20480
s_nop 0
global_load_lds_dwordx4 v10, s[24:25] offset:0
s_add_u32 s26, s22, 0
s_addc_u32 s27, s23, 0
s_add_u32 m0, s30, 105024
s_nop 0
global_load_lds_dwordx4 v11, s[26:27] offset:0
s_waitcnt vmcnt(13)
v_lshlrev_b32 v13, 16, v36
v_and_b32 v14, s35, v36
v_mul_f32 v13, s34, v13
v_mul_f32 v14, s34, v14
v_cvt_pk_bf16_f32 v36, v13, v14
v_accvgpr_write_b32 a132, v36
v_lshlrev_b32 v13, 16, v37
v_and_b32 v14, s35, v37
v_mul_f32 v13, s34, v13
v_mul_f32 v14, s34, v14
v_cvt_pk_bf16_f32 v37, v13, v14
v_accvgpr_write_b32 a133, v37
v_lshlrev_b32 v13, 16, v38
v_and_b32 v14, s35, v38
v_mul_f32 v13, s34, v13
v_mul_f32 v14, s34, v14
v_cvt_pk_bf16_f32 v38, v13, v14
v_accvgpr_write_b32 a134, v38
v_lshlrev_b32 v13, 16, v39
v_and_b32 v14, s35, v39
v_mul_f32 v13, s34, v13
v_mul_f32 v14, s34, v14
v_cvt_pk_bf16_f32 v39, v13, v14
v_accvgpr_write_b32 a135, v39
s_add_u32 m0, s30, 105032
s_nop 0
global_load_lds_dwordx4 v11, s[26:27] offset:1024
s_add_u32 s24, s20, 24576
s_addc_u32 s25, s21, 0
s_add_u32 m0, s29, 24576
s_nop 0
global_load_lds_dwordx4 v9, s[24:25] offset:0
s_waitcnt vmcnt(14)
v_lshlrev_b32 v13, 16, v40
v_and_b32 v14, s35, v40
v_mul_f32 v13, s34, v13
v_mul_f32 v14, s34, v14
v_cvt_pk_bf16_f32 v40, v13, v14
v_accvgpr_write_b32 a136, v40
v_lshlrev_b32 v13, 16, v41
v_and_b32 v14, s35, v41
v_mul_f32 v13, s34, v13
v_mul_f32 v14, s34, v14
v_cvt_pk_bf16_f32 v41, v13, v14
v_accvgpr_write_b32 a137, v41
v_lshlrev_b32 v13, 16, v42
v_and_b32 v14, s35, v42
v_mul_f32 v13, s34, v13
v_mul_f32 v14, s34, v14
v_cvt_pk_bf16_f32 v42, v13, v14
v_accvgpr_write_b32 a138, v42
v_lshlrev_b32 v13, 16, v43
v_and_b32 v14, s35, v43
v_mul_f32 v13, s34, v13
v_mul_f32 v14, s34, v14
v_cvt_pk_bf16_f32 v43, v13, v14
v_accvgpr_write_b32 a139, v43
s_add_u32 m0, s29, 28672
s_nop 0
global_load_lds_dwordx4 v10, s[24:25] offset:0
s_add_u32 s26, s22, 8192
s_addc_u32 s27, s23, 0
s_add_u32 m0, s30, 113280
s_nop 0
global_load_lds_dwordx4 v11, s[26:27] offset:0
s_add_u32 m0, s30, 113288
s_nop 0
global_load_lds_dwordx4 v11, s[26:27] offset:1024
s_waitcnt vmcnt(14) lgkmcnt(0)
s_barrier
ds_read_b128 a[0:3], v1 offset:0
ds_read_b128 a[4:7], v2 offset:0
ds_read_b128 a[8:11], v3 offset:0
ds_read_b128 a[12:15], v4 offset:0
ds_read_b128 a[16:19], v1 offset:4096
ds_read_b128 a[20:23], v2 offset:4096
ds_read_b128 a[24:27], v3 offset:4096
ds_read_b128 a[28:31], v4 offset:4096
v_lshlrev_b32 v13, 16, v44
v_and_b32 v14, s35, v44
v_mul_f32 v13, s34, v13
v_mul_f32 v14, s34, v14
v_cvt_pk_bf16_f32 v44, v13, v14
v_accvgpr_write_b32 a140, v44
v_lshlrev_b32 v13, 16, v45
v_and_b32 v14, s35, v45
v_mul_f32 v13, s34, v13
v_mul_f32 v14, s34, v14
v_cvt_pk_bf16_f32 v45, v13, v14
v_accvgpr_write_b32 a141, v45
v_lshlrev_b32 v13, 16, v46
v_and_b32 v14, s35, v46
v_mul_f32 v13, s34, v13
v_mul_f32 v14, s34, v14
v_cvt_pk_bf16_f32 v46, v13, v14
v_accvgpr_write_b32 a142, v46
v_lshlrev_b32 v13, 16, v47
v_and_b32 v14, s35, v47
v_mul_f32 v13, s34, v13
v_mul_f32 v14, s34, v14
v_cvt_pk_bf16_f32 v47, v13, v14
v_accvgpr_write_b32 a143, v47
s_add_u32 s26, s22, 16384
s_addc_u32 s27, s23, 0
s_add_u32 m0, s30, 121536
s_nop 0
global_load_lds_dwordx4 v11, s[26:27] offset:0
s_add_u32 m0, s30, 121544
s_nop 0
global_load_lds_dwordx4 v11, s[26:27] offset:1024
s_waitcnt lgkmcnt(7)
v_mfma_f32_16x16x32_bf16 v[64:67], a[0:3], a[128:131], 0
buffer_load_dwordx4 v[16:19], v12, s[12:15], s62 offen offset:0
s_waitcnt lgkmcnt(6)
v_mfma_f32_16x16x32_bf16 v[64:67], a[4:7], a[132:135], v[64:67]
buffer_load_dwordx4 v[20:23], v12, s[12:15], s62 offen offset:64
s_waitcnt lgkmcnt(5)
v_mfma_f32_16x16x32_bf16 v[64:67], a[8:11], a[136:139], v[64:67]
buffer_load_dwordx4 v[24:27], v12, s[12:15], s62 offen offset:128
s_waitcnt lgkmcnt(4)
v_mfma_f32_16x16x32_bf16 v[64:67], a[12:15], a[140:143], v[64:67]
buffer_load_dwordx4 v[28:31], v12, s[12:15], s62 offen offset:192
s_waitcnt lgkmcnt(3)
v_mfma_f32_16x16x32_bf16 v[68:71], a[16:19], a[128:131], 0
s_add_u32 s24, s20, 32768
s_waitcnt lgkmcnt(2)
v_mfma_f32_16x16x32_bf16 v[68:71], a[20:23], a[132:135], v[68:71]
s_addc_u32 s25, s21, 0
s_waitcnt lgkmcnt(0)
v_mfma_f32_16x16x32_bf16 v[68:71], a[24:27], a[136:139], v[68:71]
s_add_u32 m0, s29, 32768
s_waitcnt vmcnt(19)
v_lshlrev_b32 v13, 16, v48
v_and_b32 v14, s35, v48
v_mul_f32 v13, s34, v13
v_mul_f32 v14, s34, v14
v_cvt_pk_bf16_f32 v48, v13, v14
v_accvgpr_write_b32 a144, v48
v_lshlrev_b32 v13, 16, v49
v_and_b32 v14, s35, v49
v_mul_f32 v13, s34, v13
v_mul_f32 v14, s34, v14
v_cvt_pk_bf16_f32 v49, v13, v14
v_accvgpr_write_b32 a145, v49
v_lshlrev_b32 v13, 16, v50
v_and_b32 v14, s35, v50
v_mul_f32 v13, s34, v13
v_mul_f32 v14, s34, v14
v_cvt_pk_bf16_f32 v50, v13, v14
v_accvgpr_write_b32 a146, v50
v_lshlrev_b32 v13, 16, v51
v_and_b32 v14, s35, v51
v_mul_f32 v13, s34, v13
v_mul_f32 v14, s34, v14
v_cvt_pk_bf16_f32 v51, v13, v14
v_accvgpr_write_b32 a147, v51
s_waitcnt vmcnt(18)
v_lshlrev_b32 v13, 16, v52
v_and_b32 v14, s35, v52
v_mul_f32 v13, s34, v13
v_mul_f32 v14, s34, v14
v_cvt_pk_bf16_f32 v52, v13, v14
v_accvgpr_write_b32 a148, v52
v_lshlrev_b32 v13, 16, v53
v_and_b32 v14, s35, v53
v_mul_f32 v13, s34, v13
v_mul_f32 v14, s34, v14
v_cvt_pk_bf16_f32 v53, v13, v14
v_accvgpr_write_b32 a149, v53
v_lshlrev_b32 v13, 16, v54
v_and_b32 v14, s35, v54
v_mul_f32 v13, s34, v13
v_mul_f32 v14, s34, v14
v_cvt_pk_bf16_f32 v54, v13, v14
v_accvgpr_write_b32 a150, v54
v_lshlrev_b32 v13, 16, v55
v_and_b32 v14, s35, v55
v_mul_f32 v13, s34, v13
v_mul_f32 v14, s34, v14
v_cvt_pk_bf16_f32 v55, v13, v14
v_accvgpr_write_b32 a151, v55
s_waitcnt vmcnt(17)
v_lshlrev_b32 v13, 16, v56
v_and_b32 v14, s35, v56
v_mul_f32 v13, s34, v13
v_mul_f32 v14, s34, v14
v_cvt_pk_bf16_f32 v56, v13, v14
v_accvgpr_write_b32 a152, v56
v_lshlrev_b32 v13, 16, v57
v_and_b32 v14, s35, v57
v_mul_f32 v13, s34, v13
v_mul_f32 v14, s34, v14
v_cvt_pk_bf16_f32 v57, v13, v14
v_accvgpr_write_b32 a153, v57
v_lshlrev_b32 v13, 16, v58
v_and_b32 v14, s35, v58
v_mul_f32 v13, s34, v13
v_mul_f32 v14, s34, v14
v_cvt_pk_bf16_f32 v58, v13, v14
v_accvgpr_write_b32 a154, v58
v_lshlrev_b32 v13, 16, v59
v_and_b32 v14, s35, v59
v_mul_f32 v13, s34, v13
v_mul_f32 v14, s34, v14
v_cvt_pk_bf16_f32 v59, v13, v14
v_accvgpr_write_b32 a155, v59
s_waitcnt vmcnt(16)
v_lshlrev_b32 v13, 16, v60
v_and_b32 v14, s35, v60
v_mul_f32 v13, s34, v13
v_mul_f32 v14, s34, v14
v_cvt_pk_bf16_f32 v60, v13, v14
v_accvgpr_write_b32 a156, v60
v_lshlrev_b32 v13, 16, v61
v_and_b32 v14, s35, v61
v_mul_f32 v13, s34, v13
v_mul_f32 v14, s34, v14
v_cvt_pk_bf16_f32 v61, v13, v14
v_accvgpr_write_b32 a157, v61
v_lshlrev_b32 v13, 16, v62
v_and_b32 v14, s35, v62
v_mul_f32 v13, s34, v13
v_mul_f32 v14, s34, v14
v_cvt_pk_bf16_f32 v62, v13, v14
v_accvgpr_write_b32 a158, v62
v_lshlrev_b32 v13, 16, v63
v_and_b32 v14, s35, v63
v_mul_f32 v13, s34, v13
v_mul_f32 v14, s34, v14
v_cvt_pk_bf16_f32 v63, v13, v14
v_accvgpr_write_b32 a159, v63
v_mfma_f32_16x16x32_bf16 v[68:71], a[28:31], a[140:143], v[68:71]
s_waitcnt vmcnt(14)
s_barrier
v_mfma_f32_16x16x32_bf16 v[72:75], a[0:3], a[144:147], 0
ds_read_b128 a[32:35], v1 offset:8192
s_waitcnt vmcnt(10)
ds_write_b32 v0, v92
v_exp_f32 v64, v64
v_mfma_f32_16x16x32_bf16 v[72:75], a[4:7], a[148:151], v[72:75]
ds_read_b128 a[36:39], v2 offset:8192
ds_read_b32 v93, v90
v_exp_f32 v65, v65
v_mfma_f32_16x16x32_bf16 v[72:75], a[8:11], a[152:155], v[72:75]
ds_read_b128 a[40:43], v3 offset:8192
v_exp_f32 v66, v66
v_mfma_f32_16x16x32_bf16 v[72:75], a[12:15], a[156:159], v[72:75]
ds_read_b128 a[44:47], v4 offset:8192
v_exp_f32 v67, v67
v_mfma_f32_16x16x32_bf16 v[76:79], a[16:19], a[144:147], 0
ds_read_b128 a[48:51], v1 offset:12288
v_exp_f32 v68, v68
v_mfma_f32_16x16x32_bf16 v[76:79], a[20:23], a[148:151], v[76:79]
ds_read_b128 a[52:55], v2 offset:12288
v_exp_f32 v69, v69
v_mfma_f32_16x16x32_bf16 v[76:79], a[24:27], a[152:155], v[76:79]
ds_read_b128 a[56:59], v3 offset:12288
v_exp_f32 v70, v70
v_mfma_f32_16x16x32_bf16 v[76:79], a[28:31], a[156:159], v[76:79]
ds_read_b128 a[60:63], v4 offset:12288
v_exp_f32 v71, v71
v_cvt_pk_bf16_f32 v80, v64, v65
v_cvt_pk_bf16_f32 v81, v66, v67
s_waitcnt lgkmcnt(6)
v_cmp_gt_u32 vcc, v92, v93
v_mfma_f32_16x16x32_bf16 v[64:67], a[32:35], a[128:131], 0
s_cbranch_vccnz L_r1
L_b1:
global_load_lds_dwordx4 v9, s[24:25] offset:0
v_cvt_pk_bf16_f32 v82, v68, v69
v_mfma_f32_16x16x32_bf16 v[64:67], a[36:39], a[132:135], v[64:67]
s_add_u32 m0, s29, 36864
ds_read_b64_tr_b16 a[64:65], v5 offset:6720
ds_read_b64_tr_b16 a[66:67], v5 offset:10848
ds_read_b64_tr_b16 a[68:69], v5 offset:6728
ds_read_b64_tr_b16 a[70:71], v5 offset:10856
s_waitcnt lgkmcnt(8)
v_exp_f32 v72, v72
v_mfma_f32_16x16x32_bf16 v[64:67], a[40:43], a[136:139], v[64:67]
ds_read_b64_tr_b16 a[72:73], v6 offset:6720
ds_read_b64_tr_b16 a[74:75], v6 offset:10848
ds_read_b64_tr_b16 a[76:77], v6 offset:6728
v_mfma_f32_16x16x32_bf16 v[64:67], a[44:47], a[140:143], v[64:67]
ds_read_b64_tr_b16 a[78:79], v6 offset:10856
s_waitcnt lgkmcnt(10)
v_cvt_pk_bf16_f32 v83, v70, v71
v_exp_f32 v73, v73
v_mfma_f32_16x16x32_bf16 v[68:71], a[48:51], a[128:131], 0
ds_read_b64_tr_b16 a[80:81], v7 offset:6720
ds_read_b64_tr_b16 a[82:83], v7 offset:10848
ds_read_b64_tr_b16 a[84:85], v7 offset:6728
v_mfma_f32_16x16x32_bf16 v[68:71], a[52:55], a[132:135], v[68:71]
ds_read_b64_tr_b16 a[86:87], v7 offset:10856
s_waitcnt lgkmcnt(12)
v_exp_f32 v74, v74
v_mfma_f32_16x16x32_bf16 v[68:71], a[56:59], a[136:139], v[68:71]
ds_read_b64_tr_b16 a[88:89], v8 offset:6720
ds_read_b64_tr_b16 a[90:91], v8 offset:10848
ds_read_b64_tr_b16 a[92:93], v8 offset:6728
v_mfma_f32_16x16x32_bf16 v[68:71], a[60:63], a[140:143], v[68:71]
ds_read_b64_tr_b16 a[94:95], v8 offset:10856
s_waitcnt lgkmcnt(12)
v_exp_f32 v75, v75
v_mfma_f32_16x16x32_bf16 v[96:99], a[64:67], v[80:83], 0
global_load_lds_dwordx4 v10, s[24:25] offset:0
v_cvt_pk_bf16_f32 v84, v72, v73
v_mfma_f32_16x16x32_bf16 v[100:103], a[68:71], v[80:83], 0
s_add_u32 s26, s22, 24576
v_exp_f32 v76, v76
v_add_u32 v92, 1, v92
s_waitcnt lgkmcnt(8)
v_mfma_f32_16x16x32_bf16 v[104:107], a[72:75], v[80:83], 0
s_addc_u32 s27, s23, 0
ds_read_b128 a[0:3], v1 offset:16384
v_cvt_pk_bf16_f32 v85, v74, v75
v_mfma_f32_16x16x32_bf16 v[108:111], a[76:79], v[80:83], 0
s_add_u32 m0, s30, 129792
v_exp_f32 v77, v77
s_waitcnt lgkmcnt(5)
v_mfma_f32_16x16x32_bf16 v[112:115], a[80:83], v[80:83], 0
global_load_lds_dwordx4 v11, s[26:27] offset:0
v_cvt_pk_bf16_f32 v86, v76, v77
v_mfma_f32_16x16x32_bf16 v[116:119], a[84:87], v[80:83], 0
s_add_u32 m0, s30, 129800
v_exp_f32 v78, v78
s_waitcnt lgkmcnt(1)
v_mfma_f32_16x16x32_bf16 v[120:123], a[88:91], v[80:83], 0
global_load_lds_dwordx4 v11, s[26:27] offset:1024
v_mfma_f32_16x16x32_bf16 v[124:127], a[92:95], v[80:83], 0
s_add_u32 s24, s20, 40960
v_exp_f32 v79, v79
v_mfma_f32_16x16x32_bf16 a[208:211], a[228:231], v[80:83], 0
s_addc_u32 s25, s21, 0
ds_read_b128 a[4:7], v2 offset:16384
v_cvt_pk_bf16_f32 v87, v78, v79
v_mfma_f32_16x16x32_bf16 v[72:75], a[32:35], a[144:147], 0
s_add_u32 m0, s29, 40960
ds_read_b128 a[8:11], v3 offset:16384
ds_read_b128 a[12:15], v4 offset:16384
v_mfma_f32_16x16x32_bf16 v[72:75], a[36:39], a[148:151], v[72:75]
v_exp_f32 v64, v64
v_mfma_f32_16x16x32_bf16 v[72:75], a[40:43], a[152:155], v[72:75]
global_load_lds_dwordx4 v9, s[24:25] offset:0
v_mfma_f32_16x16x32_bf16 v[72:75], a[44:47], a[156:159], v[72:75]
s_add_u32 m0, s29, 45056
v_exp_f32 v65, v65
v_mfma_f32_16x16x32_bf16 v[76:79], a[48:51], a[144:147], 0
global_load_lds_dwordx4 v10, s[24:25] offset:0
v_cvt_pk_bf16_f32 v80, v64, v65
v_mfma_f32_16x16x32_bf16 v[76:79], a[52:55], a[148:151], v[76:79]
s_add_u32 s26, s22, 32768
s_waitcnt vmcnt(10)
ds_write_b32 v0, v92
v_exp_f32 v66, v66
v_mfma_f32_16x16x32_bf16 v[76:79], a[56:59], a[152:155], v[76:79]
s_addc_u32 s27, s23, 0
ds_read_b128 a[16:19], v1 offset:20480
ds_read_b128 a[20:23], v2 offset:20480
v_mfma_f32_16x16x32_bf16 v[76:79], a[60:63], a[156:159], v[76:79]
s_add_u32 m0, s30, 138048
v_exp_f32 v67, v67
v_mfma_f32_16x16x32_bf16 v[128:131], a[64:67], v[84:87], 0
global_load_lds_dwordx4 v11, s[26:27] offset:0
v_cvt_pk_bf16_f32 v81, v66, v67
v_mfma_f32_16x16x32_bf16 v[132:135], a[68:71], v[84:87], 0
s_add_u32 m0, s30, 138056
v_exp_f32 v68, v68
v_mfma_f32_16x16x32_bf16 v[136:139], a[72:75], v[84:87], 0
ds_read_b32 v93, v90
ds_read_b128 a[24:27], v3 offset:20480
v_mfma_f32_16x16x32_bf16 v[140:143], a[76:79], v[84:87], 0
v_exp_f32 v69, v69
v_mfma_f32_16x16x32_bf16 v[144:147], a[80:83], v[84:87], 0
global_load_lds_dwordx4 v11, s[26:27] offset:1024
v_cvt_pk_bf16_f32 v82, v68, v69
v_mfma_f32_16x16x32_bf16 v[148:151], a[84:87], v[84:87], 0
ds_read_b128 a[28:31], v4 offset:20480
v_exp_f32 v70, v70
v_mfma_f32_16x16x32_bf16 v[152:155], a[88:91], v[84:87], 0
buffer_load_dwordx4 v[32:35], v12, s[12:15], s63 offen offset:0
v_mfma_f32_16x16x32_bf16 v[156:159], a[92:95], v[84:87], 0
v_exp_f32 v71, v71
v_mfma_f32_16x16x32_bf16 a[212:215], a[228:231], v[84:87], 0
s_waitcnt lgkmcnt(2)
v_cmp_gt_u32 vcc, v92, v93
v_cvt_pk_bf16_f32 v83, v70, v71
v_mfma_f32_16x16x32_bf16 v[64:67], a[0:3], a[128:131], 0
s_cbranch_vccnz L_r2
L_b2:
buffer_load_dwordx4 v[36:39], v12, s[12:15], s63 offen offset:64
v_mfma_f32_16x16x32_bf16 v[64:67], a[4:7], a[132:135], v[64:67]
ds_read_b64_tr_b16 a[96:97], v5 offset:14976
ds_read_b64_tr_b16 a[98:99], v5 offset:19104
ds_read_b64_tr_b16 a[100:101], v5 offset:14984
ds_read_b64_tr_b16 a[102:103], v5 offset:19112
v_exp_f32 v72, v72
v_mfma_f32_16x16x32_bf16 v[64:67], a[8:11], a[136:139], v[64:67]
ds_read_b64_tr_b16 a[104:105], v6 offset:14976
ds_read_b64_tr_b16 a[106:107], v6 offset:19104
ds_read_b64_tr_b16 a[108:109], v6 offset:14984
v_mfma_f32_16x16x32_bf16 v[64:67], a[12:15], a[140:143], v[64:67]
ds_read_b64_tr_b16 a[110:111], v6 offset:19112
v_exp_f32 v73, v73
v_mfma_f32_16x16x32_bf16 v[68:71], a[16:19], a[128:131], 0
ds_read_b64_tr_b16 a[112:113], v7 offset:14976
ds_read_b64_tr_b16 a[114:115], v7 offset:19104
ds_read_b64_tr_b16 a[116:117], v7 offset:14984
v_mfma_f32_16x16x32_bf16 v[68:71], a[20:23], a[132:135], v[68:71]
ds_read_b64_tr_b16 a[118:119], v7 offset:19112
s_waitcnt lgkmcnt(12)
v_exp_f32 v74, v74
v_mfma_f32_16x16x32_bf16 v[68:71], a[24:27], a[136:139], v[68:71]
ds_read_b64_tr_b16 a[120:121], v8 offset:14976
ds_read_b64_tr_b16 a[122:123], v8 offset:19104
ds_read_b64_tr_b16 a[124:125], v8 offset:14984
v_mfma_f32_16x16x32_bf16 v[68:71], a[28:31], a[140:143], v[68:71]
ds_read_b64_tr_b16 a[126:127], v8 offset:19112
s_waitcnt lgkmcnt(12)
v_exp_f32 v75, v75
v_mfma_f32_16x16x32_bf16 v[96:99], a[96:99], v[80:83], v[96:99]
buffer_load_dwordx4 v[40:43], v12, s[12:15], s63 offen offset:128
v_cvt_pk_bf16_f32 v84, v72, v73
v_mfma_f32_16x16x32_bf16 v[100:103], a[100:103], v[80:83], v[100:103]
s_waitcnt lgkmcnt(8)
v_exp_f32 v76, v76
v_add_u32 v92, 1, v92
v_mfma_f32_16x16x32_bf16 v[104:107], a[104:107], v[80:83], v[104:107]
buffer_load_dwordx4 v[44:47], v12, s[12:15], s63 offen offset:192
s_waitcnt vmcnt(15)
v_lshlrev_b32 v13, 16, v16
v_mfma_f32_16x16x32_bf16 v[108:111], a[108:111], v[80:83], v[108:111]
s_add_u32 s24, s20, 49152
v_exp_f32 v77, v77
v_and_b32 v14, s35, v16
s_waitcnt lgkmcnt(4)
v_mfma_f32_16x16x32_bf16 v[112:115], a[112:115], v[80:83], v[112:115]
s_addc_u32 s25, s21, 0
v_mul_f32 v13, s34, v13
v_mul_f32 v14, s34, v14
v_cvt_pk_bf16_f32 v85, v74, v75
v_mfma_f32_16x16x32_bf16 v[116:119], a[116:119], v[80:83], v[116:119]
s_add_u32 m0, s29, 49152
v_exp_f32 v78, v78
v_cvt_pk_bf16_f32 v16, v13, v14
s_waitcnt lgkmcnt(0)
v_mfma_f32_16x16x32_bf16 v[120:123], a[120:123], v[80:83], v[120:123]
global_load_lds_dwordx4 v9, s[24:25] offset:0
v_accvgpr_write_b32 a160, v16
v_mfma_f32_16x16x32_bf16 v[124:127], a[124:127], v[80:83], v[124:127]
s_add_u32 m0, s29, 53248
v_exp_f32 v79, v79
v_lshlrev_b32 v13, 16, v17
v_mfma_f32_16x16x32_bf16 a[208:211], a[228:231], v[80:83], a[208:211]
global_load_lds_dwordx4 v10, s[24:25] offset:0
v_and_b32 v14, s35, v17
v_mfma_f32_16x16x32_bf16 v[72:75], a[0:3], a[144:147], 0
s_add_u32 s26, s22, 40960
v_mul_f32 v13, s34, v13
v_mul_f32 v14, s34, v14
v_cvt_pk_bf16_f32 v86, v76, v77
v_mfma_f32_16x16x32_bf16 v[72:75], a[4:7], a[148:151], v[72:75]
s_addc_u32 s27, s23, 0
v_exp_f32 v64, v64
v_cvt_pk_bf16_f32 v17, v13, v14
v_mfma_f32_16x16x32_bf16 v[72:75], a[8:11], a[152:155], v[72:75]
s_add_u32 m0, s30, 146304
v_accvgpr_write_b32 a161, v17
v_lshlrev_b32 v13, 16, v18
v_and_b32 v14, s35, v18
v_mfma_f32_16x16x32_bf16 v[72:75], a[12:15], a[156:159], v[72:75]
v_cvt_pk_bf16_f32 v87, v78, v79
v_exp_f32 v65, v65
v_mfma_f32_16x16x32_bf16 v[76:79], a[16:19], a[144:147], 0
global_load_lds_dwordx4 v11, s[26:27] offset:0
v_mul_f32 v13, s34, v13
v_mfma_f32_16x16x32_bf16 v[76:79], a[20:23], a[148:151], v[76:79]
s_add_u32 m0, s30, 146312
s_waitcnt vmcnt(11)
ds_write_b32 v0, v92
v_exp_f32 v66, v66
v_mfma_f32_16x16x32_bf16 v[76:79], a[24:27], a[152:155], v[76:79]
global_load_lds_dwordx4 v11, s[26:27] offset:1024
v_mul_f32 v14, s34, v14
v_mfma_f32_16x16x32_bf16 v[76:79], a[28:31], a[156:159], v[76:79]
v_exp_f32 v67, v67
v_cvt_pk_bf16_f32 v18, v13, v14
v_mfma_f32_16x16x32_bf16 v[128:131], a[96:99], v[84:87], v[128:131]
v_accvgpr_write_b32 a162, v18
v_lshlrev_b32 v13, 16, v19
v_and_b32 v14, s35, v19
v_mfma_f32_16x16x32_bf16 v[132:135], a[100:103], v[84:87], v[132:135]
ds_read_b128 a[32:35], v1 offset:24576
v_exp_f32 v68, v68
v_mfma_f32_16x16x32_bf16 v[136:139], a[104:107], v[84:87], v[136:139]
ds_read_b128 a[36:39], v2 offset:24576
ds_read_b32 v93, v90
v_mul_f32 v13, s34, v13
v_mfma_f32_16x16x32_bf16 v[140:143], a[108:111], v[84:87], v[140:143]
ds_read_b128 a[40:43], v3 offset:24576
v_exp_f32 v69, v69
v_mfma_f32_16x16x32_bf16 v[144:147], a[112:115], v[84:87], v[144:147]
ds_read_b128 a[44:47], v4 offset:24576
v_mul_f32 v14, s34, v14
v_cvt_pk_bf16_f32 v19, v13, v14
v_mfma_f32_16x16x32_bf16 v[148:151], a[116:119], v[84:87], v[148:151]
ds_read_b128 a[48:51], v1 offset:28672
v_exp_f32 v70, v70
v_mfma_f32_16x16x32_bf16 v[152:155], a[120:123], v[84:87], v[152:155]
ds_read_b128 a[52:55], v2 offset:28672
v_accvgpr_write_b32 a163, v19
v_cvt_pk_bf16_f32 v80, v64, v65
v_mfma_f32_16x16x32_bf16 v[156:159], a[124:127], v[84:87], v[156:159]
ds_read_b128 a[56:59], v3 offset:28672
v_exp_f32 v71, v71
v_mfma_f32_16x16x32_bf16 a[212:215], a[228:231], v[84:87], a[212:215]
ds_read_b128 a[60:63], v4 offset:28672
v_cvt_pk_bf16_f32 v81, v66, v67
s_waitcnt lgkmcnt(6)
v_cmp_gt_u32 vcc, v92, v93
v_mfma_f32_16x16x32_bf16 v[64:67], a[32:35], a[128:131], 0
s_cbranch_vccnz L_r3
L_b3:
ds_read_b64_tr_b16 a[64:65], v5 offset:23232
ds_read_b64_tr_b16 a[66:67], v5 offset:27360
v_lshlrev_b32 v13, 16, v20
v_mfma_f32_16x16x32_bf16 v[64:67], a[36:39], a[132:135], v[64:67]
ds_read_b64_tr_b16 a[68:69], v5 offset:23240
ds_read_b64_tr_b16 a[70:71], v5 offset:27368
s_waitcnt lgkmcnt(8)
v_exp_f32 v72, v72
v_mfma_f32_16x16x32_bf16 v[64:67], a[40:43], a[136:139], v[64:67]
ds_read_b64_tr_b16 a[72:73], v6 offset:23232
ds_read_b64_tr_b16 a[74:75], v6 offset:27360
v_and_b32 v14, s35, v20
v_mfma_f32_16x16x32_bf16 v[64:67], a[44:47], a[140:143], v[64:67]
ds_read_b64_tr_b16 a[76:77], v6 offset:23240
ds_read_b64_tr_b16 a[78:79], v6 offset:27368
s_waitcnt lgkmcnt(10)
v_cvt_pk_bf16_f32 v82, v68, v69
v_cvt_pk_bf16_f32 v83, v70, v71
v_exp_f32 v73, v73
v_mfma_f32_16x16x32_bf16 v[68:71], a[48:51], a[128:131], 0
ds_read_b64_tr_b16 a[80:81], v7 offset:23232
ds_read_b64_tr_b16 a[82:83], v7 offset:27360
v_mul_f32 v13, s34, v13
v_mfma_f32_16x16x32_bf16 v[68:71], a[52:55], a[132:135], v[68:71]
ds_read_b64_tr_b16 a[84:85], v7 offset:23240
ds_read_b64_tr_b16 a[86:87], v7 offset:27368
s_waitcnt lgkmcnt(12)
v_exp_f32 v74, v74
v_mfma_f32_16x16x32_bf16 v[68:71], a[56:59], a[136:139], v[68:71]
ds_read_b64_tr_b16 a[88:89], v8 offset:23232
ds_read_b64_tr_b16 a[90:91], v8 offset:27360
v_mul_f32 v14, s34, v14
v_mfma_f32_16x16x32_bf16 v[68:71], a[60:63], a[140:143], v[68:71]
ds_read_b64_tr_b16 a[92:93], v8 offset:23240
ds_read_b64_tr_b16 a[94:95], v8 offset:27368
s_waitcnt lgkmcnt(12)
v_exp_f32 v75, v75
v_mfma_f32_16x16x32_bf16 v[96:99], a[64:67], v[80:83], v[96:99]
v_cvt_pk_bf16_f32 v20, v13, v14
v_accvgpr_write_b32 a164, v20
v_lshlrev_b32 v13, 16, v21
v_mfma_f32_16x16x32_bf16 v[100:103], a[68:71], v[80:83], v[100:103]
s_waitcnt lgkmcnt(8)
v_exp_f32 v76, v76
v_and_b32 v14, s35, v21
v_mfma_f32_16x16x32_bf16 v[104:107], a[72:75], v[80:83], v[104:107]
v_add_u32 v92, 1, v92
v_mul_f32 v13, s34, v13
v_mul_f32 v14, s34, v14
v_mfma_f32_16x16x32_bf16 v[108:111], a[76:79], v[80:83], v[108:111]
s_waitcnt lgkmcnt(4)
v_exp_f32 v77, v77
v_cvt_pk_bf16_f32 v21, v13, v14
v_mfma_f32_16x16x32_bf16 v[112:115], a[80:83], v[80:83], v[112:115]
v_accvgpr_write_b32 a165, v21
v_lshlrev_b32 v13, 16, v22
v_and_b32 v14, s35, v22
v_mfma_f32_16x16x32_bf16 v[116:119], a[84:87], v[80:83], v[116:119]
s_waitcnt lgkmcnt(0)
v_exp_f32 v78, v78
v_mul_f32 v13, s34, v13
v_mfma_f32_16x16x32_bf16 v[120:123], a[88:91], v[80:83], v[120:123]
v_mul_f32 v14, s34, v14
v_cvt_pk_bf16_f32 v22, v13, v14
v_accvgpr_write_b32 a166, v22
v_mfma_f32_16x16x32_bf16 v[124:127], a[92:95], v[80:83], v[124:127]
s_add_u32 s24, s20, 57344
v_exp_f32 v79, v79
v_lshlrev_b32 v13, 16, v23
v_mfma_f32_16x16x32_bf16 a[208:211], a[228:231], v[80:83], a[208:211]
s_addc_u32 s25, s21, 0
v_cvt_pk_bf16_f32 v84, v72, v73
v_cvt_pk_bf16_f32 v85, v74, v75
v_and_b32 v14, s35, v23
v_mfma_f32_16x16x32_bf16 v[72:75], a[32:35], a[144:147], 0
s_add_u32 m0, s29, 57344
v_mul_f32 v13, s34, v13
v_mul_f32 v14, s34, v14
v_cvt_pk_bf16_f32 v23, v13, v14
v_mfma_f32_16x16x32_bf16 v[72:75], a[36:39], a[148:151], v[72:75]
v_exp_f32 v64, v64
v_accvgpr_write_b32 a167, v23
v_mfma_f32_16x16x32_bf16 v[72:75], a[40:43], a[152:155], v[72:75]
v_lshlrev_b32 v13, 16, v24
v_and_b32 v14, s35, v24
v_mul_f32 v13, s34, v13
v_mfma_f32_16x16x32_bf16 v[72:75], a[44:47], a[156:159], v[72:75]
v_cvt_pk_bf16_f32 v86, v76, v77
v_cvt_pk_bf16_f32 v87, v78, v79
v_exp_f32 v65, v65
v_mfma_f32_16x16x32_bf16 v[76:79], a[48:51], a[144:147], 0
v_mul_f32 v14, s34, v14
v_cvt_pk_bf16_f32 v24, v13, v14
v_accvgpr_write_b32 a168, v24
v_mfma_f32_16x16x32_bf16 v[76:79], a[52:55], a[148:151], v[76:79]
v_exp_f32 v66, v66
v_lshlrev_b32 v13, 16, v25
v_mfma_f32_16x16x32_bf16 v[76:79], a[56:59], a[152:155], v[76:79]
v_and_b32 v14, s35, v25
v_mul_f32 v13, s34, v13
v_mul_f32 v14, s34, v14
v_mfma_f32_16x16x32_bf16 v[76:79], a[60:63], a[156:159], v[76:79]
v_exp_f32 v67, v67
v_cvt_pk_bf16_f32 v25, v13, v14
v_mfma_f32_16x16x32_bf16 v[128:131], a[64:67], v[84:87], v[128:131]
v_accvgpr_write_b32 a169, v25
v_lshlrev_b32 v13, 16, v26
v_and_b32 v14, s35, v26
v_mfma_f32_16x16x32_bf16 v[132:135], a[68:71], v[84:87], v[132:135]
v_exp_f32 v68, v68
v_mul_f32 v13, s34, v13
v_mfma_f32_16x16x32_bf16 v[136:139], a[72:75], v[84:87], v[136:139]
v_mul_f32 v14, s34, v14
v_cvt_pk_bf16_f32 v26, v13, v14
v_accvgpr_write_b32 a170, v26
v_mfma_f32_16x16x32_bf16 v[140:143], a[76:79], v[84:87], v[140:143]
v_exp_f32 v69, v69
v_lshlrev_b32 v13, 16, v27
v_mfma_f32_16x16x32_bf16 v[144:147], a[80:83], v[84:87], v[144:147]
ds_read_b64_tr_b16 a[96:97], v5 offset:31488
ds_read_b64_tr_b16 a[98:99], v5 offset:35616
v_and_b32 v14, s35, v27
v_mfma_f32_16x16x32_bf16 v[148:151], a[84:87], v[84:87], v[148:151]
ds_read_b64_tr_b16 a[100:101], v5 offset:31496
ds_read_b64_tr_b16 a[102:103], v5 offset:35624
v_exp_f32 v70, v70
v_mfma_f32_16x16x32_bf16 v[152:155], a[88:91], v[84:87], v[152:155]
ds_read_b64_tr_b16 a[104:105], v6 offset:31488
ds_read_b64_tr_b16 a[106:107], v6 offset:35616
v_mul_f32 v13, s34, v13
v_mfma_f32_16x16x32_bf16 v[156:159], a[92:95], v[84:87], v[156:159]
ds_read_b64_tr_b16 a[108:109], v6 offset:31496
ds_read_b64_tr_b16 a[110:111], v6 offset:35624
v_exp_f32 v71, v71
v_mul_f32 v14, s34, v14
v_cvt_pk_bf16_f32 v27, v13, v14
v_accvgpr_write_b32 a171, v27
v_lshlrev_b32 v13, 16, v28
v_and_b32 v14, s35, v28
v_mul_f32 v13, s34, v13
v_mul_f32 v14, s34, v14
v_cvt_pk_bf16_f32 v28, v13, v14
v_accvgpr_write_b32 a172, v28
v_lshlrev_b32 v13, 16, v29
v_and_b32 v14, s35, v29
v_mul_f32 v13, s34, v13
v_mul_f32 v14, s34, v14
v_cvt_pk_bf16_f32 v29, v13, v14
v_accvgpr_write_b32 a173, v29
v_lshlrev_b32 v13, 16, v30
v_and_b32 v14, s35, v30
v_mul_f32 v13, s34, v13
v_mul_f32 v14, s34, v14
v_cvt_pk_bf16_f32 v30, v13, v14
v_accvgpr_write_b32 a174, v30
v_lshlrev_b32 v13, 16, v31
v_and_b32 v14, s35, v31
v_mul_f32 v13, s34, v13
v_mul_f32 v14, s34, v14
v_cvt_pk_bf16_f32 v31, v13, v14
v_accvgpr_write_b32 a175, v31
v_mfma_f32_16x16x32_bf16 a[212:215], a[228:231], v[84:87], a[212:215]
ds_read_b64_tr_b16 a[112:113], v7 offset:31488
ds_read_b64_tr_b16 a[114:115], v7 offset:35616
v_cvt_pk_bf16_f32 v80, v64, v65
v_cvt_pk_bf16_f32 v81, v66, v67
v_mfma_f32_16x16x32_bf16 v[64:67], a[32:35], a[160:163], 0
ds_read_b64_tr_b16 a[116:117], v7 offset:31496
ds_read_b64_tr_b16 a[118:119], v7 offset:35624
ds_read_b64_tr_b16 a[120:121], v8 offset:31488
v_mfma_f32_16x16x32_bf16 v[64:67], a[36:39], a[164:167], v[64:67]
ds_read_b64_tr_b16 a[122:123], v8 offset:35616
v_exp_f32 v72, v72
v_mfma_f32_16x16x32_bf16 v[64:67], a[40:43], a[168:171], v[64:67]
ds_read_b64_tr_b16 a[124:125], v8 offset:31496
ds_read_b64_tr_b16 a[126:127], v8 offset:35624
v_cvt_pk_bf16_f32 v82, v68, v69
v_mfma_f32_16x16x32_bf16 v[64:67], a[44:47], a[172:175], v[64:67]
s_waitcnt vmcnt(8)
ds_write_b32 v0, v92
v_cvt_pk_bf16_f32 v83, v70, v71
v_exp_f32 v73, v73
v_mfma_f32_16x16x32_bf16 v[68:71], a[48:51], a[160:163], 0
global_load_lds_dwordx4 v9, s[24:25] offset:0
v_cvt_pk_bf16_f32 v84, v72, v73
v_mfma_f32_16x16x32_bf16 v[68:71], a[52:55], a[164:167], v[68:71]
s_add_u32 m0, s29, 61440
ds_read_b128 a[0:3], v1 offset:32768
v_exp_f32 v74, v74
v_mfma_f32_16x16x32_bf16 v[68:71], a[56:59], a[168:171], v[68:71]
global_load_lds_dwordx4 v10, s[24:25] offset:0
ds_read_b128 a[4:7], v2 offset:32768
v_mfma_f32_16x16x32_bf16 v[68:71], a[60:63], a[172:175], v[68:71]
s_add_u32 s26, s22, 49152
ds_read_b128 a[8:11], v3 offset:32768
s_waitcnt lgkmcnt(6)
v_exp_f32 v75, v75
v_mfma_f32_16x16x32_bf16 v[96:99], a[96:99], v[80:83], v[96:99]
s_addc_u32 s27, s23, 0
ds_read_b128 a[12:15], v4 offset:32768
v_cvt_pk_bf16_f32 v85, v74, v75
v_mfma_f32_16x16x32_bf16 v[100:103], a[100:103], v[80:83], v[100:103]
s_add_u32 m0, s30, 154560
ds_read_b128 a[16:19], v1 offset:36864
v_exp_f32 v76, v76
v_mfma_f32_16x16x32_bf16 v[104:107], a[104:107], v[80:83], v[104:107]
ds_read_b32 v93, v90
ds_read_b128 a[20:23], v2 offset:36864
v_mfma_f32_16x16x32_bf16 v[108:111], a[108:111], v[80:83], v[108:111]
ds_read_b128 a[24:27], v3 offset:36864
v_exp_f32 v77, v77
v_mfma_f32_16x16x32_bf16 v[112:115], a[112:115], v[80:83], v[112:115]
global_load_lds_dwordx4 v11, s[26:27] offset:0
v_cvt_pk_bf16_f32 v86, v76, v77
v_mfma_f32_16x16x32_bf16 v[116:119], a[116:119], v[80:83], v[116:119]
s_add_u32 m0, s30, 154568
ds_read_b128 a[28:31], v4 offset:36864
v_exp_f32 v78, v78
v_mfma_f32_16x16x32_bf16 v[120:123], a[120:123], v[80:83], v[120:123]
global_load_lds_dwordx4 v11, s[26:27] offset:1024
s_waitcnt lgkmcnt(5)
v_mfma_f32_16x16x32_bf16 v[124:127], a[124:127], v[80:83], v[124:127]
v_exp_f32 v79, v79
v_mfma_f32_16x16x32_bf16 a[208:211], a[228:231], v[80:83], a[208:211]
s_waitcnt lgkmcnt(3)
v_cmp_gt_u32 vcc, v92, v93
v_cvt_pk_bf16_f32 v87, v78, v79
v_mfma_f32_16x16x32_bf16 v[72:75], a[0:3], a[128:131], 0
s_cbranch_vccnz L_r4
L_b4:
v_add_u32 v92, 1, v92
v_mfma_f32_16x16x32_bf16 v[72:75], a[4:7], a[132:135], v[72:75]
v_exp_f32 v64, v64
v_mfma_f32_16x16x32_bf16 v[72:75], a[8:11], a[136:139], v[72:75]
ds_read_b64_tr_b16 a[64:65], v5 offset:39744
ds_read_b64_tr_b16 a[66:67], v5 offset:43872
v_mfma_f32_16x16x32_bf16 v[72:75], a[12:15], a[140:143], v[72:75]
v_exp_f32 v65, v65
v_mfma_f32_16x16x32_bf16 v[76:79], a[16:19], a[128:131], 0
ds_read_b64_tr_b16 a[68:69], v5 offset:39752
s_waitcnt lgkmcnt(3)
v_cvt_pk_bf16_f32 v80, v64, v65
v_mfma_f32_16x16x32_bf16 v[76:79], a[20:23], a[132:135], v[76:79]
v_exp_f32 v66, v66
v_mfma_f32_16x16x32_bf16 v[76:79], a[24:27], a[136:139], v[76:79]
ds_read_b64_tr_b16 a[70:71], v5 offset:43880
ds_read_b64_tr_b16 a[72:73], v6 offset:39744
v_mfma_f32_16x16x32_bf16 v[76:79], a[28:31], a[140:143], v[76:79]
v_exp_f32 v67, v67
v_mfma_f32_16x16x32_bf16 v[128:131], a[96:99], v[84:87], v[128:131]
ds_read_b64_tr_b16 a[74:75], v6 offset:43872
v_cvt_pk_bf16_f32 v81, v66, v67
v_mfma_f32_16x16x32_bf16 v[132:135], a[100:103], v[84:87], v[132:135]
v_exp_f32 v68, v68
v_mfma_f32_16x16x32_bf16 v[136:139], a[104:107], v[84:87], v[136:139]
ds_read_b64_tr_b16 a[76:77], v6 offset:39752
ds_read_b64_tr_b16 a[78:79], v6 offset:43880
v_mfma_f32_16x16x32_bf16 v[140:143], a[108:111], v[84:87], v[140:143]
v_exp_f32 v69, v69
v_mfma_f32_16x16x32_bf16 v[144:147], a[112:115], v[84:87], v[144:147]
ds_read_b64_tr_b16 a[80:81], v7 offset:39744
v_cvt_pk_bf16_f32 v82, v68, v69
v_mfma_f32_16x16x32_bf16 v[148:151], a[116:119], v[84:87], v[148:151]
v_exp_f32 v70, v70
v_mfma_f32_16x16x32_bf16 v[152:155], a[120:123], v[84:87], v[152:155]
ds_read_b64_tr_b16 a[82:83], v7 offset:43872
ds_read_b64_tr_b16 a[84:85], v7 offset:39752
v_mfma_f32_16x16x32_bf16 v[156:159], a[124:127], v[84:87], v[156:159]
v_exp_f32 v71, v71
v_mfma_f32_16x16x32_bf16 a[212:215], a[228:231], v[84:87], a[212:215]
ds_read_b64_tr_b16 a[86:87], v7 offset:43880
v_cvt_pk_bf16_f32 v83, v70, v71
v_mfma_f32_16x16x32_bf16 v[64:67], a[0:3], a[144:147], 0
ds_read_b64_tr_b16 a[88:89], v8 offset:39744
ds_read_b64_tr_b16 a[90:91], v8 offset:43872
v_mfma_f32_16x16x32_bf16 v[64:67], a[4:7], a[148:151], v[64:67]
v_exp_f32 v72, v72
v_mfma_f32_16x16x32_bf16 v[64:67], a[8:11], a[152:155], v[64:67]
ds_read_b64_tr_b16 a[92:93], v8 offset:39752
ds_read_b64_tr_b16 a[94:95], v8 offset:43880
v_mfma_f32_16x16x32_bf16 v[64:67], a[12:15], a[156:159], v[64:67]
v_exp_f32 v73, v73
v_mfma_f32_16x16x32_bf16 v[68:71], a[16:19], a[144:147], 0
v_cvt_pk_bf16_f32 v84, v72, v73
s_waitcnt vmcnt(11)
v_lshlrev_b32 v13, 16, v32
v_mfma_f32_16x16x32_bf16 v[68:71], a[20:23], a[148:151], v[68:71]
v_exp_f32 v74, v74
v_and_b32 v14, s35, v32
v_mfma_f32_16x16x32_bf16 v[68:71], a[24:27], a[152:155], v[68:71]
v_mul_f32 v13, s34, v13
v_mul_f32 v14, s34, v14
v_mfma_f32_16x16x32_bf16 v[68:71], a[28:31], a[156:159], v[68:71]
v_exp_f32 v75, v75
v_mfma_f32_16x16x32_bf16 v[160:163], a[96:99], v[80:83], 0
v_cvt_pk_bf16_f32 v85, v74, v75
v_cvt_pk_bf16_f32 v32, v13, v14
v_mfma_f32_16x16x32_bf16 v[164:167], a[100:103], v[80:83], 0
v_exp_f32 v76, v76
v_mfma_f32_16x16x32_bf16 v[168:171], a[104:107], v[80:83], 0
v_accvgpr_write_b32 a176, v32
v_lshlrev_b32 v13, 16, v33
v_mfma_f32_16x16x32_bf16 v[172:175], a[108:111], v[80:83], 0
v_exp_f32 v77, v77
v_mfma_f32_16x16x32_bf16 v[176:179], a[112:115], v[80:83], 0
v_cvt_pk_bf16_f32 v86, v76, v77
v_and_b32 v14, s35, v33
v_mfma_f32_16x16x32_bf16 v[180:183], a[116:119], v[80:83], 0
v_exp_f32 v78, v78
v_mfma_f32_16x16x32_bf16 v[184:187], a[120:123], v[80:83], 0
v_mul_f32 v13, s34, v13
v_mul_f32 v14, s34, v14
v_mfma_f32_16x16x32_bf16 v[188:191], a[124:127], v[80:83], 0
v_exp_f32 v79, v79
v_mfma_f32_16x16x32_bf16 a[216:219], a[228:231], v[80:83], 0
v_cvt_pk_bf16_f32 v87, v78, v79
v_cvt_pk_bf16_f32 v33, v13, v14
v_mfma_f32_16x16x32_bf16 v[72:75], a[0:3], a[160:163], 0
s_add_u32 s24, s20, 65536
v_accvgpr_write_b32 a177, v33
v_lshlrev_b32 v13, 16, v34
v_mfma_f32_16x16x32_bf16 v[72:75], a[4:7], a[164:167], v[72:75]
s_addc_u32 s25, s21, 0
v_exp_f32 v64, v64
v_mfma_f32_16x16x32_bf16 v[72:75], a[8:11], a[168:171], v[72:75]
s_add_u32 m0, s29, 65536
ds_read_b128 a[32:35], v1 offset:40960
v_and_b32 v14, s35, v34
v_mfma_f32_16x16x32_bf16 v[72:75], a[12:15], a[172:175], v[72:75]
s_waitcnt vmcnt(4)
ds_write_b32 v0, v92
v_exp_f32 v65, v65
v_mfma_f32_16x16x32_bf16 v[76:79], a[16:19], a[160:163], 0
v_cvt_pk_bf16_f32 v80, v64, v65
v_mul_f32 v13, s34, v13
v_mfma_f32_16x16x32_bf16 v[76:79], a[20:23], a[164:167], v[76:79]
v_exp_f32 v66, v66
v_mfma_f32_16x16x32_bf16 v[76:79], a[24:27], a[168:171], v[76:79]
global_load_lds_dwordx4 v9, s[24:25] offset:0
ds_read_b128 a[36:39], v2 offset:40960
v_mfma_f32_16x16x32_bf16 v[76:79], a[28:31], a[172:175], v[76:79]
s_add_u32 m0, s29, 69632
ds_read_b128 a[40:43], v3 offset:40960
s_waitcnt lgkmcnt(4)
v_exp_f32 v67, v67
v_mfma_f32_16x16x32_bf16 v[96:99], a[64:67], v[84:87], v[96:99]
global_load_lds_dwordx4 v10, s[24:25] offset:0
v_mul_f32 v14, s34, v14
v_mfma_f32_16x16x32_bf16 v[100:103], a[68:71], v[84:87], v[100:103]
s_add_u32 s26, s22, 57344
v_exp_f32 v68, v68
v_add_co_u32 v94, s[86:87], s88, v94
v_mfma_f32_16x16x32_bf16 v[104:107], a[72:75], v[84:87], v[104:107]
s_addc_u32 s27, s23, 0
ds_read_b32 v93, v90
ds_read_b128 a[44:47], v4 offset:40960
v_cvt_pk_bf16_f32 v81, v66, v67
v_mfma_f32_16x16x32_bf16 v[108:111], a[76:79], v[84:87], v[108:111]
s_add_u32 m0, s30, 113280
v_exp_f32 v69, v69
v_cvt_pk_bf16_f32 v34, v13, v14
v_mfma_f32_16x16x32_bf16 v[112:115], a[80:83], v[84:87], v[112:115]
global_load_lds_dwordx4 v11, s[26:27] offset:0
ds_read_b128 a[48:51], v1 offset:45056
v_mfma_f32_16x16x32_bf16 v[116:119], a[84:87], v[84:87], v[116:119]
s_add_u32 m0, s30, 113288
ds_read_b128 a[52:55], v2 offset:45056
v_exp_f32 v70, v70
v_mfma_f32_16x16x32_bf16 v[120:123], a[88:91], v[84:87], v[120:123]
global_load_lds_dwordx4 v11, s[26:27] offset:1024
v_accvgpr_write_b32 a178, v34
v_mfma_f32_16x16x32_bf16 v[124:127], a[92:95], v[84:87], v[124:127]
ds_read_b128 a[56:59], v3 offset:45056
v_exp_f32 v71, v71
v_mfma_f32_16x16x32_bf16 a[208:211], a[228:231], v[84:87], a[208:211]
ds_read_b128 a[60:63], v4 offset:45056
s_waitcnt lgkmcnt(5)
v_cmp_gt_u32 vcc, v92, v93
v_addc_co_u32 v95, s[86:87], 0, v95, s[86:87]
v_mfma_f32_16x16x32_bf16 v[64:67], a[32:35], a[128:131], 0
s_cbranch_vccnz L_r5
L_b5:
buffer_load_dwordx4 v[48:51], v12, s[12:15], s64 offen offset:0
v_lshlrev_b32 v13, 16, v35
v_mfma_f32_16x16x32_bf16 v[64:67], a[36:39], a[132:135], v[64:67]
v_exp_f32 v72, v72
v_cvt_pk_bf16_f32 v82, v68, v69
v_mfma_f32_16x16x32_bf16 v[64:67], a[40:43], a[136:139], v[64:67]
buffer_load_dwordx4 v[52:55], v12, s[12:15], s64 offen offset:64
v_and_b32 v14, s35, v35
s_waitcnt lgkmcnt(2)
v_mfma_f32_16x16x32_bf16 v[64:67], a[44:47], a[140:143], v[64:67]
v_cvt_pk_bf16_f32 v83, v70, v71
v_exp_f32 v73, v73
v_mfma_f32_16x16x32_bf16 v[68:71], a[48:51], a[128:131], 0
buffer_load_dwordx4 v[56:59], v12, s[12:15], s64 offen offset:128
v_mul_f32 v13, s34, v13
v_mfma_f32_16x16x32_bf16 v[68:71], a[52:55], a[132:135], v[68:71]
s_waitcnt lgkmcnt(0)
v_exp_f32 v74, v74
v_mul_f32 v14, s34, v14
v_mfma_f32_16x16x32_bf16 v[68:71], a[56:59], a[136:139], v[68:71]
buffer_load_dwordx4 v[60:63], v12, s[12:15], s64 offen offset:192
v_cvt_pk_bf16_f32 v35, v13, v14
v_mfma_f32_16x16x32_bf16 v[68:71], a[60:63], a[140:143], v[68:71]
v_exp_f32 v75, v75
v_accvgpr_write_b32 a179, v35
v_mfma_f32_16x16x32_bf16 v[128:131], a[64:67], v[80:83], v[128:131]
global_load_ubyte a232, v[94:95], off
v_lshlrev_b32 v13, 16, v36
v_mfma_f32_16x16x32_bf16 v[132:135], a[68:71], v[80:83], v[132:135]
v_exp_f32 v76, v76
v_and_b32 v14, s35, v36
v_mfma_f32_16x16x32_bf16 v[136:139], a[72:75], v[80:83], v[136:139]
v_add_u32 v92, 1, v92
v_cvt_pk_bf16_f32 v84, v72, v73
v_mul_f32 v13, s34, v13
v_mfma_f32_16x16x32_bf16 v[140:143], a[76:79], v[80:83], v[140:143]
v_exp_f32 v77, v77
v_mul_f32 v14, s34, v14
v_mfma_f32_16x16x32_bf16 v[144:147], a[80:83], v[80:83], v[144:147]
v_cvt_pk_bf16_f32 v36, v13, v14
v_cvt_pk_bf16_f32 v85, v74, v75
v_accvgpr_write_b32 a180, v36
v_mfma_f32_16x16x32_bf16 v[148:151], a[84:87], v[80:83], v[148:151]
v_exp_f32 v78, v78
v_lshlrev_b32 v13, 16, v37
v_mfma_f32_16x16x32_bf16 v[152:155], a[88:91], v[80:83], v[152:155]
v_and_b32 v14, s35, v37
v_cvt_pk_bf16_f32 v86, v76, v77
v_mul_f32 v13, s34, v13
v_mfma_f32_16x16x32_bf16 v[156:159], a[92:95], v[80:83], v[156:159]
v_exp_f32 v79, v79
v_mul_f32 v14, s34, v14
v_mfma_f32_16x16x32_bf16 a[212:215], a[228:231], v[80:83], a[212:215]
v_cvt_pk_bf16_f32 v87, v78, v79
v_cvt_pk_bf16_f32 v37, v13, v14
v_mfma_f32_16x16x32_bf16 v[72:75], a[32:35], a[144:147], 0
v_accvgpr_write_b32 a181, v37
v_lshlrev_b32 v13, 16, v38
v_mfma_f32_16x16x32_bf16 v[72:75], a[36:39], a[148:151], v[72:75]
v_exp_f32 v64, v64
v_mfma_f32_16x16x32_bf16 v[72:75], a[40:43], a[152:155], v[72:75]
ds_read_b64_tr_b16 a[96:97], v5 offset:48000
v_and_b32 v14, s35, v38
v_mfma_f32_16x16x32_bf16 v[72:75], a[44:47], a[156:159], v[72:75]
v_exp_f32 v65, v65
v_mfma_f32_16x16x32_bf16 v[76:79], a[48:51], a[144:147], 0
ds_read_b64_tr_b16 a[98:99], v5 offset:52128
v_cvt_pk_bf16_f32 v80, v64, v65
v_mul_f32 v13, s34, v13
v_mfma_f32_16x16x32_bf16 v[76:79], a[52:55], a[148:151], v[76:79]
ds_read_b64_tr_b16 a[100:101], v5 offset:48008
v_exp_f32 v66, v66
v_mfma_f32_16x16x32_bf16 v[76:79], a[56:59], a[152:155], v[76:79]
ds_read_b64_tr_b16 a[102:103], v5 offset:52136
ds_read_b64_tr_b16 a[104:105], v6 offset:48000
v_mul_f32 v14, s34, v14
v_mfma_f32_16x16x32_bf16 v[76:79], a[60:63], a[156:159], v[76:79]
ds_read_b64_tr_b16 a[106:107], v6 offset:52128
v_exp_f32 v67, v67
v_mfma_f32_16x16x32_bf16 v[160:163], a[64:67], v[84:87], v[160:163]
ds_read_b64_tr_b16 a[108:109], v6 offset:48008
ds_read_b64_tr_b16 a[110:111], v6 offset:52136
v_cvt_pk_bf16_f32 v38, v13, v14
v_mfma_f32_16x16x32_bf16 v[164:167], a[68:71], v[84:87], v[164:167]
v_exp_f32 v68, v68
v_cvt_pk_bf16_f32 v81, v66, v67
v_mfma_f32_16x16x32_bf16 v[168:171], a[72:75], v[84:87], v[168:171]
ds_read_b64_tr_b16 a[112:113], v7 offset:48000
ds_read_b64_tr_b16 a[114:115], v7 offset:52128
v_accvgpr_write_b32 a182, v38
v_mfma_f32_16x16x32_bf16 v[172:175], a[76:79], v[84:87], v[172:175]
ds_read_b64_tr_b16 a[116:117], v7 offset:48008
v_exp_f32 v69, v69
v_mfma_f32_16x16x32_bf16 v[176:179], a[80:83], v[84:87], v[176:179]
ds_read_b64_tr_b16 a[118:119], v7 offset:52136
ds_read_b64_tr_b16 a[120:121], v8 offset:48000
v_lshlrev_b32 v13, 16, v39
v_mfma_f32_16x16x32_bf16 v[180:183], a[84:87], v[84:87], v[180:183]
ds_read_b64_tr_b16 a[122:123], v8 offset:52128
v_exp_f32 v70, v70
v_mfma_f32_16x16x32_bf16 v[184:187], a[88:91], v[84:87], v[184:187]
ds_read_b64_tr_b16 a[124:125], v8 offset:48008
ds_read_b64_tr_b16 a[126:127], v8 offset:52136
v_and_b32 v14, s35, v39
v_mfma_f32_16x16x32_bf16 v[188:191], a[92:95], v[84:87], v[188:191]
v_exp_f32 v71, v71
v_cvt_pk_bf16_f32 v82, v68, v69
v_mfma_f32_16x16x32_bf16 a[216:219], a[228:231], v[84:87], a[216:219]
v_mul_f32 v13, s34, v13
v_mul_f32 v14, s34, v14
v_cvt_pk_bf16_f32 v39, v13, v14
v_mfma_f32_16x16x32_bf16 v[64:67], a[32:35], a[160:163], 0
v_cvt_pk_bf16_f32 v83, v70, v71
v_accvgpr_write_b32 a183, v39
v_mfma_f32_16x16x32_bf16 v[64:67], a[36:39], a[164:167], v[64:67]
v_exp_f32 v72, v72
v_lshlrev_b32 v13, 16, v40
v_mfma_f32_16x16x32_bf16 v[64:67], a[40:43], a[168:171], v[64:67]
v_and_b32 v14, s35, v40
v_mul_f32 v13, s34, v13
v_mfma_f32_16x16x32_bf16 v[64:67], a[44:47], a[172:175], v[64:67]
s_waitcnt vmcnt(9)
ds_write_b32 v0, v92
v_exp_f32 v73, v73
v_mfma_f32_16x16x32_bf16 v[68:71], a[48:51], a[160:163], 0
ds_read_b128 a[0:3], v1 offset:49152
v_cvt_pk_bf16_f32 v84, v72, v73
v_mfma_f32_16x16x32_bf16 v[68:71], a[52:55], a[164:167], v[68:71]
v_exp_f32 v74, v74
v_mul_f32 v14, s34, v14
v_mfma_f32_16x16x32_bf16 v[68:71], a[56:59], a[168:171], v[68:71]
ds_read_b128 a[4:7], v2 offset:49152
v_cvt_pk_bf16_f32 v40, v13, v14
v_mfma_f32_16x16x32_bf16 v[68:71], a[60:63], a[172:175], v[68:71]
ds_read_b128 a[8:11], v3 offset:49152
s_waitcnt lgkmcnt(4)
v_exp_f32 v75, v75
v_mfma_f32_16x16x32_bf16 v[96:99], a[96:99], v[80:83], v[96:99]
ds_read_b128 a[12:15], v4 offset:49152
v_accvgpr_write_b32 a184, v40
v_cvt_pk_bf16_f32 v85, v74, v75
v_mfma_f32_16x16x32_bf16 v[100:103], a[100:103], v[80:83], v[100:103]
ds_read_b128 a[16:19], v1 offset:53248
v_exp_f32 v76, v76
v_mfma_f32_16x16x32_bf16 v[104:107], a[104:107], v[80:83], v[104:107]
ds_read_b32 v93, v90
ds_read_b128 a[20:23], v2 offset:53248
v_lshlrev_b32 v13, 16, v41
v_mfma_f32_16x16x32_bf16 v[108:111], a[108:111], v[80:83], v[108:111]
v_exp_f32 v77, v77
v_and_b32 v14, s35, v41
v_mfma_f32_16x16x32_bf16 v[112:115], a[112:115], v[80:83], v[112:115]
ds_read_b128 a[24:27], v3 offset:53248
v_mul_f32 v13, s34, v13
v_cvt_pk_bf16_f32 v86, v76, v77
v_mfma_f32_16x16x32_bf16 v[116:119], a[116:119], v[80:83], v[116:119]
ds_read_b128 a[28:31], v4 offset:53248
v_exp_f32 v78, v78
v_mfma_f32_16x16x32_bf16 v[120:123], a[120:123], v[80:83], v[120:123]
v_mul_f32 v14, s34, v14
v_cvt_pk_bf16_f32 v41, v13, v14
v_mfma_f32_16x16x32_bf16 v[124:127], a[124:127], v[80:83], v[124:127]
v_exp_f32 v79, v79
v_accvgpr_write_b32 a185, v41
v_mfma_f32_16x16x32_bf16 a[208:211], a[228:231], v[80:83], a[208:211]
s_waitcnt lgkmcnt(3)
v_cmp_gt_u32 vcc, v92, v93
v_cvt_pk_bf16_f32 v87, v78, v79
v_mfma_f32_16x16x32_bf16 v[72:75], a[0:3], a[128:131], 0
s_cbranch_vccnz L_r6
L_b6:
v_lshlrev_b32 v13, 16, v42
v_and_b32 v14, s35, v42
v_mfma_f32_16x16x32_bf16 v[72:75], a[4:7], a[132:135], v[72:75]
s_add_u32 s24, s20, 73728
v_exp_f32 v64, v64
v_mfma_f32_16x16x32_bf16 v[72:75], a[8:11], a[136:139], v[72:75]
s_addc_u32 s25, s21, 0
v_mul_f32 v13, s34, v13
v_mul_f32 v14, s34, v14
v_mfma_f32_16x16x32_bf16 v[72:75], a[12:15], a[140:143], v[72:75]
s_add_u32 m0, s29, 73728
v_exp_f32 v65, v65
v_mfma_f32_16x16x32_bf16 v[76:79], a[16:19], a[128:131], 0
s_waitcnt lgkmcnt(0)
v_cvt_pk_bf16_f32 v80, v64, v65
v_add_u32 v92, 1, v92
v_mfma_f32_16x16x32_bf16 v[76:79], a[20:23], a[132:135], v[76:79]
v_exp_f32 v66, v66
v_cvt_pk_bf16_f32 v42, v13, v14
v_mfma_f32_16x16x32_bf16 v[76:79], a[24:27], a[136:139], v[76:79]
global_load_lds_dwordx4 v9, s[24:25] offset:0
v_mfma_f32_16x16x32_bf16 v[76:79], a[28:31], a[140:143], v[76:79]
s_add_u32 m0, s29, 77824
v_exp_f32 v67, v67
v_accvgpr_write_b32 a186, v42
v_mfma_f32_16x16x32_bf16 v[128:131], a[96:99], v[84:87], v[128:131]
global_load_lds_dwordx4 v10, s[24:25] offset:0
v_cvt_pk_bf16_f32 v81, v66, v67
v_mfma_f32_16x16x32_bf16 v[132:135], a[100:103], v[84:87], v[132:135]
s_add_u32 s26, s22, 65536
v_exp_f32 v68, v68
v_lshlrev_b32 v13, 16, v43
v_mfma_f32_16x16x32_bf16 v[136:139], a[104:107], v[84:87], v[136:139]
s_addc_u32 s27, s23, 0
v_and_b32 v14, s35, v43
v_mul_f32 v13, s34, v13
v_mfma_f32_16x16x32_bf16 v[140:143], a[108:111], v[84:87], v[140:143]
s_add_u32 m0, s30, 121536
v_exp_f32 v69, v69
v_mfma_f32_16x16x32_bf16 v[144:147], a[112:115], v[84:87], v[144:147]
global_load_lds_dwordx4 v11, s[26:27] offset:0
v_cvt_pk_bf16_f32 v82, v68, v69
v_mfma_f32_16x16x32_bf16 v[148:151], a[116:119], v[84:87], v[148:151]
s_add_u32 m0, s30, 121544
v_exp_f32 v70, v70
v_mul_f32 v14, s34, v14
v_mfma_f32_16x16x32_bf16 v[152:155], a[120:123], v[84:87], v[152:155]
global_load_lds_dwordx4 v11, s[26:27] offset:1024
v_cvt_pk_bf16_f32 v43, v13, v14
v_mfma_f32_16x16x32_bf16 v[156:159], a[124:127], v[84:87], v[156:159]
v_exp_f32 v71, v71
v_accvgpr_write_b32 a187, v43
v_mfma_f32_16x16x32_bf16 a[212:215], a[228:231], v[84:87], a[212:215]
v_cvt_pk_bf16_f32 v83, v70, v71
v_lshlrev_b32 v13, 16, v44
v_mfma_f32_16x16x32_bf16 v[64:67], a[0:3], a[144:147], 0
v_and_b32 v14, s35, v44
v_mul_f32 v13, s34, v13
v_mfma_f32_16x16x32_bf16 v[64:67], a[4:7], a[148:151], v[64:67]
v_exp_f32 v72, v72
v_mfma_f32_16x16x32_bf16 v[64:67], a[8:11], a[152:155], v[64:67]
v_mul_f32 v14, s34, v14
v_cvt_pk_bf16_f32 v44, v13, v14
v_mfma_f32_16x16x32_bf16 v[64:67], a[12:15], a[156:159], v[64:67]
v_exp_f32 v73, v73
v_mfma_f32_16x16x32_bf16 v[68:71], a[16:19], a[144:147], 0
v_cvt_pk_bf16_f32 v84, v72, v73
v_accvgpr_write_b32 a188, v44
v_mfma_f32_16x16x32_bf16 v[68:71], a[20:23], a[148:151], v[68:71]
v_exp_f32 v74, v74
v_mfma_f32_16x16x32_bf16 v[68:71], a[24:27], a[152:155], v[68:71]
v_lshlrev_b32 v13, 16, v45
v_and_b32 v14, s35, v45
v_mfma_f32_16x16x32_bf16 v[68:71], a[28:31], a[156:159], v[68:71]
v_exp_f32 v75, v75
v_mfma_f32_16x16x32_bf16 v[160:163], a[96:99], v[80:83], v[160:163]
ds_read_b64_tr_b16 a[64:65], v5 offset:56256
v_cvt_pk_bf16_f32 v85, v74, v75
v_mfma_f32_16x16x32_bf16 v[164:167], a[100:103], v[80:83], v[164:167]
ds_read_b64_tr_b16 a[66:67], v5 offset:60384
v_exp_f32 v76, v76
v_mfma_f32_16x16x32_bf16 v[168:171], a[104:107], v[80:83], v[168:171]
ds_read_b64_tr_b16 a[68:69], v5 offset:56264
ds_read_b64_tr_b16 a[70:71], v5 offset:60392
v_mul_f32 v13, s34, v13
v_mfma_f32_16x16x32_bf16 v[172:175], a[108:111], v[80:83], v[172:175]
ds_read_b64_tr_b16 a[72:73], v6 offset:56256
v_exp_f32 v77, v77
v_mfma_f32_16x16x32_bf16 v[176:179], a[112:115], v[80:83], v[176:179]
ds_read_b64_tr_b16 a[74:75], v6 offset:60384
v_mul_f32 v14, s34, v14
v_cvt_pk_bf16_f32 v86, v76, v77
v_mfma_f32_16x16x32_bf16 v[180:183], a[116:119], v[80:83], v[180:183]
ds_read_b64_tr_b16 a[76:77], v6 offset:56264
v_exp_f32 v78, v78
v_mfma_f32_16x16x32_bf16 v[184:187], a[120:123], v[80:83], v[184:187]
ds_read_b64_tr_b16 a[78:79], v6 offset:60392
ds_read_b64_tr_b16 a[80:81], v7 offset:56256
v_cvt_pk_bf16_f32 v45, v13, v14
v_mfma_f32_16x16x32_bf16 v[188:191], a[124:127], v[80:83], v[188:191]
ds_read_b64_tr_b16 a[82:83], v7 offset:60384
v_exp_f32 v79, v79
v_mfma_f32_16x16x32_bf16 a[216:219], a[228:231], v[80:83], a[216:219]
ds_read_b64_tr_b16 a[84:85], v7 offset:56264
ds_read_b64_tr_b16 a[86:87], v7 offset:60392
v_accvgpr_write_b32 a189, v45
v_mfma_f32_16x16x32_bf16 v[72:75], a[0:3], a[160:163], 0
ds_read_b64_tr_b16 a[88:89], v8 offset:56256
ds_read_b64_tr_b16 a[90:91], v8 offset:60384
v_lshlrev_b32 v13, 16, v46
v_mfma_f32_16x16x32_bf16 v[72:75], a[4:7], a[164:167], v[72:75]
v_exp_f32 v64, v64
v_cvt_pk_bf16_f32 v87, v78, v79
v_mfma_f32_16x16x32_bf16 v[72:75], a[8:11], a[168:171], v[72:75]
ds_read_b64_tr_b16 a[92:93], v8 offset:56264
ds_read_b64_tr_b16 a[94:95], v8 offset:60392
v_and_b32 v14, s35, v46
v_mfma_f32_16x16x32_bf16 v[72:75], a[12:15], a[172:175], v[72:75]
v_exp_f32 v65, v65
v_mul_f32 v13, s34, v13
v_mfma_f32_16x16x32_bf16 v[76:79], a[16:19], a[160:163], 0
v_mul_f32 v14, s34, v14
v_cvt_pk_bf16_f32 v80, v64, v65
v_cvt_pk_bf16_f32 v46, v13, v14
v_mfma_f32_16x16x32_bf16 v[76:79], a[20:23], a[164:167], v[76:79]
v_exp_f32 v66, v66
v_accvgpr_write_b32 a190, v46
v_mfma_f32_16x16x32_bf16 v[76:79], a[24:27], a[168:171], v[76:79]
v_lshlrev_b32 v13, 16, v47
v_and_b32 v14, s35, v47
v_mfma_f32_16x16x32_bf16 v[76:79], a[28:31], a[172:175], v[76:79]
s_waitcnt lgkmcnt(2)
v_exp_f32 v67, v67
v_mfma_f32_16x16x32_bf16 v[96:99], a[64:67], v[84:87], v[96:99]
v_cvt_pk_bf16_f32 v81, v66, v67
v_mul_f32 v13, s34, v13
v_mfma_f32_16x16x32_bf16 v[100:103], a[68:71], v[84:87], v[100:103]
v_exp_f32 v68, v68
v_mfma_f32_16x16x32_bf16 v[104:107], a[72:75], v[84:87], v[104:107]
v_mul_f32 v14, s34, v14
v_cvt_pk_bf16_f32 v47, v13, v14
v_mfma_f32_16x16x32_bf16 v[108:111], a[76:79], v[84:87], v[108:111]
v_exp_f32 v69, v69
v_mfma_f32_16x16x32_bf16 v[112:115], a[80:83], v[84:87], v[112:115]
v_cvt_pk_bf16_f32 v82, v68, v69
v_accvgpr_write_b32 a191, v47
v_mfma_f32_16x16x32_bf16 v[116:119], a[84:87], v[84:87], v[116:119]
v_exp_f32 v70, v70
v_mfma_f32_16x16x32_bf16 v[120:123], a[88:91], v[84:87], v[120:123]
ds_read_b128 a[32:35], v1 offset:57344
ds_read_b128 a[36:39], v2 offset:57344
s_waitcnt lgkmcnt(2)
v_mfma_f32_16x16x32_bf16 v[124:127], a[92:95], v[84:87], v[124:127]
v_exp_f32 v71, v71
v_mfma_f32_16x16x32_bf16 a[208:211], a[228:231], v[84:87], a[208:211]
ds_read_b128 a[40:43], v3 offset:57344
v_cvt_pk_bf16_f32 v83, v70, v71
v_mfma_f32_16x16x32_bf16 v[64:67], a[0:3], a[176:179], 0
ds_read_b128 a[44:47], v4 offset:57344
ds_read_b128 a[48:51], v1 offset:61440
v_mfma_f32_16x16x32_bf16 v[64:67], a[4:7], a[180:183], v[64:67]
v_exp_f32 v72, v72
v_mfma_f32_16x16x32_bf16 v[64:67], a[8:11], a[184:187], v[64:67]
ds_read_b128 a[52:55], v2 offset:61440
ds_read_b128 a[56:59], v3 offset:61440
v_mfma_f32_16x16x32_bf16 v[64:67], a[12:15], a[188:191], v[64:67]
v_exp_f32 v73, v73
v_mfma_f32_16x16x32_bf16 v[68:71], a[16:19], a[176:179], 0
ds_read_b128 a[60:63], v4 offset:61440
v_cvt_pk_bf16_f32 v84, v72, v73
v_xor_b32 v1, 0x10000, v1
v_mfma_f32_16x16x32_bf16 v[68:71], a[20:23], a[180:183], v[68:71]
s_waitcnt vmcnt(9)
ds_write_b32 v0, v92
v_exp_f32 v74, v74
v_mfma_f32_16x16x32_bf16 v[68:71], a[24:27], a[184:187], v[68:71]
v_xor_b32 v2, 0x10000, v2
v_xor_b32 v3, 0x10000, v3
v_xor_b32 v4, 0x10000, v4
v_mfma_f32_16x16x32_bf16 v[68:71], a[28:31], a[188:191], v[68:71]
v_exp_f32 v75, v75
v_mfma_f32_16x16x32_bf16 v[128:131], a[64:67], v[80:83], v[128:131]
v_cvt_pk_bf16_f32 v85, v74, v75
v_mfma_f32_16x16x32_bf16 v[132:135], a[68:71], v[80:83], v[132:135]
v_exp_f32 v76, v76
v_mfma_f32_16x16x32_bf16 v[136:139], a[72:75], v[80:83], v[136:139]
ds_read_b32 v93, v90
v_mfma_f32_16x16x32_bf16 v[140:143], a[76:79], v[80:83], v[140:143]
v_exp_f32 v77, v77
v_mfma_f32_16x16x32_bf16 v[144:147], a[80:83], v[80:83], v[144:147]
v_cvt_pk_bf16_f32 v86, v76, v77
v_mfma_f32_16x16x32_bf16 v[148:151], a[84:87], v[80:83], v[148:151]
v_exp_f32 v78, v78
v_mfma_f32_16x16x32_bf16 v[152:155], a[88:91], v[80:83], v[152:155]
v_mfma_f32_16x16x32_bf16 v[156:159], a[92:95], v[80:83], v[156:159]
v_exp_f32 v79, v79
v_mfma_f32_16x16x32_bf16 a[212:215], a[228:231], v[80:83], a[212:215]
s_waitcnt lgkmcnt(0)
v_cmp_gt_u32 vcc, v92, v93
v_cvt_pk_bf16_f32 v87, v78, v79
v_mfma_f32_16x16x32_bf16 v[72:75], a[32:35], a[128:131], 0
s_cbranch_vccnz L_r7
L_b7:
v_add_u32 v92, 1, v92
v_mfma_f32_16x16x32_bf16 v[72:75], a[36:39], a[132:135], v[72:75]
s_add_u32 s24, s20, 81920
v_exp_f32 v64, v64
v_mfma_f32_16x16x32_bf16 v[72:75], a[40:43], a[136:139], v[72:75]
s_addc_u32 s25, s21, 0
ds_read_b64_tr_b16 a[96:97], v5 offset:14976
ds_read_b64_tr_b16 a[98:99], v5 offset:19104
v_mfma_f32_16x16x32_bf16 v[72:75], a[44:47], a[140:143], v[72:75]
s_add_u32 m0, s29, 81920
v_exp_f32 v65, v65
v_mfma_f32_16x16x32_bf16 v[76:79], a[48:51], a[128:131], 0
ds_read_b64_tr_b16 a[100:101], v5 offset:14984
v_cvt_pk_bf16_f32 v80, v64, v65
v_mfma_f32_16x16x32_bf16 v[76:79], a[52:55], a[132:135], v[76:79]
v_exp_f32 v66, v66
v_mfma_f32_16x16x32_bf16 v[76:79], a[56:59], a[136:139], v[76:79]
global_load_lds_dwordx4 v9, s[24:25] offset:0
v_mfma_f32_16x16x32_bf16 v[76:79], a[60:63], a[140:143], v[76:79]
s_add_u32 m0, s29, 86016
v_exp_f32 v67, v67
v_mfma_f32_16x16x32_bf16 v[160:163], a[64:67], v[84:87], v[160:163]
global_load_lds_dwordx4 v10, s[24:25] offset:0
v_cvt_pk_bf16_f32 v81, v66, v67
v_mfma_f32_16x16x32_bf16 v[164:167], a[68:71], v[84:87], v[164:167]
s_add_u32 s26, s22, 73728
v_exp_f32 v68, v68
v_mfma_f32_16x16x32_bf16 v[168:171], a[72:75], v[84:87], v[168:171]
s_addc_u32 s27, s23, 0
ds_read_b64_tr_b16 a[102:103], v5 offset:19112
ds_read_b64_tr_b16 a[104:105], v6 offset:14976
v_mfma_f32_16x16x32_bf16 v[172:175], a[76:79], v[84:87], v[172:175]
s_add_u32 m0, s30, 129792
v_exp_f32 v69, v69
v_mfma_f32_16x16x32_bf16 v[176:179], a[80:83], v[84:87], v[176:179]
global_load_lds_dwordx4 v11, s[26:27] offset:0
v_cvt_pk_bf16_f32 v82, v68, v69
v_mfma_f32_16x16x32_bf16 v[180:183], a[84:87], v[84:87], v[180:183]
s_add_u32 m0, s30, 129800
v_exp_f32 v70, v70
s_waitcnt vmcnt(11)
v_lshlrev_b32 v13, 16, v48
v_mfma_f32_16x16x32_bf16 v[184:187], a[88:91], v[84:87], v[184:187]
global_load_lds_dwordx4 v11, s[26:27] offset:1024
v_and_b32 v14, s35, v48
v_mfma_f32_16x16x32_bf16 v[188:191], a[92:95], v[84:87], v[188:191]
v_exp_f32 v71, v71
v_mul_f32 v13, s34, v13
v_mfma_f32_16x16x32_bf16 a[216:219], a[228:231], v[84:87], a[216:219]
v_cvt_pk_bf16_f32 v83, v70, v71
v_mul_f32 v14, s34, v14
v_mfma_f32_16x16x32_bf16 v[64:67], a[32:35], a[144:147], 0
v_cvt_pk_bf16_f32 v48, v13, v14
v_accvgpr_write_b32 a192, v48
v_mfma_f32_16x16x32_bf16 v[64:67], a[36:39], a[148:151], v[64:67]
v_exp_f32 v72, v72
v_mfma_f32_16x16x32_bf16 v[64:67], a[40:43], a[152:155], v[64:67]
v_lshlrev_b32 v13, 16, v49
v_and_b32 v14, s35, v49
v_mfma_f32_16x16x32_bf16 v[64:67], a[44:47], a[156:159], v[64:67]
v_exp_f32 v73, v73
v_mfma_f32_16x16x32_bf16 v[68:71], a[48:51], a[144:147], 0
v_cvt_pk_bf16_f32 v84, v72, v73
v_mul_f32 v13, s34, v13
v_mfma_f32_16x16x32_bf16 v[68:71], a[52:55], a[148:151], v[68:71]
v_exp_f32 v74, v74
v_mfma_f32_16x16x32_bf16 v[68:71], a[56:59], a[152:155], v[68:71]
ds_read_b64_tr_b16 a[106:107], v6 offset:19104
ds_read_b64_tr_b16 a[108:109], v6 offset:14984
v_mfma_f32_16x16x32_bf16 v[68:71], a[60:63], a[156:159], v[68:71]
v_exp_f32 v75, v75
v_mfma_f32_16x16x32_bf16 v[192:195], a[64:67], v[80:83], 0
ds_read_b64_tr_b16 a[110:111], v6 offset:19112
v_cvt_pk_bf16_f32 v85, v74, v75
v_mfma_f32_16x16x32_bf16 v[196:199], a[68:71], v[80:83], 0
v_exp_f32 v76, v76
v_mfma_f32_16x16x32_bf16 v[200:203], a[72:75], v[80:83], 0
ds_read_b64_tr_b16 a[112:113], v7 offset:14976
v_mul_f32 v14, s34, v14
v_mfma_f32_16x16x32_bf16 v[204:207], a[76:79], v[80:83], 0
v_exp_f32 v77, v77
v_mfma_f32_16x16x32_bf16 v[208:211], a[80:83], v[80:83], 0
ds_read_b64_tr_b16 a[114:115], v7 offset:19104
v_cvt_pk_bf16_f32 v86, v76, v77
v_mfma_f32_16x16x32_bf16 v[212:215], a[84:87], v[80:83], 0
v_exp_f32 v78, v78
v_mfma_f32_16x16x32_bf16 v[216:219], a[88:91], v[80:83], 0
ds_read_b64_tr_b16 a[116:117], v7 offset:14984
ds_read_b64_tr_b16 a[118:119], v7 offset:19112
v_cvt_pk_bf16_f32 v49, v13, v14
v_mfma_f32_16x16x32_bf16 v[220:223], a[92:95], v[80:83], 0
ds_read_b64_tr_b16 a[120:121], v8 offset:14976
v_exp_f32 v79, v79
v_mfma_f32_16x16x32_bf16 a[220:223], a[228:231], v[80:83], 0
ds_read_b64_tr_b16 a[122:123], v8 offset:19104
ds_read_b64_tr_b16 a[124:125], v8 offset:14984
v_cvt_pk_bf16_f32 v87, v78, v79
v_mfma_f32_16x16x32_bf16 v[72:75], a[32:35], a[160:163], 0
ds_read_b64_tr_b16 a[126:127], v8 offset:19112
v_accvgpr_write_b32 a193, v49
v_mfma_f32_16x16x32_bf16 v[72:75], a[36:39], a[164:167], v[72:75]
v_exp_f32 v64, v64
v_lshlrev_b32 v13, 16, v50
v_mfma_f32_16x16x32_bf16 v[72:75], a[40:43], a[168:171], v[72:75]
v_and_b32 v14, s35, v50
v_mul_f32 v13, s34, v13
v_mfma_f32_16x16x32_bf16 v[72:75], a[44:47], a[172:175], v[72:75]
v_exp_f32 v65, v65
v_mfma_f32_16x16x32_bf16 v[76:79], a[48:51], a[160:163], 0
v_cvt_pk_bf16_f32 v80, v64, v65
v_mul_f32 v14, s34, v14
v_mfma_f32_16x16x32_bf16 v[76:79], a[52:55], a[164:167], v[76:79]
v_exp_f32 v66, v66
v_mfma_f32_16x16x32_bf16 v[76:79], a[56:59], a[168:171], v[76:79]
v_cvt_pk_bf16_f32 v50, v13, v14
v_accvgpr_write_b32 a194, v50
v_mfma_f32_16x16x32_bf16 v[76:79], a[60:63], a[172:175], v[76:79]
s_waitcnt lgkmcnt(0)
v_exp_f32 v67, v67
v_mfma_f32_16x16x32_bf16 v[96:99], a[96:99], v[84:87], v[96:99]
v_cvt_pk_bf16_f32 v81, v66, v67
v_lshlrev_b32 v13, 16, v51
v_mfma_f32_16x16x32_bf16 v[100:103], a[100:103], v[84:87], v[100:103]
v_exp_f32 v68, v68
v_mfma_f32_16x16x32_bf16 v[104:107], a[104:107], v[84:87], v[104:107]
buffer_load_dwordx4 v[16:19], v12, s[12:15], s65 offen offset:0
v_mfma_f32_16x16x32_bf16 v[108:111], a[108:111], v[84:87], v[108:111]
v_exp_f32 v69, v69
v_mfma_f32_16x16x32_bf16 v[112:115], a[112:115], v[84:87], v[112:115]
buffer_load_dwordx4 v[20:23], v12, s[12:15], s65 offen offset:64
v_cvt_pk_bf16_f32 v82, v68, v69
v_mfma_f32_16x16x32_bf16 v[116:119], a[116:119], v[84:87], v[116:119]
v_exp_f32 v70, v70
v_mfma_f32_16x16x32_bf16 v[120:123], a[120:123], v[84:87], v[120:123]
buffer_load_dwordx4 v[24:27], v12, s[12:15], s65 offen offset:128
v_mfma_f32_16x16x32_bf16 v[124:127], a[124:127], v[84:87], v[124:127]
v_exp_f32 v71, v71
v_and_b32 v14, s35, v51
v_mfma_f32_16x16x32_bf16 a[208:211], a[228:231], v[84:87], a[208:211]
buffer_load_dwordx4 v[28:31], v12, s[12:15], s65 offen offset:192
v_cvt_pk_bf16_f32 v83, v70, v71
v_mfma_f32_16x16x32_bf16 v[64:67], a[32:35], a[176:179], 0
v_mul_f32 v13, s34, v13
v_mul_f32 v14, s34, v14
v_mfma_f32_16x16x32_bf16 v[64:67], a[36:39], a[180:183], v[64:67]
v_exp_f32 v72, v72
v_mfma_f32_16x16x32_bf16 v[64:67], a[40:43], a[184:187], v[64:67]
ds_read_b128 a[0:3], v1 offset:0
v_cvt_pk_bf16_f32 v51, v13, v14
v_mfma_f32_16x16x32_bf16 v[64:67], a[44:47], a[188:191], v[64:67]
v_exp_f32 v73, v73
v_mfma_f32_16x16x32_bf16 v[68:71], a[48:51], a[176:179], 0
ds_read_b128 a[4:7], v2 offset:0
v_cvt_pk_bf16_f32 v84, v72, v73
v_mfma_f32_16x16x32_bf16 v[68:71], a[52:55], a[180:183], v[68:71]
s_waitcnt vmcnt(8)
ds_write_b32 v0, v92
v_exp_f32 v74, v74
v_mfma_f32_16x16x32_bf16 v[68:71], a[56:59], a[184:187], v[68:71]
ds_read_b128 a[8:11], v3 offset:0
v_accvgpr_write_b32 a195, v51
v_mfma_f32_16x16x32_bf16 v[68:71], a[60:63], a[188:191], v[68:71]
v_exp_f32 v75, v75
v_mfma_f32_16x16x32_bf16 v[128:131], a[96:99], v[80:83], v[128:131]
ds_read_b128 a[12:15], v4 offset:0
v_cvt_pk_bf16_f32 v85, v74, v75
v_lshlrev_b32 v13, 16, v52
v_mfma_f32_16x16x32_bf16 v[132:135], a[100:103], v[80:83], v[132:135]
ds_read_b128 a[16:19], v1 offset:4096
v_exp_f32 v76, v76
v_mfma_f32_16x16x32_bf16 v[136:139], a[104:107], v[80:83], v[136:139]
ds_read_b32 v93, v90
ds_read_b128 a[20:23], v2 offset:4096
v_and_b32 v14, s35, v52
v_mfma_f32_16x16x32_bf16 v[140:143], a[108:111], v[80:83], v[140:143]
ds_read_b128 a[24:27], v3 offset:4096
v_exp_f32 v77, v77
v_mfma_f32_16x16x32_bf16 v[144:147], a[112:115], v[80:83], v[144:147]
ds_read_b128 a[28:31], v4 offset:4096
v_cvt_pk_bf16_f32 v86, v76, v77
v_mul_f32 v13, s34, v13
v_mfma_f32_16x16x32_bf16 v[148:151], a[116:119], v[80:83], v[148:151]
v_exp_f32 v78, v78
v_mfma_f32_16x16x32_bf16 v[152:155], a[120:123], v[80:83], v[152:155]
v_mul_f32 v14, s34, v14
v_cvt_pk_bf16_f32 v52, v13, v14
v_mfma_f32_16x16x32_bf16 v[156:159], a[124:127], v[80:83], v[156:159]
v_exp_f32 v79, v79
v_mfma_f32_16x16x32_bf16 a[212:215], a[228:231], v[80:83], a[212:215]
s_waitcnt lgkmcnt(3)
v_cmp_gt_u32 vcc, v92, v93
v_cvt_pk_bf16_f32 v87, v78, v79
v_mfma_f32_16x16x32_bf16 v[72:75], a[0:3], a[128:131], 0
s_cbranch_vccnz L_r8
L_b8:
v_accvgpr_write_b32 a196, v52
v_lshlrev_b32 v13, 16, v53
v_mfma_f32_16x16x32_bf16 v[72:75], a[4:7], a[132:135], v[72:75]
v_exp_f32 v64, v64
v_mfma_f32_16x16x32_bf16 v[72:75], a[8:11], a[136:139], v[72:75]
v_add_u32 v92, 1, v92
v_and_b32 v14, s35, v53
v_mfma_f32_16x16x32_bf16 v[72:75], a[12:15], a[140:143], v[72:75]
v_exp_f32 v65, v65
v_mfma_f32_16x16x32_bf16 v[76:79], a[16:19], a[128:131], 0
s_waitcnt lgkmcnt(0)
v_cvt_pk_bf16_f32 v80, v64, v65
v_mul_f32 v13, s34, v13
v_mfma_f32_16x16x32_bf16 v[76:79], a[20:23], a[132:135], v[76:79]
v_exp_f32 v66, v66
v_mfma_f32_16x16x32_bf16 v[76:79], a[24:27], a[136:139], v[76:79]
v_mul_f32 v14, s34, v14
v_cvt_pk_bf16_f32 v53, v13, v14
v_mfma_f32_16x16x32_bf16 v[76:79], a[28:31], a[140:143], v[76:79]
v_exp_f32 v67, v67
v_mfma_f32_16x16x32_bf16 v[160:163], a[96:99], v[84:87], v[160:163]
v_cvt_pk_bf16_f32 v81, v66, v67
v_accvgpr_write_b32 a197, v53
v_mfma_f32_16x16x32_bf16 v[164:167], a[100:103], v[84:87], v[164:167]
v_exp_f32 v68, v68
v_mfma_f32_16x16x32_bf16 v[168:171], a[104:107], v[84:87], v[168:171]
v_lshlrev_b32 v13, 16, v54
v_and_b32 v14, s35, v54
v_mfma_f32_16x16x32_bf16 v[172:175], a[108:111], v[84:87], v[172:175]
v_exp_f32 v69, v69
v_mfma_f32_16x16x32_bf16 v[176:179], a[112:115], v[84:87], v[176:179]
v_cvt_pk_bf16_f32 v82, v68, v69
v_mul_f32 v13, s34, v13
v_mfma_f32_16x16x32_bf16 v[180:183], a[116:119], v[84:87], v[180:183]
v_exp_f32 v70, v70
v_mfma_f32_16x16x32_bf16 v[184:187], a[120:123], v[84:87], v[184:187]
v_mul_f32 v14, s34, v14
v_cvt_pk_bf16_f32 v54, v13, v14
v_mfma_f32_16x16x32_bf16 v[188:191], a[124:127], v[84:87], v[188:191]
v_exp_f32 v71, v71
v_mfma_f32_16x16x32_bf16 a[216:219], a[228:231], v[84:87], a[216:219]
v_cvt_pk_bf16_f32 v83, v70, v71
v_accvgpr_write_b32 a198, v54
v_mfma_f32_16x16x32_bf16 v[64:67], a[0:3], a[144:147], 0
s_add_u32 s24, s20, 90112
ds_read_b64_tr_b16 a[64:65], v5 offset:23232
ds_read_b64_tr_b16 a[66:67], v5 offset:27360
v_mfma_f32_16x16x32_bf16 v[64:67], a[4:7], a[148:151], v[64:67]
s_addc_u32 s25, s21, 0
v_exp_f32 v72, v72
v_mfma_f32_16x16x32_bf16 v[64:67], a[8:11], a[152:155], v[64:67]
s_add_u32 m0, s29, 90112
ds_read_b64_tr_b16 a[68:69], v5 offset:23240
ds_read_b64_tr_b16 a[70:71], v5 offset:27368
v_mfma_f32_16x16x32_bf16 v[64:67], a[12:15], a[156:159], v[64:67]
v_exp_f32 v73, v73
v_mfma_f32_16x16x32_bf16 v[68:71], a[16:19], a[144:147], 0
v_cvt_pk_bf16_f32 v84, v72, v73
v_lshlrev_b32 v13, 16, v55
v_mfma_f32_16x16x32_bf16 v[68:71], a[20:23], a[148:151], v[68:71]
v_exp_f32 v74, v74
v_mfma_f32_16x16x32_bf16 v[68:71], a[24:27], a[152:155], v[68:71]
global_load_lds_dwordx4 v9, s[24:25] offset:0
v_mfma_f32_16x16x32_bf16 v[68:71], a[28:31], a[156:159], v[68:71]
s_add_u32 m0, s29, 94208
v_exp_f32 v75, v75
v_mfma_f32_16x16x32_bf16 v[192:195], a[96:99], v[80:83], v[192:195]
global_load_lds_dwordx4 v10, s[24:25] offset:0
v_cvt_pk_bf16_f32 v85, v74, v75
v_mfma_f32_16x16x32_bf16 v[196:199], a[100:103], v[80:83], v[196:199]
s_add_u32 s26, s22, 81920
v_exp_f32 v76, v76
v_mfma_f32_16x16x32_bf16 v[200:203], a[104:107], v[80:83], v[200:203]
s_addc_u32 s27, s23, 0
ds_read_b64_tr_b16 a[72:73], v6 offset:23232
ds_read_b64_tr_b16 a[74:75], v6 offset:27360
v_mfma_f32_16x16x32_bf16 v[204:207], a[108:111], v[80:83], v[204:207]
s_add_u32 m0, s30, 138048
v_exp_f32 v77, v77
v_mfma_f32_16x16x32_bf16 v[208:211], a[112:115], v[80:83], v[208:211]
global_load_lds_dwordx4 v11, s[26:27] offset:0
v_cvt_pk_bf16_f32 v86, v76, v77
v_mfma_f32_16x16x32_bf16 v[212:215], a[116:119], v[80:83], v[212:215]
s_add_u32 m0, s30, 138056
ds_read_b64_tr_b16 a[76:77], v6 offset:23240
v_exp_f32 v78, v78
v_mfma_f32_16x16x32_bf16 v[216:219], a[120:123], v[80:83], v[216:219]
global_load_lds_dwordx4 v11, s[26:27] offset:1024
ds_read_b64_tr_b16 a[78:79], v6 offset:27368
v_mfma_f32_16x16x32_bf16 v[220:223], a[124:127], v[80:83], v[220:223]
v_exp_f32 v79, v79
v_and_b32 v14, s35, v55
v_mfma_f32_16x16x32_bf16 a[220:223], a[228:231], v[80:83], a[220:223]
ds_read_b64_tr_b16 a[80:81], v7 offset:23232
ds_read_b64_tr_b16 a[82:83], v7 offset:27360
v_mul_f32 v13, s34, v13
v_mfma_f32_16x16x32_bf16 v[72:75], a[0:3], a[160:163], 0
ds_read_b64_tr_b16 a[84:85], v7 offset:23240
ds_read_b64_tr_b16 a[86:87], v7 offset:27368
v_cvt_pk_bf16_f32 v87, v78, v79
v_mfma_f32_16x16x32_bf16 v[72:75], a[4:7], a[164:167], v[72:75]
ds_read_b64_tr_b16 a[88:89], v8 offset:23232
v_exp_f32 v64, v64
v_mfma_f32_16x16x32_bf16 v[72:75], a[8:11], a[168:171], v[72:75]
ds_read_b64_tr_b16 a[90:91], v8 offset:27360
ds_read_b64_tr_b16 a[92:93], v8 offset:23240
v_mul_f32 v14, s34, v14
v_mfma_f32_16x16x32_bf16 v[72:75], a[12:15], a[172:175], v[72:75]
ds_read_b64_tr_b16 a[94:95], v8 offset:27368
v_exp_f32 v65, v65
v_mfma_f32_16x16x32_bf16 v[76:79], a[16:19], a[160:163], 0
v_cvt_pk_bf16_f32 v55, v13, v14
v_accvgpr_write_b32 a199, v55
v_cvt_pk_bf16_f32 v80, v64, v65
v_mfma_f32_16x16x32_bf16 v[76:79], a[20:23], a[164:167], v[76:79]
v_exp_f32 v66, v66
v_lshlrev_b32 v13, 16, v56
v_mfma_f32_16x16x32_bf16 v[76:79], a[24:27], a[168:171], v[76:79]
v_and_b32 v14, s35, v56
v_mul_f32 v13, s34, v13
v_mfma_f32_16x16x32_bf16 v[76:79], a[28:31], a[172:175], v[76:79]
s_waitcnt lgkmcnt(3)
v_exp_f32 v67, v67
v_mfma_f32_16x16x32_bf16 v[96:99], a[64:67], v[84:87], v[96:99]
v_cvt_pk_bf16_f32 v81, v66, v67
v_mul_f32 v14, s34, v14
v_mfma_f32_16x16x32_bf16 v[100:103], a[68:71], v[84:87], v[100:103]
v_exp_f32 v68, v68
v_mfma_f32_16x16x32_bf16 v[104:107], a[72:75], v[84:87], v[104:107]
v_cvt_pk_bf16_f32 v56, v13, v14
v_accvgpr_write_b32 a200, v56
v_mfma_f32_16x16x32_bf16 v[108:111], a[76:79], v[84:87], v[108:111]
v_exp_f32 v69, v69
v_mfma_f32_16x16x32_bf16 v[112:115], a[80:83], v[84:87], v[112:115]
v_cvt_pk_bf16_f32 v82, v68, v69
v_lshlrev_b32 v13, 16, v57
v_mfma_f32_16x16x32_bf16 v[116:119], a[84:87], v[84:87], v[116:119]
s_waitcnt lgkmcnt(0)
v_exp_f32 v70, v70
v_mfma_f32_16x16x32_bf16 v[120:123], a[88:91], v[84:87], v[120:123]
v_and_b32 v14, s35, v57
v_mul_f32 v13, s34, v13
v_mfma_f32_16x16x32_bf16 v[124:127], a[92:95], v[84:87], v[124:127]
v_exp_f32 v71, v71
v_mfma_f32_16x16x32_bf16 a[208:211], a[228:231], v[84:87], a[208:211]
ds_read_b128 a[32:35], v1 offset:8192
v_cvt_pk_bf16_f32 v83, v70, v71
v_mfma_f32_16x16x32_bf16 v[64:67], a[0:3], a[176:179], 0
ds_read_b128 a[36:39], v2 offset:8192
v_mul_f32 v14, s34, v14
v_mfma_f32_16x16x32_bf16 v[64:67], a[4:7], a[180:183], v[64:67]
v_exp_f32 v72, v72
v_mfma_f32_16x16x32_bf16 v[64:67], a[8:11], a[184:187], v[64:67]
ds_read_b128 a[40:43], v3 offset:8192
v_cvt_pk_bf16_f32 v57, v13, v14
v_mfma_f32_16x16x32_bf16 v[64:67], a[12:15], a[188:191], v[64:67]
v_exp_f32 v73, v73
v_mfma_f32_16x16x32_bf16 v[68:71], a[16:19], a[176:179], 0
ds_read_b128 a[44:47], v4 offset:8192
v_cvt_pk_bf16_f32 v84, v72, v73
v_mfma_f32_16x16x32_bf16 v[68:71], a[20:23], a[180:183], v[68:71]
s_waitcnt vmcnt(8)
ds_write_b32 v0, v92
v_exp_f32 v74, v74
v_mfma_f32_16x16x32_bf16 v[68:71], a[24:27], a[184:187], v[68:71]
ds_read_b128 a[48:51], v1 offset:12288
v_accvgpr_write_b32 a201, v57
v_mfma_f32_16x16x32_bf16 v[68:71], a[28:31], a[188:191], v[68:71]
v_exp_f32 v75, v75
v_mfma_f32_16x16x32_bf16 v[128:131], a[64:67], v[80:83], v[128:131]
ds_read_b128 a[52:55], v2 offset:12288
v_cvt_pk_bf16_f32 v85, v74, v75
v_mfma_f32_16x16x32_bf16 v[132:135], a[68:71], v[80:83], v[132:135]
v_exp_f32 v76, v76
v_mfma_f32_16x16x32_bf16 v[136:139], a[72:75], v[80:83], v[136:139]
ds_read_b32 v93, v90
ds_read_b128 a[56:59], v3 offset:12288
v_mfma_f32_16x16x32_bf16 v[140:143], a[76:79], v[80:83], v[140:143]
v_exp_f32 v77, v77
v_lshlrev_b32 v13, 16, v58
v_mfma_f32_16x16x32_bf16 v[144:147], a[80:83], v[80:83], v[144:147]
ds_read_b128 a[60:63], v4 offset:12288
v_cvt_pk_bf16_f32 v86, v76, v77
v_mfma_f32_16x16x32_bf16 v[148:151], a[84:87], v[80:83], v[148:151]
v_exp_f32 v78, v78
v_and_b32 v14, s35, v58
v_mfma_f32_16x16x32_bf16 v[152:155], a[88:91], v[80:83], v[152:155]
v_mul_f32 v13, s34, v13
v_mul_f32 v14, s34, v14
v_mfma_f32_16x16x32_bf16 v[156:159], a[92:95], v[80:83], v[156:159]
v_exp_f32 v79, v79
v_mfma_f32_16x16x32_bf16 a[212:215], a[228:231], v[80:83], a[212:215]
s_waitcnt lgkmcnt(2)
v_cmp_gt_u32 vcc, v92, v93
v_cvt_pk_bf16_f32 v87, v78, v79
v_mfma_f32_16x16x32_bf16 v[72:75], a[32:35], a[128:131], 0
s_cbranch_vccnz L_r9
L_b9:
v_cvt_pk_bf16_f32 v58, v13, v14
v_accvgpr_write_b32 a202, v58
v_mfma_f32_16x16x32_bf16 v[72:75], a[36:39], a[132:135], v[72:75]
v_exp_f32 v64, v64
v_mfma_f32_16x16x32_bf16 v[72:75], a[40:43], a[136:139], v[72:75]
v_add_u32 v92, 1, v92
v_lshlrev_b32 v13, 16, v59
v_mfma_f32_16x16x32_bf16 v[72:75], a[44:47], a[140:143], v[72:75]
v_exp_f32 v65, v65
v_mfma_f32_16x16x32_bf16 v[76:79], a[48:51], a[128:131], 0
v_cvt_pk_bf16_f32 v80, v64, v65
v_and_b32 v14, s35, v59
v_mfma_f32_16x16x32_bf16 v[76:79], a[52:55], a[132:135], v[76:79]
s_waitcnt lgkmcnt(0)
v_exp_f32 v66, v66
v_mfma_f32_16x16x32_bf16 v[76:79], a[56:59], a[136:139], v[76:79]
v_mul_f32 v13, s34, v13
v_mul_f32 v14, s34, v14
v_mfma_f32_16x16x32_bf16 v[76:79], a[60:63], a[140:143], v[76:79]
v_exp_f32 v67, v67
v_mfma_f32_16x16x32_bf16 v[160:163], a[64:67], v[84:87], v[160:163]
v_cvt_pk_bf16_f32 v81, v66, v67
v_cvt_pk_bf16_f32 v59, v13, v14
v_mfma_f32_16x16x32_bf16 v[164:167], a[68:71], v[84:87], v[164:167]
v_exp_f32 v68, v68
v_mfma_f32_16x16x32_bf16 v[168:171], a[72:75], v[84:87], v[168:171]
v_accvgpr_write_b32 a203, v59
v_lshlrev_b32 v13, 16, v60
v_mfma_f32_16x16x32_bf16 v[172:175], a[76:79], v[84:87], v[172:175]
v_exp_f32 v69, v69
v_mfma_f32_16x16x32_bf16 v[176:179], a[80:83], v[84:87], v[176:179]
v_cvt_pk_bf16_f32 v82, v68, v69
v_and_b32 v14, s35, v60
v_mfma_f32_16x16x32_bf16 v[180:183], a[84:87], v[84:87], v[180:183]
v_exp_f32 v70, v70
v_mfma_f32_16x16x32_bf16 v[184:187], a[88:91], v[84:87], v[184:187]
v_mul_f32 v13, s34, v13
v_mul_f32 v14, s34, v14
v_mfma_f32_16x16x32_bf16 v[188:191], a[92:95], v[84:87], v[188:191]
v_exp_f32 v71, v71
v_mfma_f32_16x16x32_bf16 a[216:219], a[228:231], v[84:87], a[216:219]
ds_read_b64_tr_b16 a[96:97], v5 offset:31488
v_cvt_pk_bf16_f32 v83, v70, v71
v_mfma_f32_16x16x32_bf16 v[64:67], a[32:35], a[144:147], 0
ds_read_b64_tr_b16 a[98:99], v5 offset:35616
v_cvt_pk_bf16_f32 v60, v13, v14
v_mfma_f32_16x16x32_bf16 v[64:67], a[36:39], a[148:151], v[64:67]
v_exp_f32 v72, v72
v_mfma_f32_16x16x32_bf16 v[64:67], a[40:43], a[152:155], v[64:67]
ds_read_b64_tr_b16 a[100:101], v5 offset:31496
ds_read_b64_tr_b16 a[102:103], v5 offset:35624
v_mfma_f32_16x16x32_bf16 v[64:67], a[44:47], a[156:159], v[64:67]
v_exp_f32 v73, v73
v_mfma_f32_16x16x32_bf16 v[68:71], a[48:51], a[144:147], 0
ds_read_b64_tr_b16 a[104:105], v6 offset:31488
v_cvt_pk_bf16_f32 v84, v72, v73
v_mfma_f32_16x16x32_bf16 v[68:71], a[52:55], a[148:151], v[68:71]
v_exp_f32 v74, v74
v_mfma_f32_16x16x32_bf16 v[68:71], a[56:59], a[152:155], v[68:71]
ds_read_b64_tr_b16 a[106:107], v6 offset:35616
v_accvgpr_write_b32 a204, v60
v_mfma_f32_16x16x32_bf16 v[68:71], a[60:63], a[156:159], v[68:71]
v_exp_f32 v75, v75
v_mfma_f32_16x16x32_bf16 v[192:195], a[64:67], v[80:83], v[192:195]
ds_read_b64_tr_b16 a[108:109], v6 offset:31496
v_cvt_pk_bf16_f32 v85, v74, v75
v_mfma_f32_16x16x32_bf16 v[196:199], a[68:71], v[80:83], v[196:199]
v_exp_f32 v76, v76
v_mfma_f32_16x16x32_bf16 v[200:203], a[72:75], v[80:83], v[200:203]
ds_read_b64_tr_b16 a[110:111], v6 offset:35624
ds_read_b64_tr_b16 a[112:113], v7 offset:31488
v_mfma_f32_16x16x32_bf16 v[204:207], a[76:79], v[80:83], v[204:207]
v_exp_f32 v77, v77
v_mfma_f32_16x16x32_bf16 v[208:211], a[80:83], v[80:83], v[208:211]
ds_read_b64_tr_b16 a[114:115], v7 offset:35616
v_cvt_pk_bf16_f32 v86, v76, v77
v_mfma_f32_16x16x32_bf16 v[212:215], a[84:87], v[80:83], v[212:215]
v_exp_f32 v78, v78
v_lshlrev_b32 v13, 16, v61
v_mfma_f32_16x16x32_bf16 v[216:219], a[88:91], v[80:83], v[216:219]
ds_read_b64_tr_b16 a[116:117], v7 offset:31496
ds_read_b64_tr_b16 a[118:119], v7 offset:35624
v_mfma_f32_16x16x32_bf16 v[220:223], a[92:95], v[80:83], v[220:223]
ds_read_b64_tr_b16 a[120:121], v8 offset:31488
v_exp_f32 v79, v79
v_mfma_f32_16x16x32_bf16 a[220:223], a[228:231], v[80:83], a[220:223]
ds_read_b64_tr_b16 a[122:123], v8 offset:35616
v_and_b32 v14, s35, v61
v_cvt_pk_bf16_f32 v87, v78, v79
v_mfma_f32_16x16x32_bf16 v[72:75], a[32:35], a[160:163], 0
s_add_u32 s24, s20, 98304
ds_read_b64_tr_b16 a[124:125], v8 offset:31496
ds_read_b64_tr_b16 a[126:127], v8 offset:35624
v_mul_f32 v13, s34, v13
v_mfma_f32_16x16x32_bf16 v[72:75], a[36:39], a[164:167], v[72:75]
s_addc_u32 s25, s21, 0
v_exp_f32 v64, v64
v_mfma_f32_16x16x32_bf16 v[72:75], a[40:43], a[168:171], v[72:75]
s_add_u32 m0, s29, 98304
v_mul_f32 v14, s34, v14
v_cvt_pk_bf16_f32 v61, v13, v14
v_mfma_f32_16x16x32_bf16 v[72:75], a[44:47], a[172:175], v[72:75]
v_exp_f32 v65, v65
v_mfma_f32_16x16x32_bf16 v[76:79], a[48:51], a[160:163], 0
v_cvt_pk_bf16_f32 v80, v64, v65
v_accvgpr_write_b32 a205, v61
v_mfma_f32_16x16x32_bf16 v[76:79], a[52:55], a[164:167], v[76:79]
v_exp_f32 v66, v66
v_mfma_f32_16x16x32_bf16 v[76:79], a[56:59], a[168:171], v[76:79]
global_load_lds_dwordx4 v9, s[24:25] offset:0
v_mfma_f32_16x16x32_bf16 v[76:79], a[60:63], a[172:175], v[76:79]
s_add_u32 m0, s29, 102400
v_exp_f32 v67, v67
s_waitcnt lgkmcnt(0)
v_mfma_f32_16x16x32_bf16 v[96:99], a[96:99], v[84:87], v[96:99]
global_load_lds_dwordx4 v10, s[24:25] offset:0
v_cvt_pk_bf16_f32 v81, v66, v67
v_mfma_f32_16x16x32_bf16 v[100:103], a[100:103], v[84:87], v[100:103]
s_add_u32 s26, s22, 90112
v_exp_f32 v68, v68
v_lshlrev_b32 v13, 16, v62
v_mfma_f32_16x16x32_bf16 v[104:107], a[104:107], v[84:87], v[104:107]
s_addc_u32 s27, s23, 0
v_and_b32 v14, s35, v62
v_mul_f32 v13, s34, v13
v_mfma_f32_16x16x32_bf16 v[108:111], a[108:111], v[84:87], v[108:111]
s_add_u32 m0, s30, 146304
v_exp_f32 v69, v69
v_mfma_f32_16x16x32_bf16 v[112:115], a[112:115], v[84:87], v[112:115]
global_load_lds_dwordx4 v11, s[26:27] offset:0
v_cvt_pk_bf16_f32 v82, v68, v69
v_mfma_f32_16x16x32_bf16 v[116:119], a[116:119], v[84:87], v[116:119]
s_add_u32 m0, s30, 146312
v_exp_f32 v70, v70
v_mfma_f32_16x16x32_bf16 v[120:123], a[120:123], v[84:87], v[120:123]
global_load_lds_dwordx4 v11, s[26:27] offset:1024
v_mul_f32 v14, s34, v14
v_mfma_f32_16x16x32_bf16 v[124:127], a[124:127], v[84:87], v[124:127]
v_exp_f32 v71, v71
v_mfma_f32_16x16x32_bf16 a[208:211], a[228:231], v[84:87], a[208:211]
v_cvt_pk_bf16_f32 v83, v70, v71
v_cvt_pk_bf16_f32 v62, v13, v14
v_mfma_f32_16x16x32_bf16 v[64:67], a[32:35], a[176:179], 0
v_accvgpr_write_b32 a206, v62
v_lshlrev_b32 v13, 16, v63
v_mfma_f32_16x16x32_bf16 v[64:67], a[36:39], a[180:183], v[64:67]
v_exp_f32 v72, v72
v_mfma_f32_16x16x32_bf16 v[64:67], a[40:43], a[184:187], v[64:67]
v_and_b32 v14, s35, v63
v_mul_f32 v13, s34, v13
v_mfma_f32_16x16x32_bf16 v[64:67], a[44:47], a[188:191], v[64:67]
v_exp_f32 v73, v73
v_mfma_f32_16x16x32_bf16 v[68:71], a[48:51], a[176:179], 0
v_cvt_pk_bf16_f32 v84, v72, v73
v_mul_f32 v14, s34, v14
v_mfma_f32_16x16x32_bf16 v[68:71], a[52:55], a[180:183], v[68:71]
v_exp_f32 v74, v74
v_mfma_f32_16x16x32_bf16 v[68:71], a[56:59], a[184:187], v[68:71]
v_cvt_pk_bf16_f32 v63, v13, v14
v_accvgpr_write_b32 a207, v63
v_mfma_f32_16x16x32_bf16 v[68:71], a[60:63], a[188:191], v[68:71]
v_exp_f32 v75, v75
v_mfma_f32_16x16x32_bf16 v[128:131], a[96:99], v[80:83], v[128:131]
ds_read_b128 a[0:3], v1 offset:16384
v_cvt_pk_bf16_f32 v85, v74, v75
v_mfma_f32_16x16x32_bf16 v[132:135], a[100:103], v[80:83], v[132:135]
v_exp_f32 v76, v76
v_mfma_f32_16x16x32_bf16 v[136:139], a[104:107], v[80:83], v[136:139]
ds_read_b128 a[4:7], v2 offset:16384
ds_read_b128 a[8:11], v3 offset:16384
v_mfma_f32_16x16x32_bf16 v[140:143], a[108:111], v[80:83], v[140:143]
v_exp_f32 v77, v77
v_mfma_f32_16x16x32_bf16 v[144:147], a[112:115], v[80:83], v[144:147]
ds_read_b128 a[12:15], v4 offset:16384
v_cvt_pk_bf16_f32 v86, v76, v77
v_mfma_f32_16x16x32_bf16 v[148:151], a[116:119], v[80:83], v[148:151]
v_exp_f32 v78, v78
v_mfma_f32_16x16x32_bf16 v[152:155], a[120:123], v[80:83], v[152:155]
ds_read_b128 a[16:19], v1 offset:20480
ds_read_b128 a[20:23], v2 offset:20480
v_mfma_f32_16x16x32_bf16 v[156:159], a[124:127], v[80:83], v[156:159]
v_exp_f32 v79, v79
v_mfma_f32_16x16x32_bf16 a[212:215], a[228:231], v[80:83], a[212:215]
v_cvt_pk_bf16_f32 v87, v78, v79
s_waitcnt vmcnt(11)
v_lshlrev_b32 v13, 16, v16
v_mfma_f32_16x16x32_bf16 v[72:75], a[32:35], a[192:195], 0
v_and_b32 v14, s35, v16
v_mul_f32 v13, s34, v13
v_mfma_f32_16x16x32_bf16 v[72:75], a[36:39], a[196:199], v[72:75]
v_exp_f32 v64, v64
v_mfma_f32_16x16x32_bf16 v[72:75], a[40:43], a[200:203], v[72:75]
v_mul_f32 v14, s34, v14
v_cvt_pk_bf16_f32 v16, v13, v14
v_mfma_f32_16x16x32_bf16 v[72:75], a[44:47], a[204:207], v[72:75]
v_exp_f32 v65, v65
v_mfma_f32_16x16x32_bf16 v[76:79], a[48:51], a[192:195], 0
v_cvt_pk_bf16_f32 v80, v64, v65
v_lshlrev_b32 v13, 16, v17
v_mfma_f32_16x16x32_bf16 v[76:79], a[52:55], a[196:199], v[76:79]
s_waitcnt vmcnt(4)
ds_write_b32 v0, v92
v_exp_f32 v66, v66
v_mfma_f32_16x16x32_bf16 v[76:79], a[56:59], a[200:203], v[76:79]
ds_read_b128 a[24:27], v3 offset:20480
ds_read_b128 a[28:31], v4 offset:20480
v_mfma_f32_16x16x32_bf16 v[76:79], a[60:63], a[204:207], v[76:79]
v_exp_f32 v67, v67
v_mfma_f32_16x16x32_bf16 v[160:163], a[96:99], v[84:87], v[160:163]
v_cvt_pk_bf16_f32 v81, v66, v67
v_and_b32 v14, s35, v17
v_mfma_f32_16x16x32_bf16 v[164:167], a[100:103], v[84:87], v[164:167]
v_exp_f32 v68, v68
v_mfma_f32_16x16x32_bf16 v[168:171], a[104:107], v[84:87], v[168:171]
ds_read_b32 v93, v90
v_mul_f32 v13, s34, v13
v_mfma_f32_16x16x32_bf16 v[172:175], a[108:111], v[84:87], v[172:175]
v_exp_f32 v69, v69
v_mfma_f32_16x16x32_bf16 v[176:179], a[112:115], v[84:87], v[176:179]
v_cvt_pk_bf16_f32 v82, v68, v69
v_mul_f32 v14, s34, v14
v_mfma_f32_16x16x32_bf16 v[180:183], a[116:119], v[84:87], v[180:183]
v_exp_f32 v70, v70
v_mfma_f32_16x16x32_bf16 v[184:187], a[120:123], v[84:87], v[184:187]
v_cvt_pk_bf16_f32 v17, v13, v14
v_lshlrev_b32 v13, 16, v18
v_mfma_f32_16x16x32_bf16 v[188:191], a[124:127], v[84:87], v[188:191]
v_exp_f32 v71, v71
v_mfma_f32_16x16x32_bf16 a[216:219], a[228:231], v[84:87], a[216:219]
s_waitcnt lgkmcnt(0)
v_cmp_gt_u32 vcc, v92, v93
v_cvt_pk_bf16_f32 v83, v70, v71
v_mfma_f32_16x16x32_bf16 v[64:67], a[0:3], a[128:131], 0
s_cbranch_vccnz L_r10
L_b10:
buffer_load_dwordx4 v[32:35], v12, s[12:15], s66 offen offset:0
v_mfma_f32_16x16x32_bf16 v[64:67], a[4:7], a[132:135], v[64:67]
v_exp_f32 v72, v72
v_mfma_f32_16x16x32_bf16 v[64:67], a[8:11], a[136:139], v[64:67]
buffer_load_dwordx4 v[36:39], v12, s[12:15], s66 offen offset:64
v_mfma_f32_16x16x32_bf16 v[64:67], a[12:15], a[140:143], v[64:67]
v_exp_f32 v73, v73
v_mfma_f32_16x16x32_bf16 v[68:71], a[16:19], a[128:131], 0
buffer_load_dwordx4 v[40:43], v12, s[12:15], s66 offen offset:128
v_cvt_pk_bf16_f32 v84, v72, v73
v_mfma_f32_16x16x32_bf16 v[68:71], a[20:23], a[132:135], v[68:71]
v_exp_f32 v74, v74
v_add_u32 v92, 1, v92
v_mfma_f32_16x16x32_bf16 v[68:71], a[24:27], a[136:139], v[68:71]
buffer_load_dwordx4 v[44:47], v12, s[12:15], s66 offen offset:192
v_and_b32 v14, s35, v18
v_mfma_f32_16x16x32_bf16 v[68:71], a[28:31], a[140:143], v[68:71]
v_exp_f32 v75, v75
v_mfma_f32_16x16x32_bf16 v[192:195], a[96:99], v[80:83], v[192:195]
v_cvt_pk_bf16_f32 v85, v74, v75
v_mul_f32 v13, s34, v13
v_mfma_f32_16x16x32_bf16 v[196:199], a[100:103], v[80:83], v[196:199]
v_exp_f32 v76, v76
v_mfma_f32_16x16x32_bf16 v[200:203], a[104:107], v[80:83], v[200:203]
v_mul_f32 v14, s34, v14
v_cvt_pk_bf16_f32 v18, v13, v14
v_mfma_f32_16x16x32_bf16 v[204:207], a[108:111], v[80:83], v[204:207]
v_exp_f32 v77, v77
v_mfma_f32_16x16x32_bf16 v[208:211], a[112:115], v[80:83], v[208:211]
v_cvt_pk_bf16_f32 v86, v76, v77
v_lshlrev_b32 v13, 16, v19
v_mfma_f32_16x16x32_bf16 v[212:215], a[116:119], v[80:83], v[212:215]
v_exp_f32 v78, v78
v_mfma_f32_16x16x32_bf16 v[216:219], a[120:123], v[80:83], v[216:219]
v_and_b32 v14, s35, v19
v_mul_f32 v13, s34, v13
v_mfma_f32_16x16x32_bf16 v[220:223], a[124:127], v[80:83], v[220:223]
v_exp_f32 v79, v79
v_mfma_f32_16x16x32_bf16 a[220:223], a[228:231], v[80:83], a[220:223]
v_cvt_pk_bf16_f32 v87, v78, v79
v_mul_f32 v14, s34, v14
v_mfma_f32_16x16x32_bf16 v[72:75], a[0:3], a[144:147], 0
v_cvt_pk_bf16_f32 v19, v13, v14
v_lshlrev_b32 v13, 16, v20
v_mfma_f32_16x16x32_bf16 v[72:75], a[4:7], a[148:151], v[72:75]
v_exp_f32 v64, v64
v_mfma_f32_16x16x32_bf16 v[72:75], a[8:11], a[152:155], v[72:75]
ds_read_b64_tr_b16 a[64:65], v5 offset:39744
ds_read_b64_tr_b16 a[66:67], v5 offset:43872
v_mfma_f32_16x16x32_bf16 v[72:75], a[12:15], a[156:159], v[72:75]
v_exp_f32 v65, v65
v_mfma_f32_16x16x32_bf16 v[76:79], a[16:19], a[144:147], 0
ds_read_b64_tr_b16 a[68:69], v5 offset:39752
v_cvt_pk_bf16_f32 v80, v64, v65
v_mfma_f32_16x16x32_bf16 v[76:79], a[20:23], a[148:151], v[76:79]
v_exp_f32 v66, v66
v_mfma_f32_16x16x32_bf16 v[76:79], a[24:27], a[152:155], v[76:79]
ds_read_b64_tr_b16 a[70:71], v5 offset:43880
v_and_b32 v14, s35, v20
v_mfma_f32_16x16x32_bf16 v[76:79], a[28:31], a[156:159], v[76:79]
v_exp_f32 v67, v67
v_mfma_f32_16x16x32_bf16 v[224:227], a[96:99], v[84:87], 0
ds_read_b64_tr_b16 a[72:73], v6 offset:39744
v_cvt_pk_bf16_f32 v81, v66, v67
v_mfma_f32_16x16x32_bf16 v[228:231], a[100:103], v[84:87], 0
v_exp_f32 v68, v68
v_mfma_f32_16x16x32_bf16 v[232:235], a[104:107], v[84:87], 0
ds_read_b64_tr_b16 a[74:75], v6 offset:43872
ds_read_b64_tr_b16 a[76:77], v6 offset:39752
v_mfma_f32_16x16x32_bf16 v[236:239], a[108:111], v[84:87], 0
v_exp_f32 v69, v69
v_mfma_f32_16x16x32_bf16 v[240:243], a[112:115], v[84:87], 0
ds_read_b64_tr_b16 a[78:79], v6 offset:43880
v_cvt_pk_bf16_f32 v82, v68, v69
v_mfma_f32_16x16x32_bf16 v[244:247], a[116:119], v[84:87], 0
ds_read_b64_tr_b16 a[80:81], v7 offset:39744
v_exp_f32 v70, v70
v_mfma_f32_16x16x32_bf16 v[248:251], a[120:123], v[84:87], 0
ds_read_b64_tr_b16 a[82:83], v7 offset:43872
ds_read_b64_tr_b16 a[84:85], v7 offset:39752
v_mul_f32 v13, s34, v13
v_mfma_f32_16x16x32_bf16 v[252:255], a[124:127], v[84:87], 0
ds_read_b64_tr_b16 a[86:87], v7 offset:43880
v_exp_f32 v71, v71
v_mfma_f32_16x16x32_bf16 a[224:227], a[228:231], v[84:87], 0
ds_read_b64_tr_b16 a[88:89], v8 offset:39744
ds_read_b64_tr_b16 a[90:91], v8 offset:43872
v_mul_f32 v14, s34, v14
v_mfma_f32_16x16x32_bf16 v[64:67], a[0:3], a[160:163], 0
s_add_u32 s24, s20, 106496
ds_read_b64_tr_b16 a[92:93], v8 offset:39752
ds_read_b64_tr_b16 a[94:95], v8 offset:43880
v_cvt_pk_bf16_f32 v83, v70, v71
v_mfma_f32_16x16x32_bf16 v[64:67], a[4:7], a[164:167], v[64:67]
s_addc_u32 s25, s21, 0
v_exp_f32 v72, v72
v_cvt_pk_bf16_f32 v20, v13, v14
v_mfma_f32_16x16x32_bf16 v[64:67], a[8:11], a[168:171], v[64:67]
s_add_u32 m0, s29, 106496
v_lshlrev_b32 v13, 16, v21
v_and_b32 v14, s35, v21
v_mfma_f32_16x16x32_bf16 v[64:67], a[12:15], a[172:175], v[64:67]
v_exp_f32 v73, v73
v_mfma_f32_16x16x32_bf16 v[68:71], a[16:19], a[160:163], 0
v_cvt_pk_bf16_f32 v84, v72, v73
v_mul_f32 v13, s34, v13
v_mfma_f32_16x16x32_bf16 v[68:71], a[20:23], a[164:167], v[68:71]
v_exp_f32 v74, v74
v_mfma_f32_16x16x32_bf16 v[68:71], a[24:27], a[168:171], v[68:71]
global_load_lds_dwordx4 v9, s[24:25] offset:0
v_mfma_f32_16x16x32_bf16 v[68:71], a[28:31], a[172:175], v[68:71]
s_add_u32 m0, s29, 110592
v_exp_f32 v75, v75
s_waitcnt lgkmcnt(0)
v_mfma_f32_16x16x32_bf16 v[96:99], a[64:67], v[80:83], v[96:99]
global_load_lds_dwordx4 v10, s[24:25] offset:0
v_cvt_pk_bf16_f32 v85, v74, v75
v_mfma_f32_16x16x32_bf16 v[100:103], a[68:71], v[80:83], v[100:103]
s_add_u32 s26, s22, 98304
v_exp_f32 v76, v76
v_mul_f32 v14, s34, v14
v_mfma_f32_16x16x32_bf16 v[104:107], a[72:75], v[80:83], v[104:107]
s_addc_u32 s27, s23, 0
v_cvt_pk_bf16_f32 v21, v13, v14
v_lshlrev_b32 v13, 16, v22
v_mfma_f32_16x16x32_bf16 v[108:111], a[76:79], v[80:83], v[108:111]
s_add_u32 m0, s30, 154560
v_exp_f32 v77, v77
v_mfma_f32_16x16x32_bf16 v[112:115], a[80:83], v[80:83], v[112:115]
global_load_lds_dwordx4 v11, s[26:27] offset:0
v_cvt_pk_bf16_f32 v86, v76, v77
v_mfma_f32_16x16x32_bf16 v[116:119], a[84:87], v[80:83], v[116:119]
s_add_u32 m0, s30, 154568
v_exp_f32 v78, v78
v_mfma_f32_16x16x32_bf16 v[120:123], a[88:91], v[80:83], v[120:123]
global_load_lds_dwordx4 v11, s[26:27] offset:1024
v_mfma_f32_16x16x32_bf16 v[124:127], a[92:95], v[80:83], v[124:127]
v_exp_f32 v79, v79
v_and_b32 v14, s35, v22
v_mfma_f32_16x16x32_bf16 a[208:211], a[228:231], v[80:83], a[208:211]
v_cvt_pk_bf16_f32 v87, v78, v79
v_mul_f32 v13, s34, v13
v_mfma_f32_16x16x32_bf16 v[72:75], a[0:3], a[176:179], 0
v_mul_f32 v14, s34, v14
v_cvt_pk_bf16_f32 v22, v13, v14
v_mfma_f32_16x16x32_bf16 v[72:75], a[4:7], a[180:183], v[72:75]
v_exp_f32 v64, v64
v_mfma_f32_16x16x32_bf16 v[72:75], a[8:11], a[184:187], v[72:75]
v_lshlrev_b32 v13, 16, v23
v_and_b32 v14, s35, v23
v_mfma_f32_16x16x32_bf16 v[72:75], a[12:15], a[188:191], v[72:75]
v_exp_f32 v65, v65
v_mfma_f32_16x16x32_bf16 v[76:79], a[16:19], a[176:179], 0
v_cvt_pk_bf16_f32 v80, v64, v65
v_mul_f32 v13, s34, v13
v_mfma_f32_16x16x32_bf16 v[76:79], a[20:23], a[180:183], v[76:79]
v_exp_f32 v66, v66
v_mfma_f32_16x16x32_bf16 v[76:79], a[24:27], a[184:187], v[76:79]
v_mul_f32 v14, s34, v14
v_cvt_pk_bf16_f32 v23, v13, v14
v_mfma_f32_16x16x32_bf16 v[76:79], a[28:31], a[188:191], v[76:79]
v_exp_f32 v67, v67
v_mfma_f32_16x16x32_bf16 v[128:131], a[64:67], v[84:87], v[128:131]
v_cvt_pk_bf16_f32 v81, v66, v67
v_lshlrev_b32 v13, 16, v24
v_mfma_f32_16x16x32_bf16 v[132:135], a[68:71], v[84:87], v[132:135]
v_exp_f32 v68, v68
v_mfma_f32_16x16x32_bf16 v[136:139], a[72:75], v[84:87], v[136:139]
ds_read_b128 a[32:35], v1 offset:24576
v_and_b32 v14, s35, v24
v_mfma_f32_16x16x32_bf16 v[140:143], a[76:79], v[84:87], v[140:143]
v_exp_f32 v69, v69
v_mfma_f32_16x16x32_bf16 v[144:147], a[80:83], v[84:87], v[144:147]
v_cvt_pk_bf16_f32 v82, v68, v69
v_mul_f32 v13, s34, v13
v_mfma_f32_16x16x32_bf16 v[148:151], a[84:87], v[84:87], v[148:151]
v_exp_f32 v70, v70
v_mfma_f32_16x16x32_bf16 v[152:155], a[88:91], v[84:87], v[152:155]
ds_read_b128 a[36:39], v2 offset:24576
ds_read_b128 a[40:43], v3 offset:24576
v_mfma_f32_16x16x32_bf16 v[156:159], a[92:95], v[84:87], v[156:159]
v_exp_f32 v71, v71
v_mfma_f32_16x16x32_bf16 a[212:215], a[228:231], v[84:87], a[212:215]
ds_read_b128 a[44:47], v4 offset:24576
v_cvt_pk_bf16_f32 v83, v70, v71
v_mfma_f32_16x16x32_bf16 v[64:67], a[0:3], a[192:195], 0
ds_read_b128 a[48:51], v1 offset:28672
v_mul_f32 v14, s34, v14
v_mfma_f32_16x16x32_bf16 v[64:67], a[4:7], a[196:199], v[64:67]
v_exp_f32 v72, v72
v_mfma_f32_16x16x32_bf16 v[64:67], a[8:11], a[200:203], v[64:67]
ds_read_b128 a[52:55], v2 offset:28672
v_cvt_pk_bf16_f32 v24, v13, v14
v_mfma_f32_16x16x32_bf16 v[64:67], a[12:15], a[204:207], v[64:67]
v_exp_f32 v73, v73
v_mfma_f32_16x16x32_bf16 v[68:71], a[16:19], a[192:195], 0
ds_read_b128 a[56:59], v3 offset:28672
v_cvt_pk_bf16_f32 v84, v72, v73
v_mfma_f32_16x16x32_bf16 v[68:71], a[20:23], a[196:199], v[68:71]
s_waitcnt vmcnt(8)
ds_write_b32 v0, v92
v_exp_f32 v74, v74
v_mfma_f32_16x16x32_bf16 v[68:71], a[24:27], a[200:203], v[68:71]
ds_read_b128 a[60:63], v4 offset:28672
v_lshlrev_b32 v13, 16, v25
v_mfma_f32_16x16x32_bf16 v[68:71], a[28:31], a[204:207], v[68:71]
v_exp_f32 v75, v75
v_mfma_f32_16x16x32_bf16 v[160:163], a[64:67], v[80:83], v[160:163]
v_cvt_pk_bf16_f32 v85, v74, v75
v_and_b32 v14, s35, v25
v_mfma_f32_16x16x32_bf16 v[164:167], a[68:71], v[80:83], v[164:167]
v_exp_f32 v76, v76
v_mfma_f32_16x16x32_bf16 v[168:171], a[72:75], v[80:83], v[168:171]
ds_read_b32 v93, v90
v_mul_f32 v13, s34, v13
v_mfma_f32_16x16x32_bf16 v[172:175], a[76:79], v[80:83], v[172:175]
v_exp_f32 v77, v77
v_mfma_f32_16x16x32_bf16 v[176:179], a[80:83], v[80:83], v[176:179]
v_cvt_pk_bf16_f32 v86, v76, v77
v_mul_f32 v14, s34, v14
v_mfma_f32_16x16x32_bf16 v[180:183], a[84:87], v[80:83], v[180:183]
v_exp_f32 v78, v78
v_mfma_f32_16x16x32_bf16 v[184:187], a[88:91], v[80:83], v[184:187]
v_cvt_pk_bf16_f32 v25, v13, v14
v_lshlrev_b32 v13, 16, v26
v_mfma_f32_16x16x32_bf16 v[188:191], a[92:95], v[80:83], v[188:191]
v_exp_f32 v79, v79
v_mfma_f32_16x16x32_bf16 a[216:219], a[228:231], v[80:83], a[216:219]
s_waitcnt lgkmcnt(0)
v_cmp_gt_u32 vcc, v92, v93
v_cvt_pk_bf16_f32 v87, v78, v79
v_mfma_f32_16x16x32_bf16 v[72:75], a[32:35], a[128:131], 0
s_cbranch_vccnz L_r11
L_b11:
v_add_u32 v92, 1, v92
v_and_b32 v14, s35, v26
v_mfma_f32_16x16x32_bf16 v[72:75], a[36:39], a[132:135], v[72:75]
v_exp_f32 v64, v64
v_mfma_f32_16x16x32_bf16 v[72:75], a[40:43], a[136:139], v[72:75]
v_mul_f32 v13, s34, v13
v_mul_f32 v14, s34, v14
v_mfma_f32_16x16x32_bf16 v[72:75], a[44:47], a[140:143], v[72:75]
v_exp_f32 v65, v65
v_mfma_f32_16x16x32_bf16 v[76:79], a[48:51], a[128:131], 0
v_cvt_pk_bf16_f32 v80, v64, v65
v_cvt_pk_bf16_f32 v26, v13, v14
v_mfma_f32_16x16x32_bf16 v[76:79], a[52:55], a[132:135], v[76:79]
v_exp_f32 v66, v66
v_mfma_f32_16x16x32_bf16 v[76:79], a[56:59], a[136:139], v[76:79]
v_lshlrev_b32 v13, 16, v27
v_and_b32 v14, s35, v27
v_mfma_f32_16x16x32_bf16 v[76:79], a[60:63], a[140:143], v[76:79]
v_exp_f32 v67, v67
v_mfma_f32_16x16x32_bf16 v[192:195], a[64:67], v[84:87], v[192:195]
v_cvt_pk_bf16_f32 v81, v66, v67
v_mul_f32 v13, s34, v13
v_mfma_f32_16x16x32_bf16 v[196:199], a[68:71], v[84:87], v[196:199]
v_exp_f32 v68, v68
v_mfma_f32_16x16x32_bf16 v[200:203], a[72:75], v[84:87], v[200:203]
ds_read_b64_tr_b16 a[96:97], v5 offset:48000
v_mul_f32 v14, s34, v14
v_mfma_f32_16x16x32_bf16 v[204:207], a[76:79], v[84:87], v[204:207]
v_exp_f32 v69, v69
v_mfma_f32_16x16x32_bf16 v[208:211], a[80:83], v[84:87], v[208:211]
ds_read_b64_tr_b16 a[98:99], v5 offset:52128
v_cvt_pk_bf16_f32 v82, v68, v69
v_mfma_f32_16x16x32_bf16 v[212:215], a[84:87], v[84:87], v[212:215]
v_exp_f32 v70, v70
v_mfma_f32_16x16x32_bf16 v[216:219], a[88:91], v[84:87], v[216:219]
ds_read_b64_tr_b16 a[100:101], v5 offset:48008
v_cvt_pk_bf16_f32 v27, v13, v14
v_mfma_f32_16x16x32_bf16 v[220:223], a[92:95], v[84:87], v[220:223]
v_exp_f32 v71, v71
v_mfma_f32_16x16x32_bf16 a[220:223], a[228:231], v[84:87], a[220:223]
ds_read_b64_tr_b16 a[102:103], v5 offset:52136
v_cvt_pk_bf16_f32 v83, v70, v71
v_mfma_f32_16x16x32_bf16 v[64:67], a[32:35], a[144:147], 0
ds_read_b64_tr_b16 a[104:105], v6 offset:48000
ds_read_b64_tr_b16 a[106:107], v6 offset:52128
v_mfma_f32_16x16x32_bf16 v[64:67], a[36:39], a[148:151], v[64:67]
v_exp_f32 v72, v72
v_mfma_f32_16x16x32_bf16 v[64:67], a[40:43], a[152:155], v[64:67]
ds_read_b64_tr_b16 a[108:109], v6 offset:48008
v_lshlrev_b32 v13, 16, v28
v_mfma_f32_16x16x32_bf16 v[64:67], a[44:47], a[156:159], v[64:67]
v_exp_f32 v73, v73
v_mfma_f32_16x16x32_bf16 v[68:71], a[48:51], a[144:147], 0
ds_read_b64_tr_b16 a[110:111], v6 offset:52136
v_cvt_pk_bf16_f32 v84, v72, v73
v_mfma_f32_16x16x32_bf16 v[68:71], a[52:55], a[148:151], v[68:71]
v_exp_f32 v74, v74
v_mfma_f32_16x16x32_bf16 v[68:71], a[56:59], a[152:155], v[68:71]
ds_read_b64_tr_b16 a[112:113], v7 offset:48000
ds_read_b64_tr_b16 a[114:115], v7 offset:52128
v_mfma_f32_16x16x32_bf16 v[68:71], a[60:63], a[156:159], v[68:71]
v_exp_f32 v75, v75
v_mfma_f32_16x16x32_bf16 v[224:227], a[64:67], v[80:83], v[224:227]
v_cvt_pk_bf16_f32 v85, v74, v75
v_and_b32 v14, s35, v28
v_mfma_f32_16x16x32_bf16 v[228:231], a[68:71], v[80:83], v[228:231]
s_add_u32 s24, s20, 114688
v_exp_f32 v76, v76
v_mfma_f32_16x16x32_bf16 v[232:235], a[72:75], v[80:83], v[232:235]
s_addc_u32 s25, s21, 0
ds_read_b64_tr_b16 a[116:117], v7 offset:48008
ds_read_b64_tr_b16 a[118:119], v7 offset:52136
v_mfma_f32_16x16x32_bf16 v[236:239], a[76:79], v[80:83], v[236:239]
s_add_u32 m0, s29, 114688
v_exp_f32 v77, v77
v_mfma_f32_16x16x32_bf16 v[240:243], a[80:83], v[80:83], v[240:243]
ds_read_b64_tr_b16 a[120:121], v8 offset:48000
v_cvt_pk_bf16_f32 v86, v76, v77
v_mfma_f32_16x16x32_bf16 v[244:247], a[84:87], v[80:83], v[244:247]
v_exp_f32 v78, v78
v_mfma_f32_16x16x32_bf16 v[248:251], a[88:91], v[80:83], v[248:251]
global_load_lds_dwordx4 v9, s[24:25] offset:0
v_mfma_f32_16x16x32_bf16 v[252:255], a[92:95], v[80:83], v[252:255]
s_add_u32 m0, s29, 118784
ds_read_b64_tr_b16 a[122:123], v8 offset:52128
v_exp_f32 v79, v79
v_mfma_f32_16x16x32_bf16 a[224:227], a[228:231], v[80:83], a[224:227]
global_load_lds_dwordx4 v10, s[24:25] offset:0
v_mul_f32 v13, s34, v13
v_mfma_f32_16x16x32_bf16 v[72:75], a[32:35], a[160:163], 0
s_add_u32 s26, s22, 106496
ds_read_b64_tr_b16 a[124:125], v8 offset:48008
ds_read_b64_tr_b16 a[126:127], v8 offset:52136
v_cvt_pk_bf16_f32 v87, v78, v79
v_mfma_f32_16x16x32_bf16 v[72:75], a[36:39], a[164:167], v[72:75]
s_addc_u32 s27, s23, 0
v_exp_f32 v64, v64
v_mul_f32 v14, s34, v14
v_mfma_f32_16x16x32_bf16 v[72:75], a[40:43], a[168:171], v[72:75]
s_add_u32 m0, s30, 138048
v_cvt_pk_bf16_f32 v28, v13, v14
v_lshlrev_b32 v13, 16, v29
v_mfma_f32_16x16x32_bf16 v[72:75], a[44:47], a[172:175], v[72:75]
v_exp_f32 v65, v65
v_mfma_f32_16x16x32_bf16 v[76:79], a[48:51], a[160:163], 0
global_load_lds_dwordx4 v11, s[26:27] offset:0
v_cvt_pk_bf16_f32 v80, v64, v65
v_mfma_f32_16x16x32_bf16 v[76:79], a[52:55], a[164:167], v[76:79]
s_add_u32 m0, s30, 138056
v_exp_f32 v66, v66
v_mfma_f32_16x16x32_bf16 v[76:79], a[56:59], a[168:171], v[76:79]
global_load_lds_dwordx4 v11, s[26:27] offset:1024
v_mfma_f32_16x16x32_bf16 v[76:79], a[60:63], a[172:175], v[76:79]
s_waitcnt lgkmcnt(0)
v_exp_f32 v67, v67
v_and_b32 v14, s35, v29
v_mfma_f32_16x16x32_bf16 v[96:99], a[96:99], v[84:87], v[96:99]
v_cvt_pk_bf16_f32 v81, v66, v67
v_mul_f32 v13, s34, v13
v_mfma_f32_16x16x32_bf16 v[100:103], a[100:103], v[84:87], v[100:103]
v_exp_f32 v68, v68
v_mfma_f32_16x16x32_bf16 v[104:107], a[104:107], v[84:87], v[104:107]
v_mul_f32 v14, s34, v14
v_cvt_pk_bf16_f32 v29, v13, v14
v_mfma_f32_16x16x32_bf16 v[108:111], a[108:111], v[84:87], v[108:111]
v_exp_f32 v69, v69
v_mfma_f32_16x16x32_bf16 v[112:115], a[112:115], v[84:87], v[112:115]
v_cvt_pk_bf16_f32 v82, v68, v69
v_lshlrev_b32 v13, 16, v30
v_mfma_f32_16x16x32_bf16 v[116:119], a[116:119], v[84:87], v[116:119]
v_exp_f32 v70, v70
v_mfma_f32_16x16x32_bf16 v[120:123], a[120:123], v[84:87], v[120:123]
v_and_b32 v14, s35, v30
v_mul_f32 v13, s34, v13
v_mfma_f32_16x16x32_bf16 v[124:127], a[124:127], v[84:87], v[124:127]
v_exp_f32 v71, v71
v_mfma_f32_16x16x32_bf16 a[208:211], a[228:231], v[84:87], a[208:211]
v_cvt_pk_bf16_f32 v83, v70, v71
v_mul_f32 v14, s34, v14
v_mfma_f32_16x16x32_bf16 v[64:67], a[32:35], a[176:179], 0
v_cvt_pk_bf16_f32 v30, v13, v14
v_lshlrev_b32 v13, 16, v31
v_mfma_f32_16x16x32_bf16 v[64:67], a[36:39], a[180:183], v[64:67]
v_exp_f32 v72, v72
v_mfma_f32_16x16x32_bf16 v[64:67], a[40:43], a[184:187], v[64:67]
v_and_b32 v14, s35, v31
v_mul_f32 v13, s34, v13
v_mfma_f32_16x16x32_bf16 v[64:67], a[44:47], a[188:191], v[64:67]
v_exp_f32 v73, v73
v_mfma_f32_16x16x32_bf16 v[68:71], a[48:51], a[176:179], 0
v_cvt_pk_bf16_f32 v84, v72, v73
v_mul_f32 v14, s34, v14
v_mfma_f32_16x16x32_bf16 v[68:71], a[52:55], a[180:183], v[68:71]
v_exp_f32 v74, v74
v_mfma_f32_16x16x32_bf16 v[68:71], a[56:59], a[184:187], v[68:71]
ds_read_b128 a[0:3], v1 offset:32768
v_cvt_pk_bf16_f32 v31, v13, v14
v_mfma_f32_16x16x32_bf16 v[68:71], a[60:63], a[188:191], v[68:71]
v_exp_f32 v75, v75
v_mfma_f32_16x16x32_bf16 v[128:131], a[96:99], v[80:83], v[128:131]
ds_read_b128 a[4:7], v2 offset:32768
v_cvt_pk_bf16_f32 v85, v74, v75
v_mfma_f32_16x16x32_bf16 v[132:135], a[100:103], v[80:83], v[132:135]
v_exp_f32 v76, v76
v_mfma_f32_16x16x32_bf16 v[136:139], a[104:107], v[80:83], v[136:139]
ds_read_b128 a[8:11], v3 offset:32768
ds_read_b128 a[12:15], v4 offset:32768
v_mfma_f32_16x16x32_bf16 v[140:143], a[108:111], v[80:83], v[140:143]
v_exp_f32 v77, v77
v_mfma_f32_16x16x32_bf16 v[144:147], a[112:115], v[80:83], v[144:147]
ds_read_b128 a[16:19], v1 offset:36864
v_cvt_pk_bf16_f32 v86, v76, v77
v_mfma_f32_16x16x32_bf16 v[148:151], a[116:119], v[80:83], v[148:151]
v_exp_f32 v78, v78
v_mfma_f32_16x16x32_bf16 v[152:155], a[120:123], v[80:83], v[152:155]
ds_read_b128 a[20:23], v2 offset:36864
ds_read_b128 a[24:27], v3 offset:36864
v_mfma_f32_16x16x32_bf16 v[156:159], a[124:127], v[80:83], v[156:159]
v_exp_f32 v79, v79
v_mfma_f32_16x16x32_bf16 a[212:215], a[228:231], v[80:83], a[212:215]
ds_read_b128 a[28:31], v4 offset:36864
v_cvt_pk_bf16_f32 v87, v78, v79
v_mfma_f32_16x16x32_bf16 v[72:75], a[32:35], a[192:195], 0
v_mfma_f32_16x16x32_bf16 v[72:75], a[36:39], a[196:199], v[72:75]
v_exp_f32 v64, v64
v_mfma_f32_16x16x32_bf16 v[72:75], a[40:43], a[200:203], v[72:75]
v_mfma_f32_16x16x32_bf16 v[72:75], a[44:47], a[204:207], v[72:75]
v_exp_f32 v65, v65
v_mfma_f32_16x16x32_bf16 v[76:79], a[48:51], a[192:195], 0
v_cvt_pk_bf16_f32 v80, v64, v65
v_mfma_f32_16x16x32_bf16 v[76:79], a[52:55], a[196:199], v[76:79]
s_waitcnt vmcnt(4)
ds_write_b32 v0, v92
v_exp_f32 v66, v66
v_mfma_f32_16x16x32_bf16 v[76:79], a[56:59], a[200:203], v[76:79]
v_lshlrev_b32 v13, 16, v32
v_and_b32 v14, s35, v32
v_mfma_f32_16x16x32_bf16 v[76:79], a[60:63], a[204:207], v[76:79]
v_exp_f32 v67, v67
v_mfma_f32_16x16x32_bf16 v[160:163], a[96:99], v[84:87], v[160:163]
v_cvt_pk_bf16_f32 v81, v66, v67
v_mul_f32 v13, s34, v13
v_mfma_f32_16x16x32_bf16 v[164:167], a[100:103], v[84:87], v[164:167]
v_exp_f32 v68, v68
v_mfma_f32_16x16x32_bf16 v[168:171], a[104:107], v[84:87], v[168:171]
ds_read_b32 v93, v90
v_mul_f32 v14, s34, v14
v_mfma_f32_16x16x32_bf16 v[172:175], a[108:111], v[84:87], v[172:175]
v_exp_f32 v69, v69
v_mfma_f32_16x16x32_bf16 v[176:179], a[112:115], v[84:87], v[176:179]
v_cvt_pk_bf16_f32 v82, v68, v69
v_cvt_pk_bf16_f32 v32, v13, v14
v_mfma_f32_16x16x32_bf16 v[180:183], a[116:119], v[84:87], v[180:183]
v_exp_f32 v70, v70
v_mfma_f32_16x16x32_bf16 v[184:187], a[120:123], v[84:87], v[184:187]
v_lshlrev_b32 v13, 16, v33
v_and_b32 v14, s35, v33
v_mfma_f32_16x16x32_bf16 v[188:191], a[124:127], v[84:87], v[188:191]
v_exp_f32 v71, v71
v_mfma_f32_16x16x32_bf16 a[216:219], a[228:231], v[84:87], a[216:219]
s_waitcnt lgkmcnt(0)
v_cmp_gt_u32 vcc, v92, v93
v_cvt_pk_bf16_f32 v83, v70, v71
v_mfma_f32_16x16x32_bf16 v[64:67], a[0:3], a[128:131], 0
s_cbranch_vccnz L_r12
L_b12:
v_mul_f32 v13, s34, v13
v_add_u32 v92, 1, v92
v_mfma_f32_16x16x32_bf16 v[64:67], a[4:7], a[132:135], v[64:67]
v_exp_f32 v72, v72
v_mfma_f32_16x16x32_bf16 v[64:67], a[8:11], a[136:139], v[64:67]
v_mul_f32 v14, s34, v14
v_cvt_pk_bf16_f32 v33, v13, v14
v_mfma_f32_16x16x32_bf16 v[64:67], a[12:15], a[140:143], v[64:67]
v_exp_f32 v73, v73
v_mfma_f32_16x16x32_bf16 v[68:71], a[16:19], a[128:131], 0
v_cvt_pk_bf16_f32 v84, v72, v73
v_lshlrev_b32 v13, 16, v34
v_mfma_f32_16x16x32_bf16 v[68:71], a[20:23], a[132:135], v[68:71]
v_exp_f32 v74, v74
v_mfma_f32_16x16x32_bf16 v[68:71], a[24:27], a[136:139], v[68:71]
v_and_b32 v14, s35, v34
v_mul_f32 v13, s34, v13
v_mfma_f32_16x16x32_bf16 v[68:71], a[28:31], a[140:143], v[68:71]
v_exp_f32 v75, v75
v_mfma_f32_16x16x32_bf16 v[192:195], a[96:99], v[80:83], v[192:195]
v_cvt_pk_bf16_f32 v85, v74, v75
v_mul_f32 v14, s34, v14
v_mfma_f32_16x16x32_bf16 v[196:199], a[100:103], v[80:83], v[196:199]
v_exp_f32 v76, v76
v_mfma_f32_16x16x32_bf16 v[200:203], a[104:107], v[80:83], v[200:203]
v_cvt_pk_bf16_f32 v34, v13, v14
v_lshlrev_b32 v13, 16, v35
v_mfma_f32_16x16x32_bf16 v[204:207], a[108:111], v[80:83], v[204:207]
v_exp_f32 v77, v77
v_mfma_f32_16x16x32_bf16 v[208:211], a[112:115], v[80:83], v[208:211]
v_cvt_pk_bf16_f32 v86, v76, v77
v_and_b32 v14, s35, v35
v_mfma_f32_16x16x32_bf16 v[212:215], a[116:119], v[80:83], v[212:215]
v_exp_f32 v78, v78
v_mfma_f32_16x16x32_bf16 v[216:219], a[120:123], v[80:83], v[216:219]
ds_read_b64_tr_b16 a[64:65], v5 offset:56256
v_mul_f32 v13, s34, v13
v_mfma_f32_16x16x32_bf16 v[220:223], a[124:127], v[80:83], v[220:223]
v_exp_f32 v79, v79
v_mfma_f32_16x16x32_bf16 a[220:223], a[228:231], v[80:83], a[220:223]
ds_read_b64_tr_b16 a[66:67], v5 offset:60384
v_cvt_pk_bf16_f32 v87, v78, v79
v_mfma_f32_16x16x32_bf16 v[72:75], a[0:3], a[144:147], 0
ds_read_b64_tr_b16 a[68:69], v5 offset:56264
ds_read_b64_tr_b16 a[70:71], v5 offset:60392
v_mfma_f32_16x16x32_bf16 v[72:75], a[4:7], a[148:151], v[72:75]
v_exp_f32 v64, v64
v_mfma_f32_16x16x32_bf16 v[72:75], a[8:11], a[152:155], v[72:75]
ds_read_b64_tr_b16 a[72:73], v6 offset:56256
v_mul_f32 v14, s34, v14
v_mfma_f32_16x16x32_bf16 v[72:75], a[12:15], a[156:159], v[72:75]
v_exp_f32 v65, v65
v_mfma_f32_16x16x32_bf16 v[76:79], a[16:19], a[144:147], 0
ds_read_b64_tr_b16 a[74:75], v6 offset:60384
v_cvt_pk_bf16_f32 v80, v64, v65
v_mfma_f32_16x16x32_bf16 v[76:79], a[20:23], a[148:151], v[76:79]
v_exp_f32 v66, v66
v_mfma_f32_16x16x32_bf16 v[76:79], a[24:27], a[152:155], v[76:79]
ds_read_b64_tr_b16 a[76:77], v6 offset:56264
ds_read_b64_tr_b16 a[78:79], v6 offset:60392
v_mfma_f32_16x16x32_bf16 v[76:79], a[28:31], a[156:159], v[76:79]
v_exp_f32 v67, v67
v_mfma_f32_16x16x32_bf16 v[224:227], a[96:99], v[84:87], v[224:227]
v_cvt_pk_bf16_f32 v81, v66, v67
v_cvt_pk_bf16_f32 v35, v13, v14
v_mfma_f32_16x16x32_bf16 v[228:231], a[100:103], v[84:87], v[228:231]
s_add_u32 s24, s20, 122880
v_exp_f32 v68, v68
v_mfma_f32_16x16x32_bf16 v[232:235], a[104:107], v[84:87], v[232:235]
s_addc_u32 s25, s21, 0
ds_read_b64_tr_b16 a[80:81], v7 offset:56256
ds_read_b64_tr_b16 a[82:83], v7 offset:60384
v_mfma_f32_16x16x32_bf16 v[236:239], a[108:111], v[84:87], v[236:239]
s_add_u32 m0, s29, 122880
v_exp_f32 v69, v69
v_mfma_f32_16x16x32_bf16 v[240:243], a[112:115], v[84:87], v[240:243]
ds_read_b64_tr_b16 a[84:85], v7 offset:56264
v_cvt_pk_bf16_f32 v82, v68, v69
v_mfma_f32_16x16x32_bf16 v[244:247], a[116:119], v[84:87], v[244:247]
v_exp_f32 v70, v70
v_mfma_f32_16x16x32_bf16 v[248:251], a[120:123], v[84:87], v[248:251]
global_load_lds_dwordx4 v9, s[24:25] offset:0
ds_read_b64_tr_b16 a[86:87], v7 offset:60392
v_mfma_f32_16x16x32_bf16 v[252:255], a[124:127], v[84:87], v[252:255]
s_add_u32 m0, s29, 126976
v_exp_f32 v71, v71
v_lshlrev_b32 v13, 16, v36
v_mfma_f32_16x16x32_bf16 a[224:227], a[228:231], v[84:87], a[224:227]
global_load_lds_dwordx4 v10, s[24:25] offset:0
ds_read_b64_tr_b16 a[88:89], v8 offset:56256
v_mfma_f32_16x16x32_bf16 v[64:67], a[0:3], a[160:163], 0
s_add_u32 s26, s22, 114688
ds_read_b64_tr_b16 a[90:91], v8 offset:60384
ds_read_b64_tr_b16 a[92:93], v8 offset:56264
v_cvt_pk_bf16_f32 v83, v70, v71
v_mfma_f32_16x16x32_bf16 v[64:67], a[4:7], a[164:167], v[64:67]
s_addc_u32 s27, s23, 0
ds_read_b64_tr_b16 a[94:95], v8 offset:60392
v_exp_f32 v72, v72
v_mfma_f32_16x16x32_bf16 v[64:67], a[8:11], a[168:171], v[64:67]
s_add_u32 m0, s30, 146304
v_and_b32 v14, s35, v36
v_mul_f32 v13, s34, v13
v_mfma_f32_16x16x32_bf16 v[64:67], a[12:15], a[172:175], v[64:67]
v_exp_f32 v73, v73
v_mfma_f32_16x16x32_bf16 v[68:71], a[16:19], a[160:163], 0
global_load_lds_dwordx4 v11, s[26:27] offset:0
v_cvt_pk_bf16_f32 v84, v72, v73
v_mfma_f32_16x16x32_bf16 v[68:71], a[20:23], a[164:167], v[68:71]
s_add_u32 m0, s30, 146312
v_exp_f32 v74, v74
v_mul_f32 v14, s34, v14
v_mfma_f32_16x16x32_bf16 v[68:71], a[24:27], a[168:171], v[68:71]
global_load_lds_dwordx4 v11, s[26:27] offset:1024
v_cvt_pk_bf16_f32 v36, v13, v14
v_mfma_f32_16x16x32_bf16 v[68:71], a[28:31], a[172:175], v[68:71]
s_waitcnt lgkmcnt(0)
v_exp_f32 v75, v75
v_mfma_f32_16x16x32_bf16 v[96:99], a[64:67], v[80:83], v[96:99]
buffer_load_dwordx4 v[48:51], v12, s[12:15], s67 offen offset:0
v_cvt_pk_bf16_f32 v85, v74, v75
v_mfma_f32_16x16x32_bf16 v[100:103], a[68:71], v[80:83], v[100:103]
v_exp_f32 v76, v76
v_lshlrev_b32 v13, 16, v37
v_mfma_f32_16x16x32_bf16 v[104:107], a[72:75], v[80:83], v[104:107]
buffer_load_dwordx4 v[52:55], v12, s[12:15], s67 offen offset:64
v_and_b32 v14, s35, v37
v_mfma_f32_16x16x32_bf16 v[108:111], a[76:79], v[80:83], v[108:111]
v_exp_f32 v77, v77
v_mfma_f32_16x16x32_bf16 v[112:115], a[80:83], v[80:83], v[112:115]
buffer_load_dwordx4 v[56:59], v12, s[12:15], s67 offen offset:128
v_cvt_pk_bf16_f32 v86, v76, v77
v_mfma_f32_16x16x32_bf16 v[116:119], a[84:87], v[80:83], v[116:119]
v_exp_f32 v78, v78
v_mul_f32 v13, s34, v13
v_mfma_f32_16x16x32_bf16 v[120:123], a[88:91], v[80:83], v[120:123]
buffer_load_dwordx4 v[60:63], v12, s[12:15], s67 offen offset:192
v_mfma_f32_16x16x32_bf16 v[124:127], a[92:95], v[80:83], v[124:127]
v_exp_f32 v79, v79
v_mul_f32 v14, s34, v14
v_mfma_f32_16x16x32_bf16 a[208:211], a[228:231], v[80:83], a[208:211]
v_cvt_pk_bf16_f32 v87, v78, v79
v_cvt_pk_bf16_f32 v37, v13, v14
v_mfma_f32_16x16x32_bf16 v[72:75], a[0:3], a[176:179], 0
v_lshlrev_b32 v13, 16, v38
v_and_b32 v14, s35, v38
v_mfma_f32_16x16x32_bf16 v[72:75], a[4:7], a[180:183], v[72:75]
v_exp_f32 v64, v64
v_mfma_f32_16x16x32_bf16 v[72:75], a[8:11], a[184:187], v[72:75]
v_mul_f32 v13, s34, v13
v_mul_f32 v14, s34, v14
v_mfma_f32_16x16x32_bf16 v[72:75], a[12:15], a[188:191], v[72:75]
v_exp_f32 v65, v65
v_mfma_f32_16x16x32_bf16 v[76:79], a[16:19], a[176:179], 0
v_cvt_pk_bf16_f32 v80, v64, v65
v_cvt_pk_bf16_f32 v38, v13, v14
v_mfma_f32_16x16x32_bf16 v[76:79], a[20:23], a[180:183], v[76:79]
v_exp_f32 v66, v66
v_mfma_f32_16x16x32_bf16 v[76:79], a[24:27], a[184:187], v[76:79]
v_lshlrev_b32 v13, 16, v39
v_and_b32 v14, s35, v39
v_mfma_f32_16x16x32_bf16 v[76:79], a[28:31], a[188:191], v[76:79]
v_exp_f32 v67, v67
v_mfma_f32_16x16x32_bf16 v[128:131], a[64:67], v[84:87], v[128:131]
v_cvt_pk_bf16_f32 v81, v66, v67
v_mul_f32 v13, s34, v13
v_mfma_f32_16x16x32_bf16 v[132:135], a[68:71], v[84:87], v[132:135]
v_exp_f32 v68, v68
v_mfma_f32_16x16x32_bf16 v[136:139], a[72:75], v[84:87], v[136:139]
ds_read_b128 a[32:35], v1 offset:40960
v_mul_f32 v14, s34, v14
v_mfma_f32_16x16x32_bf16 v[140:143], a[76:79], v[84:87], v[140:143]
v_exp_f32 v69, v69
v_mfma_f32_16x16x32_bf16 v[144:147], a[80:83], v[84:87], v[144:147]
v_cvt_pk_bf16_f32 v82, v68, v69
v_cvt_pk_bf16_f32 v39, v13, v14
v_mfma_f32_16x16x32_bf16 v[148:151], a[84:87], v[84:87], v[148:151]
v_exp_f32 v70, v70
v_mfma_f32_16x16x32_bf16 v[152:155], a[88:91], v[84:87], v[152:155]
s_waitcnt vmcnt(8)
ds_write_b32 v0, v92
ds_read_b128 a[36:39], v2 offset:40960
v_mfma_f32_16x16x32_bf16 v[156:159], a[92:95], v[84:87], v[156:159]
v_exp_f32 v71, v71
v_mfma_f32_16x16x32_bf16 a[212:215], a[228:231], v[84:87], a[212:215]
ds_read_b128 a[40:43], v3 offset:40960
v_cvt_pk_bf16_f32 v83, v70, v71
v_mfma_f32_16x16x32_bf16 v[64:67], a[0:3], a[192:195], 0
ds_read_b128 a[44:47], v4 offset:40960
v_lshlrev_b32 v13, 16, v40
v_mfma_f32_16x16x32_bf16 v[64:67], a[4:7], a[196:199], v[64:67]
v_exp_f32 v72, v72
v_mfma_f32_16x16x32_bf16 v[64:67], a[8:11], a[200:203], v[64:67]
ds_read_b128 a[48:51], v1 offset:45056
v_and_b32 v14, s35, v40
v_mfma_f32_16x16x32_bf16 v[64:67], a[12:15], a[204:207], v[64:67]
v_exp_f32 v73, v73
v_mfma_f32_16x16x32_bf16 v[68:71], a[16:19], a[192:195], 0
ds_read_b128 a[52:55], v2 offset:45056
v_cvt_pk_bf16_f32 v84, v72, v73
v_mfma_f32_16x16x32_bf16 v[68:71], a[20:23], a[196:199], v[68:71]
v_exp_f32 v74, v74
v_mfma_f32_16x16x32_bf16 v[68:71], a[24:27], a[200:203], v[68:71]
ds_read_b128 a[56:59], v3 offset:45056
v_mul_f32 v13, s34, v13
v_mfma_f32_16x16x32_bf16 v[68:71], a[28:31], a[204:207], v[68:71]
v_exp_f32 v75, v75
v_mfma_f32_16x16x32_bf16 v[160:163], a[64:67], v[80:83], v[160:163]
ds_read_b128 a[60:63], v4 offset:45056
v_cvt_pk_bf16_f32 v85, v74, v75
v_mfma_f32_16x16x32_bf16 v[164:167], a[68:71], v[80:83], v[164:167]
v_exp_f32 v76, v76
v_mfma_f32_16x16x32_bf16 v[168:171], a[72:75], v[80:83], v[168:171]
ds_read_b32 v93, v90
v_mul_f32 v14, s34, v14
v_mfma_f32_16x16x32_bf16 v[172:175], a[76:79], v[80:83], v[172:175]
v_exp_f32 v77, v77
v_mfma_f32_16x16x32_bf16 v[176:179], a[80:83], v[80:83], v[176:179]
v_cvt_pk_bf16_f32 v86, v76, v77
v_cvt_pk_bf16_f32 v40, v13, v14
v_mfma_f32_16x16x32_bf16 v[180:183], a[84:87], v[80:83], v[180:183]
v_exp_f32 v78, v78
v_mfma_f32_16x16x32_bf16 v[184:187], a[88:91], v[80:83], v[184:187]
s_add_u32 s26, s22, 122880
v_lshlrev_b32 v13, 16, v41
v_and_b32 v14, s35, v41
v_mfma_f32_16x16x32_bf16 v[188:191], a[92:95], v[80:83], v[188:191]
s_addc_u32 s27, s23, 0
v_exp_f32 v79, v79
v_mfma_f32_16x16x32_bf16 a[216:219], a[228:231], v[80:83], a[216:219]
s_add_u32 m0, s30, 154560
s_waitcnt lgkmcnt(0)
v_cmp_gt_u32 vcc, v92, v93
v_cvt_pk_bf16_f32 v87, v78, v79
v_mfma_f32_16x16x32_bf16 v[72:75], a[32:35], a[128:131], 0
s_cbranch_vccnz L_r13
L_b13:
v_add_u32 v92, 1, v92
v_mul_f32 v13, s34, v13
v_mfma_f32_16x16x32_bf16 v[72:75], a[36:39], a[132:135], v[72:75]
v_exp_f32 v64, v64
v_mfma_f32_16x16x32_bf16 v[72:75], a[40:43], a[136:139], v[72:75]
global_load_lds_dwordx4 v11, s[26:27] offset:0
v_mfma_f32_16x16x32_bf16 v[72:75], a[44:47], a[140:143], v[72:75]
s_add_u32 m0, s30, 154568
v_exp_f32 v65, v65
v_mfma_f32_16x16x32_bf16 v[76:79], a[48:51], a[128:131], 0
global_load_lds_dwordx4 v11, s[26:27] offset:1024
v_cvt_pk_bf16_f32 v80, v64, v65
v_mfma_f32_16x16x32_bf16 v[76:79], a[52:55], a[132:135], v[76:79]
v_exp_f32 v66, v66
v_mfma_f32_16x16x32_bf16 v[76:79], a[56:59], a[136:139], v[76:79]
v_mul_f32 v14, s34, v14
v_cvt_pk_bf16_f32 v41, v13, v14
v_mfma_f32_16x16x32_bf16 v[76:79], a[60:63], a[140:143], v[76:79]
v_exp_f32 v67, v67
v_mfma_f32_16x16x32_bf16 v[192:195], a[64:67], v[84:87], v[192:195]
v_cvt_pk_bf16_f32 v81, v66, v67
v_lshlrev_b32 v13, 16, v42
v_mfma_f32_16x16x32_bf16 v[196:199], a[68:71], v[84:87], v[196:199]
v_exp_f32 v68, v68
v_mfma_f32_16x16x32_bf16 v[200:203], a[72:75], v[84:87], v[200:203]
v_and_b32 v14, s35, v42
v_mul_f32 v13, s34, v13
v_mfma_f32_16x16x32_bf16 v[204:207], a[76:79], v[84:87], v[204:207]
v_exp_f32 v69, v69
v_mfma_f32_16x16x32_bf16 v[208:211], a[80:83], v[84:87], v[208:211]
v_cvt_pk_bf16_f32 v82, v68, v69
v_mul_f32 v14, s34, v14
v_mfma_f32_16x16x32_bf16 v[212:215], a[84:87], v[84:87], v[212:215]
v_exp_f32 v70, v70
v_mfma_f32_16x16x32_bf16 v[216:219], a[88:91], v[84:87], v[216:219]
v_cvt_pk_bf16_f32 v42, v13, v14
v_lshlrev_b32 v13, 16, v43
v_mfma_f32_16x16x32_bf16 v[220:223], a[92:95], v[84:87], v[220:223]
v_exp_f32 v71, v71
v_mfma_f32_16x16x32_bf16 a[220:223], a[228:231], v[84:87], a[220:223]
v_cvt_pk_bf16_f32 v83, v70, v71
v_and_b32 v14, s35, v43
v_mfma_f32_16x16x32_bf16 v[64:67], a[32:35], a[144:147], 0
ds_read_b64_tr_b16 a[96:97], v5 offset:39744
ds_read_b64_tr_b16 a[98:99], v5 offset:43872
v_mfma_f32_16x16x32_bf16 v[64:67], a[36:39], a[148:151], v[64:67]
v_exp_f32 v72, v72
v_mfma_f32_16x16x32_bf16 v[64:67], a[40:43], a[152:155], v[64:67]
ds_read_b64_tr_b16 a[100:101], v5 offset:39752
ds_read_b64_tr_b16 a[102:103], v5 offset:43880
v_mfma_f32_16x16x32_bf16 v[64:67], a[44:47], a[156:159], v[64:67]
v_exp_f32 v73, v73
v_mfma_f32_16x16x32_bf16 v[68:71], a[48:51], a[144:147], 0
v_cvt_pk_bf16_f32 v84, v72, v73
v_mul_f32 v13, s34, v13
v_mfma_f32_16x16x32_bf16 v[68:71], a[52:55], a[148:151], v[68:71]
v_exp_f32 v74, v74
v_mfma_f32_16x16x32_bf16 v[68:71], a[56:59], a[152:155], v[68:71]
ds_read_b64_tr_b16 a[104:105], v6 offset:39744
ds_read_b64_tr_b16 a[106:107], v6 offset:43872
v_mfma_f32_16x16x32_bf16 v[68:71], a[60:63], a[156:159], v[68:71]
v_exp_f32 v75, v75
v_mfma_f32_16x16x32_bf16 v[224:227], a[64:67], v[80:83], v[224:227]
ds_read_b64_tr_b16 a[108:109], v6 offset:39752
v_cvt_pk_bf16_f32 v85, v74, v75
v_mfma_f32_16x16x32_bf16 v[228:231], a[68:71], v[80:83], v[228:231]
v_exp_f32 v76, v76
v_mfma_f32_16x16x32_bf16 v[232:235], a[72:75], v[80:83], v[232:235]
ds_read_b64_tr_b16 a[110:111], v6 offset:43880
v_mul_f32 v14, s34, v14
v_mfma_f32_16x16x32_bf16 v[236:239], a[76:79], v[80:83], v[236:239]
v_exp_f32 v77, v77
v_mfma_f32_16x16x32_bf16 v[240:243], a[80:83], v[80:83], v[240:243]
ds_read_b64_tr_b16 a[112:113], v7 offset:39744
v_cvt_pk_bf16_f32 v86, v76, v77
v_mfma_f32_16x16x32_bf16 v[244:247], a[84:87], v[80:83], v[244:247]
ds_read_b64_tr_b16 a[114:115], v7 offset:43872
v_exp_f32 v78, v78
v_mfma_f32_16x16x32_bf16 v[248:251], a[88:91], v[80:83], v[248:251]
ds_read_b64_tr_b16 a[116:117], v7 offset:39752
ds_read_b64_tr_b16 a[118:119], v7 offset:43880
v_mfma_f32_16x16x32_bf16 v[252:255], a[92:95], v[80:83], v[252:255]
ds_read_b64_tr_b16 a[120:121], v8 offset:39744
v_exp_f32 v79, v79
v_mfma_f32_16x16x32_bf16 a[224:227], a[228:231], v[80:83], a[224:227]
ds_read_b64_tr_b16 a[122:123], v8 offset:43872
v_cvt_pk_bf16_f32 v43, v13, v14
v_cvt_pk_bf16_f32 v87, v78, v79
v_mfma_f32_16x16x32_bf16 v[72:75], a[32:35], a[160:163], 0
ds_read_b64_tr_b16 a[124:125], v8 offset:39752
ds_read_b64_tr_b16 a[126:127], v8 offset:43880
v_lshlrev_b32 v13, 16, v44
v_mfma_f32_16x16x32_bf16 v[72:75], a[36:39], a[164:167], v[72:75]
v_exp_f32 v64, v64
v_mfma_f32_16x16x32_bf16 v[72:75], a[40:43], a[168:171], v[72:75]
v_and_b32 v14, s35, v44
v_mul_f32 v13, s34, v13
v_mfma_f32_16x16x32_bf16 v[72:75], a[44:47], a[172:175], v[72:75]
v_exp_f32 v65, v65
v_mfma_f32_16x16x32_bf16 v[76:79], a[48:51], a[160:163], 0
v_cvt_pk_bf16_f32 v80, v64, v65
v_mul_f32 v14, s34, v14
v_mfma_f32_16x16x32_bf16 v[76:79], a[52:55], a[164:167], v[76:79]
v_exp_f32 v66, v66
v_mfma_f32_16x16x32_bf16 v[76:79], a[56:59], a[168:171], v[76:79]
v_cvt_pk_bf16_f32 v44, v13, v14
v_lshlrev_b32 v13, 16, v45
v_mfma_f32_16x16x32_bf16 v[76:79], a[60:63], a[172:175], v[76:79]
s_waitcnt lgkmcnt(0)
v_exp_f32 v67, v67
v_mfma_f32_16x16x32_bf16 v[96:99], a[96:99], v[84:87], v[96:99]
v_cvt_pk_bf16_f32 v81, v66, v67
v_and_b32 v14, s35, v45
v_mfma_f32_16x16x32_bf16 v[100:103], a[100:103], v[84:87], v[100:103]
v_exp_f32 v68, v68
v_mfma_f32_16x16x32_bf16 v[104:107], a[104:107], v[84:87], v[104:107]
v_mul_f32 v13, s34, v13
v_mul_f32 v14, s34, v14
v_mfma_f32_16x16x32_bf16 v[108:111], a[108:111], v[84:87], v[108:111]
v_exp_f32 v69, v69
v_mfma_f32_16x16x32_bf16 v[112:115], a[112:115], v[84:87], v[112:115]
v_cvt_pk_bf16_f32 v82, v68, v69
v_cvt_pk_bf16_f32 v45, v13, v14
v_mfma_f32_16x16x32_bf16 v[116:119], a[116:119], v[84:87], v[116:119]
v_exp_f32 v70, v70
v_mfma_f32_16x16x32_bf16 v[120:123], a[120:123], v[84:87], v[120:123]
v_lshlrev_b32 v13, 16, v46
v_and_b32 v14, s35, v46
v_mfma_f32_16x16x32_bf16 v[124:127], a[124:127], v[84:87], v[124:127]
v_exp_f32 v71, v71
v_mfma_f32_16x16x32_bf16 a[208:211], a[228:231], v[84:87], a[208:211]
v_cvt_pk_bf16_f32 v83, v70, v71
v_mul_f32 v13, s34, v13
v_mfma_f32_16x16x32_bf16 v[64:67], a[32:35], a[176:179], 0
v_mul_f32 v14, s34, v14
v_cvt_pk_bf16_f32 v46, v13, v14
v_mfma_f32_16x16x32_bf16 v[64:67], a[36:39], a[180:183], v[64:67]
v_exp_f32 v72, v72
v_mfma_f32_16x16x32_bf16 v[64:67], a[40:43], a[184:187], v[64:67]
v_lshlrev_b32 v13, 16, v47
v_and_b32 v14, s35, v47
v_mfma_f32_16x16x32_bf16 v[64:67], a[44:47], a[188:191], v[64:67]
v_exp_f32 v73, v73
v_mfma_f32_16x16x32_bf16 v[68:71], a[48:51], a[176:179], 0
v_cvt_pk_bf16_f32 v84, v72, v73
v_mul_f32 v13, s34, v13
v_mfma_f32_16x16x32_bf16 v[68:71], a[52:55], a[180:183], v[68:71]
v_exp_f32 v74, v74
v_mfma_f32_16x16x32_bf16 v[68:71], a[56:59], a[184:187], v[68:71]
ds_read_b128 a[0:3], v1 offset:49152
v_mul_f32 v14, s34, v14
v_mfma_f32_16x16x32_bf16 v[68:71], a[60:63], a[188:191], v[68:71]
v_exp_f32 v75, v75
v_mfma_f32_16x16x32_bf16 v[128:131], a[96:99], v[80:83], v[128:131]
ds_read_b128 a[4:7], v2 offset:49152
v_cvt_pk_bf16_f32 v85, v74, v75
v_mfma_f32_16x16x32_bf16 v[132:135], a[100:103], v[80:83], v[132:135]
v_exp_f32 v76, v76
v_mfma_f32_16x16x32_bf16 v[136:139], a[104:107], v[80:83], v[136:139]
ds_read_b128 a[8:11], v3 offset:49152
v_cvt_pk_bf16_f32 v47, v13, v14
v_mfma_f32_16x16x32_bf16 v[140:143], a[108:111], v[80:83], v[140:143]
v_exp_f32 v77, v77
v_mfma_f32_16x16x32_bf16 v[144:147], a[112:115], v[80:83], v[144:147]
ds_read_b128 a[12:15], v4 offset:49152
v_cvt_pk_bf16_f32 v86, v76, v77
v_mfma_f32_16x16x32_bf16 v[148:151], a[116:119], v[80:83], v[148:151]
v_exp_f32 v78, v78
v_mfma_f32_16x16x32_bf16 v[152:155], a[120:123], v[80:83], v[152:155]
s_waitcnt vmcnt(6)
ds_write_b32 v0, v92
ds_read_b128 a[16:19], v1 offset:53248
v_mfma_f32_16x16x32_bf16 v[156:159], a[124:127], v[80:83], v[156:159]
v_exp_f32 v79, v79
v_mfma_f32_16x16x32_bf16 a[212:215], a[228:231], v[80:83], a[212:215]
ds_read_b128 a[20:23], v2 offset:53248
v_cvt_pk_bf16_f32 v87, v78, v79
v_mfma_f32_16x16x32_bf16 v[72:75], a[32:35], a[192:195], 0
ds_read_b128 a[24:27], v3 offset:53248
ds_read_b128 a[28:31], v4 offset:53248
v_mfma_f32_16x16x32_bf16 v[72:75], a[36:39], a[196:199], v[72:75]
v_exp_f32 v64, v64
v_mfma_f32_16x16x32_bf16 v[72:75], a[40:43], a[200:203], v[72:75]
v_mfma_f32_16x16x32_bf16 v[72:75], a[44:47], a[204:207], v[72:75]
v_exp_f32 v65, v65
v_mfma_f32_16x16x32_bf16 v[76:79], a[48:51], a[192:195], 0
v_cvt_pk_bf16_f32 v80, v64, v65
v_mfma_f32_16x16x32_bf16 v[76:79], a[52:55], a[196:199], v[76:79]
v_exp_f32 v66, v66
v_mfma_f32_16x16x32_bf16 v[76:79], a[56:59], a[200:203], v[76:79]
v_mfma_f32_16x16x32_bf16 v[76:79], a[60:63], a[204:207], v[76:79]
v_exp_f32 v67, v67
v_add_co_u32 v94, s[86:87], s88, v94
v_mfma_f32_16x16x32_bf16 v[160:163], a[96:99], v[84:87], v[160:163]
s_nop 0
v_cvt_pk_bf16_f32 v81, v66, v67
v_addc_co_u32 v95, s[86:87], 0, v95, s[86:87]
v_mfma_f32_16x16x32_bf16 v[164:167], a[100:103], v[84:87], v[164:167]
v_exp_f32 v68, v68
v_mfma_f32_16x16x32_bf16 v[168:171], a[104:107], v[84:87], v[168:171]
ds_read_b32 v93, v90
v_mfma_f32_16x16x32_bf16 v[172:175], a[108:111], v[84:87], v[172:175]
v_exp_f32 v69, v69
s_waitcnt vmcnt(5)
v_lshlrev_b32 v13, 16, v48
v_mfma_f32_16x16x32_bf16 v[176:179], a[112:115], v[84:87], v[176:179]
v_cvt_pk_bf16_f32 v82, v68, v69
v_and_b32 v14, s35, v48
v_mfma_f32_16x16x32_bf16 v[180:183], a[116:119], v[84:87], v[180:183]
v_exp_f32 v70, v70
v_mfma_f32_16x16x32_bf16 v[184:187], a[120:123], v[84:87], v[184:187]
s_add_u32 s26, s22, 0
v_mul_f32 v13, s34, v13
v_mul_f32 v14, s34, v14
v_mfma_f32_16x16x32_bf16 v[188:191], a[124:127], v[84:87], v[188:191]
s_addc_u32 s27, s23, 0
v_exp_f32 v71, v71
v_mfma_f32_16x16x32_bf16 a[216:219], a[228:231], v[84:87], a[216:219]
s_add_u32 m0, s30, 138048
s_waitcnt lgkmcnt(0)
v_cmp_gt_u32 vcc, v92, v93
v_cvt_pk_bf16_f32 v83, v70, v71
v_mfma_f32_16x16x32_bf16 v[64:67], a[0:3], a[128:131], 0
s_cbranch_vccnz L_r14
L_b14:
v_cvt_pk_bf16_f32 v48, v13, v14
v_add_u32 v92, 1, v92
v_mfma_f32_16x16x32_bf16 v[64:67], a[4:7], a[132:135], v[64:67]
v_exp_f32 v72, v72
v_mfma_f32_16x16x32_bf16 v[64:67], a[8:11], a[136:139], v[64:67]
global_load_lds_dwordx4 v11, s[26:27] offset:0
v_mfma_f32_16x16x32_bf16 v[64:67], a[12:15], a[140:143], v[64:67]
s_add_u32 m0, s30, 138056
v_exp_f32 v73, v73
v_mfma_f32_16x16x32_bf16 v[68:71], a[16:19], a[128:131], 0
global_load_lds_dwordx4 v11, s[26:27] offset:1024
v_cvt_pk_bf16_f32 v84, v72, v73
v_mfma_f32_16x16x32_bf16 v[68:71], a[20:23], a[132:135], v[68:71]
s_add_u32 s26, s22, 8192
v_exp_f32 v74, v74
v_lshlrev_b32 v13, 16, v49
v_mfma_f32_16x16x32_bf16 v[68:71], a[24:27], a[136:139], v[68:71]
s_addc_u32 s27, s23, 0
global_load_ubyte a232, v[94:95], off
v_mfma_f32_16x16x32_bf16 v[68:71], a[28:31], a[140:143], v[68:71]
s_add_u32 m0, s30, 105024
v_exp_f32 v75, v75
v_and_b32 v14, s35, v49
v_mfma_f32_16x16x32_bf16 v[192:195], a[96:99], v[80:83], v[192:195]
global_load_lds_dwordx4 v11, s[26:27] offset:0
v_cvt_pk_bf16_f32 v85, v74, v75
v_mfma_f32_16x16x32_bf16 v[196:199], a[100:103], v[80:83], v[196:199]
s_add_u32 m0, s30, 105032
v_exp_f32 v76, v76
v_mul_f32 v13, s34, v13
v_mfma_f32_16x16x32_bf16 v[200:203], a[104:107], v[80:83], v[200:203]
global_load_lds_dwordx4 v11, s[26:27] offset:1024
v_mfma_f32_16x16x32_bf16 v[204:207], a[108:111], v[80:83], v[204:207]
v_exp_f32 v77, v77
v_mul_f32 v14, s34, v14
v_mfma_f32_16x16x32_bf16 v[208:211], a[112:115], v[80:83], v[208:211]
v_cvt_pk_bf16_f32 v86, v76, v77
v_cvt_pk_bf16_f32 v49, v13, v14
v_mfma_f32_16x16x32_bf16 v[212:215], a[116:119], v[80:83], v[212:215]
v_exp_f32 v78, v78
v_mfma_f32_16x16x32_bf16 v[216:219], a[120:123], v[80:83], v[216:219]
v_lshlrev_b32 v13, 16, v50
v_and_b32 v14, s35, v50
v_mfma_f32_16x16x32_bf16 v[220:223], a[124:127], v[80:83], v[220:223]
v_exp_f32 v79, v79
v_mfma_f32_16x16x32_bf16 a[220:223], a[228:231], v[80:83], a[220:223]
v_cvt_pk_bf16_f32 v87, v78, v79
v_mul_f32 v13, s34, v13
v_mfma_f32_16x16x32_bf16 v[72:75], a[0:3], a[144:147], 0
v_mul_f32 v14, s34, v14
v_cvt_pk_bf16_f32 v50, v13, v14
v_mfma_f32_16x16x32_bf16 v[72:75], a[4:7], a[148:151], v[72:75]
v_exp_f32 v64, v64
v_mfma_f32_16x16x32_bf16 v[72:75], a[8:11], a[152:155], v[72:75]
ds_read_b64_tr_b16 a[64:65], v5 offset:48000
ds_read_b64_tr_b16 a[66:67], v5 offset:52128
v_mfma_f32_16x16x32_bf16 v[72:75], a[12:15], a[156:159], v[72:75]
v_exp_f32 v65, v65
v_mfma_f32_16x16x32_bf16 v[76:79], a[16:19], a[144:147], 0
ds_read_b64_tr_b16 a[68:69], v5 offset:48008
v_cvt_pk_bf16_f32 v80, v64, v65
v_mfma_f32_16x16x32_bf16 v[76:79], a[20:23], a[148:151], v[76:79]
v_exp_f32 v66, v66
v_mfma_f32_16x16x32_bf16 v[76:79], a[24:27], a[152:155], v[76:79]
ds_read_b64_tr_b16 a[70:71], v5 offset:52136
v_lshlrev_b32 v13, 16, v51
v_mfma_f32_16x16x32_bf16 v[76:79], a[28:31], a[156:159], v[76:79]
v_exp_f32 v67, v67
v_mfma_f32_16x16x32_bf16 v[224:227], a[96:99], v[84:87], v[224:227]
ds_read_b64_tr_b16 a[72:73], v6 offset:48000
v_cvt_pk_bf16_f32 v81, v66, v67
v_mfma_f32_16x16x32_bf16 v[228:231], a[100:103], v[84:87], v[228:231]
v_exp_f32 v68, v68
v_mfma_f32_16x16x32_bf16 v[232:235], a[104:107], v[84:87], v[232:235]
ds_read_b64_tr_b16 a[74:75], v6 offset:52128
ds_read_b64_tr_b16 a[76:77], v6 offset:48008
v_mfma_f32_16x16x32_bf16 v[236:239], a[108:111], v[84:87], v[236:239]
v_exp_f32 v69, v69
v_mfma_f32_16x16x32_bf16 v[240:243], a[112:115], v[84:87], v[240:243]
ds_read_b64_tr_b16 a[78:79], v6 offset:52136
v_cvt_pk_bf16_f32 v82, v68, v69
v_and_b32 v14, s35, v51
v_mfma_f32_16x16x32_bf16 v[244:247], a[116:119], v[84:87], v[244:247]
ds_read_b64_tr_b16 a[80:81], v7 offset:48000
v_exp_f32 v70, v70
v_mfma_f32_16x16x32_bf16 v[248:251], a[120:123], v[84:87], v[248:251]
ds_read_b64_tr_b16 a[82:83], v7 offset:52128
ds_read_b64_tr_b16 a[84:85], v7 offset:48008
v_mul_f32 v13, s34, v13
v_mfma_f32_16x16x32_bf16 v[252:255], a[124:127], v[84:87], v[252:255]
ds_read_b64_tr_b16 a[86:87], v7 offset:52136
v_exp_f32 v71, v71
v_mfma_f32_16x16x32_bf16 a[224:227], a[228:231], v[84:87], a[224:227]
ds_read_b64_tr_b16 a[88:89], v8 offset:48000
ds_read_b64_tr_b16 a[90:91], v8 offset:52128
v_cvt_pk_bf16_f32 v83, v70, v71
v_mfma_f32_16x16x32_bf16 v[64:67], a[0:3], a[160:163], 0
ds_read_b64_tr_b16 a[92:93], v8 offset:48008
ds_read_b64_tr_b16 a[94:95], v8 offset:52136
v_mul_f32 v14, s34, v14
v_mfma_f32_16x16x32_bf16 v[64:67], a[4:7], a[164:167], v[64:67]
v_exp_f32 v72, v72
v_cvt_pk_bf16_f32 v51, v13, v14
v_mfma_f32_16x16x32_bf16 v[64:67], a[8:11], a[168:171], v[64:67]
s_waitcnt vmcnt(9)
v_lshlrev_b32 v13, 16, v52
v_and_b32 v14, s35, v52
v_mfma_f32_16x16x32_bf16 v[64:67], a[12:15], a[172:175], v[64:67]
v_exp_f32 v73, v73
v_mfma_f32_16x16x32_bf16 v[68:71], a[16:19], a[160:163], 0
v_cvt_pk_bf16_f32 v84, v72, v73
v_mul_f32 v13, s34, v13
v_mfma_f32_16x16x32_bf16 v[68:71], a[20:23], a[164:167], v[68:71]
v_exp_f32 v74, v74
v_mfma_f32_16x16x32_bf16 v[68:71], a[24:27], a[168:171], v[68:71]
v_mul_f32 v14, s34, v14
v_cvt_pk_bf16_f32 v52, v13, v14
v_mfma_f32_16x16x32_bf16 v[68:71], a[28:31], a[172:175], v[68:71]
s_waitcnt lgkmcnt(0)
v_exp_f32 v75, v75
v_mfma_f32_16x16x32_bf16 v[96:99], a[64:67], v[80:83], v[96:99]
v_cvt_pk_bf16_f32 v85, v74, v75
v_lshlrev_b32 v13, 16, v53
v_mfma_f32_16x16x32_bf16 v[100:103], a[68:71], v[80:83], v[100:103]
v_exp_f32 v76, v76
v_mfma_f32_16x16x32_bf16 v[104:107], a[72:75], v[80:83], v[104:107]
v_and_b32 v14, s35, v53
v_mul_f32 v13, s34, v13
v_mfma_f32_16x16x32_bf16 v[108:111], a[76:79], v[80:83], v[108:111]
v_exp_f32 v77, v77
v_mfma_f32_16x16x32_bf16 v[112:115], a[80:83], v[80:83], v[112:115]
v_cvt_pk_bf16_f32 v86, v76, v77
v_mul_f32 v14, s34, v14
v_mfma_f32_16x16x32_bf16 v[116:119], a[84:87], v[80:83], v[116:119]
v_exp_f32 v78, v78
v_mfma_f32_16x16x32_bf16 v[120:123], a[88:91], v[80:83], v[120:123]
v_cvt_pk_bf16_f32 v53, v13, v14
v_lshlrev_b32 v13, 16, v54
v_mfma_f32_16x16x32_bf16 v[124:127], a[92:95], v[80:83], v[124:127]
v_exp_f32 v79, v79
v_mfma_f32_16x16x32_bf16 a[208:211], a[228:231], v[80:83], a[208:211]
v_cvt_pk_bf16_f32 v87, v78, v79
v_and_b32 v14, s35, v54
v_mfma_f32_16x16x32_bf16 v[72:75], a[0:3], a[176:179], 0
v_mul_f32 v13, s34, v13
v_mul_f32 v14, s34, v14
v_mfma_f32_16x16x32_bf16 v[72:75], a[4:7], a[180:183], v[72:75]
v_exp_f32 v64, v64
v_mfma_f32_16x16x32_bf16 v[72:75], a[8:11], a[184:187], v[72:75]
v_cvt_pk_bf16_f32 v54, v13, v14
v_lshlrev_b32 v13, 16, v55
v_mfma_f32_16x16x32_bf16 v[72:75], a[12:15], a[188:191], v[72:75]
v_exp_f32 v65, v65
v_mfma_f32_16x16x32_bf16 v[76:79], a[16:19], a[176:179], 0
ds_read_b128 a[32:35], v1 offset:57344
v_cvt_pk_bf16_f32 v80, v64, v65
v_mfma_f32_16x16x32_bf16 v[76:79], a[20:23], a[180:183], v[76:79]
v_exp_f32 v66, v66
v_mfma_f32_16x16x32_bf16 v[76:79], a[24:27], a[184:187], v[76:79]
ds_read_b128 a[36:39], v2 offset:57344
v_and_b32 v14, s35, v55
v_mfma_f32_16x16x32_bf16 v[76:79], a[28:31], a[188:191], v[76:79]
v_exp_f32 v67, v67
v_mfma_f32_16x16x32_bf16 v[128:131], a[64:67], v[84:87], v[128:131]
ds_read_b128 a[40:43], v3 offset:57344
v_cvt_pk_bf16_f32 v81, v66, v67
v_mfma_f32_16x16x32_bf16 v[132:135], a[68:71], v[84:87], v[132:135]
v_exp_f32 v68, v68
v_mfma_f32_16x16x32_bf16 v[136:139], a[72:75], v[84:87], v[136:139]
ds_read_b128 a[44:47], v4 offset:57344
v_mul_f32 v13, s34, v13
v_mfma_f32_16x16x32_bf16 v[140:143], a[76:79], v[84:87], v[140:143]
v_exp_f32 v69, v69
v_mfma_f32_16x16x32_bf16 v[144:147], a[80:83], v[84:87], v[144:147]
ds_read_b128 a[48:51], v1 offset:61440
v_cvt_pk_bf16_f32 v82, v68, v69
v_mfma_f32_16x16x32_bf16 v[148:151], a[84:87], v[84:87], v[148:151]
v_exp_f32 v70, v70
v_mfma_f32_16x16x32_bf16 v[152:155], a[88:91], v[84:87], v[152:155]
s_waitcnt vmcnt(5)
ds_write_b32 v0, v92
v_mul_f32 v14, s34, v14
v_mfma_f32_16x16x32_bf16 v[156:159], a[92:95], v[84:87], v[156:159]
v_exp_f32 v71, v71
v_mfma_f32_16x16x32_bf16 a[212:215], a[228:231], v[84:87], a[212:215]
ds_read_b128 a[52:55], v2 offset:61440
v_cvt_pk_bf16_f32 v83, v70, v71
v_mfma_f32_16x16x32_bf16 v[64:67], a[0:3], a[192:195], 0
ds_read_b128 a[56:59], v3 offset:61440
v_cvt_pk_bf16_f32 v55, v13, v14
v_mfma_f32_16x16x32_bf16 v[64:67], a[4:7], a[196:199], v[64:67]
v_exp_f32 v72, v72
v_mfma_f32_16x16x32_bf16 v[64:67], a[8:11], a[200:203], v[64:67]
ds_read_b128 a[60:63], v4 offset:61440
v_xor_b32 v1, 0x10000, v1
v_xor_b32 v2, 0x10000, v2
v_mfma_f32_16x16x32_bf16 v[64:67], a[12:15], a[204:207], v[64:67]
v_exp_f32 v73, v73
v_xor_b32 v3, 0x10000, v3
v_mfma_f32_16x16x32_bf16 v[68:71], a[16:19], a[192:195], 0
v_xor_b32 v4, 0x10000, v4
v_cvt_pk_bf16_f32 v84, v72, v73
v_mfma_f32_16x16x32_bf16 v[68:71], a[20:23], a[196:199], v[68:71]
v_exp_f32 v74, v74
v_mfma_f32_16x16x32_bf16 v[68:71], a[24:27], a[200:203], v[68:71]
v_lshlrev_b32 v13, 16, v56
v_and_b32 v14, s35, v56
v_mfma_f32_16x16x32_bf16 v[68:71], a[28:31], a[204:207], v[68:71]
v_exp_f32 v75, v75
v_mfma_f32_16x16x32_bf16 v[160:163], a[64:67], v[80:83], v[160:163]
v_cvt_pk_bf16_f32 v85, v74, v75
v_mul_f32 v13, s34, v13
v_mfma_f32_16x16x32_bf16 v[164:167], a[68:71], v[80:83], v[164:167]
v_exp_f32 v76, v76
v_mfma_f32_16x16x32_bf16 v[168:171], a[72:75], v[80:83], v[168:171]
ds_read_b32 v93, v90
v_mul_f32 v14, s34, v14
v_mfma_f32_16x16x32_bf16 v[172:175], a[76:79], v[80:83], v[172:175]
v_exp_f32 v77, v77
v_mfma_f32_16x16x32_bf16 v[176:179], a[80:83], v[80:83], v[176:179]
v_cvt_pk_bf16_f32 v86, v76, v77
v_cvt_pk_bf16_f32 v56, v13, v14
v_mfma_f32_16x16x32_bf16 v[180:183], a[84:87], v[80:83], v[180:183]
v_exp_f32 v78, v78
v_mfma_f32_16x16x32_bf16 v[184:187], a[88:91], v[80:83], v[184:187]
s_add_u32 s26, s22, 16384
v_lshlrev_b32 v13, 16, v57
v_and_b32 v14, s35, v57
v_mfma_f32_16x16x32_bf16 v[188:191], a[92:95], v[80:83], v[188:191]
s_addc_u32 s27, s23, 0
v_exp_f32 v79, v79
v_mfma_f32_16x16x32_bf16 a[216:219], a[228:231], v[80:83], a[216:219]
s_add_u32 m0, s30, 146304
s_waitcnt lgkmcnt(0)
v_cmp_gt_u32 vcc, v92, v93
v_cvt_pk_bf16_f32 v87, v78, v79
v_mfma_f32_16x16x32_bf16 v[72:75], a[32:35], a[128:131], 0
s_cbranch_vccnz L_r15
L_b15:
v_add_u32 v92, 1, v92
v_mul_f32 v13, s34, v13
v_mfma_f32_16x16x32_bf16 v[72:75], a[36:39], a[132:135], v[72:75]
v_exp_f32 v64, v64
v_mfma_f32_16x16x32_bf16 v[72:75], a[40:43], a[136:139], v[72:75]
global_load_lds_dwordx4 v11, s[26:27] offset:0
v_mfma_f32_16x16x32_bf16 v[72:75], a[44:47], a[140:143], v[72:75]
v_exp_f32 v65, v65
v_mfma_f32_16x16x32_bf16 v[76:79], a[48:51], a[128:131], 0
v_cvt_pk_bf16_f32 v80, v64, v65
v_mul_f32 v14, s34, v14
v_mfma_f32_16x16x32_bf16 v[76:79], a[52:55], a[132:135], v[76:79]
s_add_u32 m0, s30, 146312
v_exp_f32 v66, v66
v_mfma_f32_16x16x32_bf16 v[76:79], a[56:59], a[136:139], v[76:79]
v_cvt_pk_bf16_f32 v57, v13, v14
v_lshlrev_b32 v13, 16, v58
v_mfma_f32_16x16x32_bf16 v[76:79], a[60:63], a[140:143], v[76:79]
v_exp_f32 v67, v67
v_mfma_f32_16x16x32_bf16 v[192:195], a[64:67], v[84:87], v[192:195]
v_cvt_pk_bf16_f32 v81, v66, v67
v_and_b32 v14, s35, v58
v_mfma_f32_16x16x32_bf16 v[196:199], a[68:71], v[84:87], v[196:199]
v_exp_f32 v68, v68
v_mfma_f32_16x16x32_bf16 v[200:203], a[72:75], v[84:87], v[200:203]
global_load_lds_dwordx4 v11, s[26:27] offset:1024
v_mfma_f32_16x16x32_bf16 v[204:207], a[76:79], v[84:87], v[204:207]
v_exp_f32 v69, v69
v_mfma_f32_16x16x32_bf16 v[208:211], a[80:83], v[84:87], v[208:211]
v_cvt_pk_bf16_f32 v82, v68, v69
v_mul_f32 v13, s34, v13
v_mfma_f32_16x16x32_bf16 v[212:215], a[84:87], v[84:87], v[212:215]
s_add_u32 s26, s22, 24576
v_exp_f32 v70, v70
v_mfma_f32_16x16x32_bf16 v[216:219], a[88:91], v[84:87], v[216:219]
s_addc_u32 s27, s23, 0
ds_read_b64_tr_b16 a[96:97], v5 offset:56256
v_mul_f32 v14, s34, v14
v_mfma_f32_16x16x32_bf16 v[220:223], a[92:95], v[84:87], v[220:223]
s_add_u32 m0, s30, 113280
v_exp_f32 v71, v71
v_mfma_f32_16x16x32_bf16 a[220:223], a[228:231], v[84:87], a[220:223]
ds_read_b64_tr_b16 a[98:99], v5 offset:60384
v_cvt_pk_bf16_f32 v83, v70, v71
v_mfma_f32_16x16x32_bf16 v[64:67], a[32:35], a[144:147], 0
global_load_lds_dwordx4 v11, s[26:27] offset:0
v_mfma_f32_16x16x32_bf16 v[64:67], a[36:39], a[148:151], v[64:67]
v_exp_f32 v72, v72
v_mfma_f32_16x16x32_bf16 v[64:67], a[40:43], a[152:155], v[64:67]
ds_read_b64_tr_b16 a[100:101], v5 offset:56264
ds_read_b64_tr_b16 a[102:103], v5 offset:60392
v_mfma_f32_16x16x32_bf16 v[64:67], a[44:47], a[156:159], v[64:67]
v_exp_f32 v73, v73
v_mfma_f32_16x16x32_bf16 v[68:71], a[48:51], a[144:147], 0
s_add_u32 m0, s30, 113288
v_cvt_pk_bf16_f32 v84, v72, v73
v_cvt_pk_bf16_f32 v58, v13, v14
v_mfma_f32_16x16x32_bf16 v[68:71], a[52:55], a[148:151], v[68:71]
v_exp_f32 v74, v74
v_mfma_f32_16x16x32_bf16 v[68:71], a[56:59], a[152:155], v[68:71]
ds_read_b64_tr_b16 a[104:105], v6 offset:56256
ds_read_b64_tr_b16 a[106:107], v6 offset:60384
v_mfma_f32_16x16x32_bf16 v[68:71], a[60:63], a[156:159], v[68:71]
v_exp_f32 v75, v75
v_mfma_f32_16x16x32_bf16 v[224:227], a[64:67], v[80:83], v[224:227]
ds_read_b64_tr_b16 a[108:109], v6 offset:56264
v_cvt_pk_bf16_f32 v85, v74, v75
v_mfma_f32_16x16x32_bf16 v[228:231], a[68:71], v[80:83], v[228:231]
v_exp_f32 v76, v76
v_mfma_f32_16x16x32_bf16 v[232:235], a[72:75], v[80:83], v[232:235]
global_load_lds_dwordx4 v11, s[26:27] offset:1024
v_mfma_f32_16x16x32_bf16 v[236:239], a[76:79], v[80:83], v[236:239]
v_exp_f32 v77, v77
v_mfma_f32_16x16x32_bf16 v[240:243], a[80:83], v[80:83], v[240:243]
ds_read_b64_tr_b16 a[110:111], v6 offset:60392
v_cvt_pk_bf16_f32 v86, v76, v77
v_mfma_f32_16x16x32_bf16 v[244:247], a[84:87], v[80:83], v[244:247]
ds_read_b64_tr_b16 a[112:113], v7 offset:56256
v_exp_f32 v78, v78
v_mfma_f32_16x16x32_bf16 v[248:251], a[88:91], v[80:83], v[248:251]
ds_read_b64_tr_b16 a[114:115], v7 offset:60384
ds_read_b64_tr_b16 a[116:117], v7 offset:56264
v_lshlrev_b32 v13, 16, v59
v_mfma_f32_16x16x32_bf16 v[252:255], a[92:95], v[80:83], v[252:255]
ds_read_b64_tr_b16 a[118:119], v7 offset:60392
v_exp_f32 v79, v79
v_mfma_f32_16x16x32_bf16 a[224:227], a[228:231], v[80:83], a[224:227]
ds_read_b64_tr_b16 a[120:121], v8 offset:56256
ds_read_b64_tr_b16 a[122:123], v8 offset:60384
v_and_b32 v14, s35, v59
v_mfma_f32_16x16x32_bf16 v[72:75], a[32:35], a[160:163], 0
ds_read_b64_tr_b16 a[124:125], v8 offset:56264
ds_read_b64_tr_b16 a[126:127], v8 offset:60392
v_cvt_pk_bf16_f32 v87, v78, v79
v_mfma_f32_16x16x32_bf16 v[72:75], a[36:39], a[164:167], v[72:75]
v_exp_f32 v64, v64
v_mul_f32 v13, s34, v13
v_mfma_f32_16x16x32_bf16 v[72:75], a[40:43], a[168:171], v[72:75]
v_mul_f32 v14, s34, v14
v_cvt_pk_bf16_f32 v59, v13, v14
v_mfma_f32_16x16x32_bf16 v[72:75], a[44:47], a[172:175], v[72:75]
v_exp_f32 v65, v65
v_mfma_f32_16x16x32_bf16 v[76:79], a[48:51], a[160:163], 0
v_cvt_pk_bf16_f32 v80, v64, v65
v_lshlrev_b32 v13, 16, v60
v_mfma_f32_16x16x32_bf16 v[76:79], a[52:55], a[164:167], v[76:79]
v_exp_f32 v66, v66
v_mfma_f32_16x16x32_bf16 v[76:79], a[56:59], a[168:171], v[76:79]
v_and_b32 v14, s35, v60
v_mul_f32 v13, s34, v13
v_mfma_f32_16x16x32_bf16 v[76:79], a[60:63], a[172:175], v[76:79]
s_waitcnt lgkmcnt(0)
v_exp_f32 v67, v67
v_mfma_f32_16x16x32_bf16 v[96:99], a[96:99], v[84:87], v[96:99]
v_cvt_pk_bf16_f32 v81, v66, v67
v_mul_f32 v14, s34, v14
v_mfma_f32_16x16x32_bf16 v[100:103], a[100:103], v[84:87], v[100:103]
v_exp_f32 v68, v68
v_mfma_f32_16x16x32_bf16 v[104:107], a[104:107], v[84:87], v[104:107]
v_cvt_pk_bf16_f32 v60, v13, v14
v_lshlrev_b32 v13, 16, v61
v_mfma_f32_16x16x32_bf16 v[108:111], a[108:111], v[84:87], v[108:111]
v_exp_f32 v69, v69
v_mfma_f32_16x16x32_bf16 v[112:115], a[112:115], v[84:87], v[112:115]
v_cvt_pk_bf16_f32 v82, v68, v69
v_and_b32 v14, s35, v61
v_mfma_f32_16x16x32_bf16 v[116:119], a[116:119], v[84:87], v[116:119]
v_exp_f32 v70, v70
v_mfma_f32_16x16x32_bf16 v[120:123], a[120:123], v[84:87], v[120:123]
v_mul_f32 v13, s34, v13
v_mul_f32 v14, s34, v14
v_mfma_f32_16x16x32_bf16 v[124:127], a[124:127], v[84:87], v[124:127]
v_exp_f32 v71, v71
v_mfma_f32_16x16x32_bf16 a[208:211], a[228:231], v[84:87], a[208:211]
v_cvt_pk_bf16_f32 v83, v70, v71
v_cvt_pk_bf16_f32 v61, v13, v14
v_mfma_f32_16x16x32_bf16 v[64:67], a[32:35], a[176:179], 0
v_lshlrev_b32 v13, 16, v62
v_and_b32 v14, s35, v62
v_mfma_f32_16x16x32_bf16 v[64:67], a[36:39], a[180:183], v[64:67]
v_exp_f32 v72, v72
v_mfma_f32_16x16x32_bf16 v[64:67], a[40:43], a[184:187], v[64:67]
v_mul_f32 v13, s34, v13
v_mul_f32 v14, s34, v14
v_mfma_f32_16x16x32_bf16 v[64:67], a[44:47], a[188:191], v[64:67]
v_exp_f32 v73, v73
v_accvgpr_read_b32 v91, a208
v_mfma_f32_16x16x32_bf16 v[68:71], a[48:51], a[176:179], 0
v_cvt_pk_bf16_f32 v84, v72, v73
v_subrev_u32 v88, s36, v91
v_mfma_f32_16x16x32_bf16 v[68:71], a[52:55], a[180:183], v[68:71]
v_exp_f32 v74, v74
v_cmp_lt_u32 s[70:71], s33, v88
v_mfma_f32_16x16x32_bf16 v[68:71], a[56:59], a[184:187], v[68:71]
v_rcp_f32 v91, v91
v_mfma_f32_16x16x32_bf16 v[68:71], a[60:63], a[188:191], v[68:71]
v_exp_f32 v75, v75
v_mfma_f32_16x16x32_bf16 v[128:131], a[96:99], v[80:83], v[128:131]
v_cvt_pk_bf16_f32 v85, v74, v75
v_mul_f32 v96, v91, v96
v_mfma_f32_16x16x32_bf16 v[132:135], a[100:103], v[80:83], v[132:135]
v_exp_f32 v76, v76
v_mul_f32 v97, v91, v97
v_mfma_f32_16x16x32_bf16 v[136:139], a[104:107], v[80:83], v[136:139]
v_mul_f32 v98, v91, v98
v_mul_f32 v99, v91, v99
v_mfma_f32_16x16x32_bf16 v[140:143], a[108:111], v[80:83], v[140:143]
v_exp_f32 v77, v77
v_mfma_f32_16x16x32_bf16 v[144:147], a[112:115], v[80:83], v[144:147]
v_cvt_pk_bf16_f32 v86, v76, v77
v_mul_f32 v100, v91, v100
v_mfma_f32_16x16x32_bf16 v[148:151], a[116:119], v[80:83], v[148:151]
v_exp_f32 v78, v78
v_mfma_f32_16x16x32_bf16 v[152:155], a[120:123], v[80:83], v[152:155]
s_waitcnt vmcnt(4)
ds_write_b32 v0, v92
v_mul_f32 v101, v91, v101
v_mfma_f32_16x16x32_bf16 v[156:159], a[124:127], v[80:83], v[156:159]
v_exp_f32 v79, v79
v_mul_f32 v102, v91, v102
v_mfma_f32_16x16x32_bf16 a[212:215], a[228:231], v[80:83], a[212:215]
v_cvt_pk_bf16_f32 v87, v78, v79
v_mul_f32 v103, v91, v103
v_mfma_f32_16x16x32_bf16 v[72:75], a[32:35], a[192:195], 0
v_cvt_pk_bf16_f32 v96, v96, v97
v_cvt_pk_bf16_f32 v97, v98, v99
v_mfma_f32_16x16x32_bf16 v[72:75], a[36:39], a[196:199], v[72:75]
v_exp_f32 v64, v64
v_mfma_f32_16x16x32_bf16 v[72:75], a[40:43], a[200:203], v[72:75]
v_cvt_pk_bf16_f32 v62, v13, v14
v_cvt_pk_bf16_f32 v98, v100, v101
v_mfma_f32_16x16x32_bf16 v[72:75], a[44:47], a[204:207], v[72:75]
v_exp_f32 v65, v65
v_mfma_f32_16x16x32_bf16 v[76:79], a[48:51], a[192:195], 0
v_cvt_pk_bf16_f32 v80, v64, v65
v_cvt_pk_bf16_f32 v99, v102, v103
v_mfma_f32_16x16x32_bf16 v[76:79], a[52:55], a[196:199], v[76:79]
ds_read_b128 a[0:3], v1 offset:0
v_exp_f32 v66, v66
v_mfma_f32_16x16x32_bf16 v[76:79], a[56:59], a[200:203], v[76:79]
ds_read_b128 a[4:7], v2 offset:0
v_lshlrev_b32 v13, 16, v63
v_mfma_f32_16x16x32_bf16 v[76:79], a[60:63], a[204:207], v[76:79]
ds_read_b128 a[8:11], v3 offset:0
v_exp_f32 v67, v67
v_mfma_f32_16x16x32_bf16 v[160:163], a[96:99], v[84:87], v[160:163]
buffer_store_dwordx4 v[96:99], v12, s[16:19], s60 offen offset:0 sc0 sc1
v_mul_f32 v104, v91, v104
v_mfma_f32_16x16x32_bf16 v[164:167], a[100:103], v[84:87], v[164:167]
v_exp_f32 v68, v68
v_cvt_pk_bf16_f32 v81, v66, v67
v_mfma_f32_16x16x32_bf16 v[168:171], a[104:107], v[84:87], v[168:171]
ds_read_b32 v93, v90
ds_read_b128 a[12:15], v4 offset:0
v_and_b32 v14, s35, v63
v_mfma_f32_16x16x32_bf16 v[172:175], a[108:111], v[84:87], v[172:175]
v_exp_f32 v69, v69
v_mul_f32 v105, v91, v105
v_mfma_f32_16x16x32_bf16 v[176:179], a[112:115], v[84:87], v[176:179]
ds_read_b128 a[16:19], v1 offset:4096
ds_read_b128 a[20:23], v2 offset:4096
v_mul_f32 v106, v91, v106
v_mfma_f32_16x16x32_bf16 v[180:183], a[116:119], v[84:87], v[180:183]
v_exp_f32 v70, v70
v_mul_f32 v13, s34, v13
v_mfma_f32_16x16x32_bf16 v[184:187], a[120:123], v[84:87], v[184:187]
s_add_u32 s26, s22, 32768
ds_read_b128 a[24:27], v3 offset:4096
v_mul_f32 v107, v91, v107
v_cvt_pk_bf16_f32 v82, v68, v69
v_mfma_f32_16x16x32_bf16 v[188:191], a[124:127], v[84:87], v[188:191]
s_addc_u32 s27, s23, 0
ds_read_b128 a[28:31], v4 offset:4096
v_exp_f32 v71, v71
v_mfma_f32_16x16x32_bf16 a[216:219], a[228:231], v[84:87], a[216:219]
s_add_u32 m0, s30, 154560
s_waitcnt lgkmcnt(5)
v_cmp_gt_u32 vcc, v92, v93
v_mul_f32 v14, s34, v14
v_mul_f32 v108, v91, v108
v_mfma_f32_16x16x32_bf16 v[64:67], a[0:3], a[160:163], 0
s_cbranch_vccnz L_r16
L_b16:
v_mul_f32 v109, v91, v109
v_cvt_pk_bf16_f32 v63, v13, v14
v_mul_f32 v110, v91, v110
v_mfma_f32_16x16x32_bf16 v[64:67], a[4:7], a[164:167], v[64:67]
v_exp_f32 v72, v72
v_cvt_pk_bf16_f32 v83, v70, v71
v_mfma_f32_16x16x32_bf16 v[64:67], a[8:11], a[168:171], v[64:67]
s_waitcnt lgkmcnt(2)
v_mul_f32 v111, v91, v111
v_cvt_pk_bf16_f32 v104, v104, v105
v_cvt_pk_bf16_f32 v105, v106, v107
v_mfma_f32_16x16x32_bf16 v[64:67], a[12:15], a[172:175], v[64:67]
v_exp_f32 v73, v73
v_cvt_pk_bf16_f32 v106, v108, v109
v_mfma_f32_16x16x32_bf16 v[68:71], a[16:19], a[160:163], 0
global_load_lds_dwordx4 v11, s[26:27] offset:0
v_cvt_pk_bf16_f32 v84, v72, v73
v_mfma_f32_16x16x32_bf16 v[68:71], a[20:23], a[164:167], v[68:71]
s_add_u32 m0, s30, 154568
v_exp_f32 v74, v74
v_cvt_pk_bf16_f32 v107, v110, v111
s_waitcnt lgkmcnt(0)
v_mfma_f32_16x16x32_bf16 v[68:71], a[24:27], a[168:171], v[68:71]
ds_read_b64_tr_b16 a[64:65], v5 offset:39744
v_add_u32 v92, 1, v92
v_mfma_f32_16x16x32_bf16 v[68:71], a[28:31], a[172:175], v[68:71]
v_exp_f32 v75, v75
v_mfma_f32_16x16x32_bf16 v[192:195], a[96:99], v[80:83], v[192:195]
buffer_store_dwordx4 v[104:107], v12, s[16:19], s60 offen offset:64 sc0 sc1
v_mul_f32 v112, v91, v112
v_mfma_f32_16x16x32_bf16 v[196:199], a[100:103], v[80:83], v[196:199]
v_exp_f32 v76, v76
v_mul_f32 v113, v91, v113
v_mfma_f32_16x16x32_bf16 v[200:203], a[104:107], v[80:83], v[200:203]
v_cvt_pk_bf16_f32 v85, v74, v75
v_mul_f32 v114, v91, v114
v_mul_f32 v115, v91, v115
v_mfma_f32_16x16x32_bf16 v[204:207], a[108:111], v[80:83], v[204:207]
v_exp_f32 v77, v77
v_mul_f32 v116, v91, v116
v_mfma_f32_16x16x32_bf16 v[208:211], a[112:115], v[80:83], v[208:211]
global_load_lds_dwordx4 v11, s[26:27] offset:1024
v_cvt_pk_bf16_f32 v86, v76, v77
v_mfma_f32_16x16x32_bf16 v[212:215], a[116:119], v[80:83], v[212:215]
v_exp_f32 v78, v78
v_mul_f32 v117, v91, v117
v_mfma_f32_16x16x32_bf16 v[216:219], a[120:123], v[80:83], v[216:219]
v_mul_f32 v118, v91, v118
v_mul_f32 v119, v91, v119
v_mfma_f32_16x16x32_bf16 v[220:223], a[124:127], v[80:83], v[220:223]
v_exp_f32 v79, v79
v_mfma_f32_16x16x32_bf16 a[220:223], a[228:231], v[80:83], a[220:223]
v_cvt_pk_bf16_f32 v87, v78, v79
v_cvt_pk_bf16_f32 v112, v112, v113
v_mfma_f32_16x16x32_bf16 v[72:75], a[0:3], a[176:179], 0
v_cvt_pk_bf16_f32 v113, v114, v115
v_cvt_pk_bf16_f32 v114, v116, v117
v_mfma_f32_16x16x32_bf16 v[72:75], a[4:7], a[180:183], v[72:75]
v_exp_f32 v64, v64
v_mfma_f32_16x16x32_bf16 v[72:75], a[8:11], a[184:187], v[72:75]
ds_read_b64_tr_b16 a[66:67], v5 offset:43872
v_cvt_pk_bf16_f32 v115, v118, v119
v_mfma_f32_16x16x32_bf16 v[72:75], a[12:15], a[188:191], v[72:75]
v_exp_f32 v65, v65
v_mfma_f32_16x16x32_bf16 v[76:79], a[16:19], a[176:179], 0
ds_read_b64_tr_b16 a[68:69], v5 offset:39752
v_cvt_pk_bf16_f32 v80, v64, v65
v_mfma_f32_16x16x32_bf16 v[76:79], a[20:23], a[180:183], v[76:79]
v_exp_f32 v66, v66
v_mfma_f32_16x16x32_bf16 v[76:79], a[24:27], a[184:187], v[76:79]
buffer_store_dwordx4 v[112:115], v12, s[16:19], s60 offen offset:128 sc0 sc1
v_mul_f32 v120, v91, v120
v_mfma_f32_16x16x32_bf16 v[76:79], a[28:31], a[188:191], v[76:79]
v_exp_f32 v67, v67
v_mul_f32 v121, v91, v121
v_mfma_f32_16x16x32_bf16 v[224:227], a[96:99], v[84:87], v[224:227]
v_cvt_pk_bf16_f32 v81, v66, v67
v_mul_f32 v122, v91, v122
v_mfma_f32_16x16x32_bf16 v[228:231], a[100:103], v[84:87], v[228:231]
v_exp_f32 v68, v68
v_mul_f32 v123, v91, v123
v_mfma_f32_16x16x32_bf16 v[232:235], a[104:107], v[84:87], v[232:235]
ds_read_b64_tr_b16 a[70:71], v5 offset:43880
v_mul_f32 v124, v91, v124
v_mfma_f32_16x16x32_bf16 v[236:239], a[108:111], v[84:87], v[236:239]
ds_read_b64_tr_b16 a[72:73], v6 offset:39744
v_exp_f32 v69, v69
v_mfma_f32_16x16x32_bf16 v[240:243], a[112:115], v[84:87], v[240:243]
ds_read_b64_tr_b16 a[74:75], v6 offset:43872
ds_read_b64_tr_b16 a[76:77], v6 offset:39752
v_cvt_pk_bf16_f32 v82, v68, v69
v_mfma_f32_16x16x32_bf16 v[244:247], a[116:119], v[84:87], v[244:247]
ds_read_b64_tr_b16 a[78:79], v6 offset:43880
v_exp_f32 v70, v70
v_mfma_f32_16x16x32_bf16 v[248:251], a[120:123], v[84:87], v[248:251]
ds_read_b64_tr_b16 a[80:81], v7 offset:39744
ds_read_b64_tr_b16 a[82:83], v7 offset:43872
v_mul_f32 v125, v91, v125
v_mfma_f32_16x16x32_bf16 v[252:255], a[124:127], v[84:87], v[252:255]
v_exp_f32 v71, v71
v_mul_f32 v126, v91, v126
v_mfma_f32_16x16x32_bf16 a[224:227], a[228:231], v[84:87], a[224:227]
ds_read_b64_tr_b16 a[84:85], v7 offset:39752
ds_read_b64_tr_b16 a[86:87], v7 offset:43880
v_mul_f32 v127, v91, v127
v_mfma_f32_16x16x32_bf16 v[64:67], a[0:3], a[192:195], 0
ds_read_b64_tr_b16 a[88:89], v8 offset:39744
ds_read_b64_tr_b16 a[90:91], v8 offset:43872
v_cvt_pk_bf16_f32 v120, v120, v121
v_mfma_f32_16x16x32_bf16 v[64:67], a[4:7], a[196:199], v[64:67]
v_exp_f32 v72, v72
v_cvt_pk_bf16_f32 v83, v70, v71
v_mfma_f32_16x16x32_bf16 v[64:67], a[8:11], a[200:203], v[64:67]
ds_read_b64_tr_b16 a[92:93], v8 offset:39752
ds_read_b64_tr_b16 a[94:95], v8 offset:43880
v_cvt_pk_bf16_f32 v121, v122, v123
v_mfma_f32_16x16x32_bf16 v[64:67], a[12:15], a[204:207], v[64:67]
v_exp_f32 v73, v73
v_cvt_pk_bf16_f32 v122, v124, v125
v_mfma_f32_16x16x32_bf16 v[68:71], a[16:19], a[192:195], 0
v_cvt_pk_bf16_f32 v123, v126, v127
v_cvt_pk_bf16_f32 v84, v72, v73
v_mfma_f32_16x16x32_bf16 v[68:71], a[20:23], a[196:199], v[68:71]
buffer_store_dwordx4 v[120:123], v12, s[16:19], s60 offen offset:192 sc0 sc1
v_exp_f32 v74, v74
v_mfma_f32_16x16x32_bf16 v[68:71], a[24:27], a[200:203], v[68:71]
ds_read_b128 a[32:35], v1 offset:8192
ds_read_b128 a[36:39], v2 offset:8192
v_accvgpr_read_b32 v91, a212
v_mfma_f32_16x16x32_bf16 v[68:71], a[28:31], a[204:207], v[68:71]
ds_read_b128 a[40:43], v3 offset:8192
s_waitcnt lgkmcnt(5)
v_exp_f32 v75, v75
v_mfma_f32_16x16x32_bf16 v[160:163], a[64:67], v[80:83], v[160:163]
ds_read_b128 a[44:47], v4 offset:8192
v_subrev_u32 v88, s36, v91
v_cvt_pk_bf16_f32 v85, v74, v75
v_mfma_f32_16x16x32_bf16 v[164:167], a[68:71], v[80:83], v[164:167]
ds_read_b128 a[48:51], v1 offset:12288
v_exp_f32 v76, v76
v_mfma_f32_16x16x32_bf16 v[168:171], a[72:75], v[80:83], v[168:171]
ds_read_b128 a[52:55], v2 offset:12288
v_cmp_lt_u32 s[72:73], s33, v88
v_mfma_f32_16x16x32_bf16 v[172:175], a[76:79], v[80:83], v[172:175]
ds_read_b128 a[56:59], v3 offset:12288
v_exp_f32 v77, v77
v_mfma_f32_16x16x32_bf16 v[176:179], a[80:83], v[80:83], v[176:179]
ds_read_b128 a[60:63], v4 offset:12288
v_cvt_pk_bf16_f32 v86, v76, v77
v_mfma_f32_16x16x32_bf16 v[180:183], a[84:87], v[80:83], v[180:183]
v_exp_f32 v78, v78
v_mfma_f32_16x16x32_bf16 v[184:187], a[88:91], v[80:83], v[184:187]
s_waitcnt lgkmcnt(4)
v_rcp_f32 v91, v91
v_mfma_f32_16x16x32_bf16 v[188:191], a[92:95], v[80:83], v[188:191]
v_exp_f32 v79, v79
v_mul_f32 v128, v91, v128
v_mfma_f32_16x16x32_bf16 a[216:219], a[228:231], v[80:83], a[216:219]
v_cvt_pk_bf16_f32 v87, v78, v79
v_mul_f32 v129, v91, v129
v_mfma_f32_16x16x32_bf16 v[72:75], a[32:35], a[160:163], 0
v_mul_f32 v130, v91, v130
v_mul_f32 v131, v91, v131
v_mfma_f32_16x16x32_bf16 v[72:75], a[36:39], a[164:167], v[72:75]
v_exp_f32 v64, v64
v_mfma_f32_16x16x32_bf16 v[72:75], a[40:43], a[168:171], v[72:75]
v_mul_f32 v132, v91, v132
v_mul_f32 v133, v91, v133
v_mfma_f32_16x16x32_bf16 v[72:75], a[44:47], a[172:175], v[72:75]
s_waitcnt lgkmcnt(0)
v_exp_f32 v65, v65
v_mfma_f32_16x16x32_bf16 v[76:79], a[48:51], a[160:163], 0
v_cvt_pk_bf16_f32 v80, v64, v65
v_mul_f32 v134, v91, v134
v_mfma_f32_16x16x32_bf16 v[76:79], a[52:55], a[164:167], v[76:79]
v_exp_f32 v66, v66
v_mfma_f32_16x16x32_bf16 v[76:79], a[56:59], a[168:171], v[76:79]
v_mul_f32 v135, v91, v135
v_cvt_pk_bf16_f32 v128, v128, v129
v_mfma_f32_16x16x32_bf16 v[76:79], a[60:63], a[172:175], v[76:79]
v_exp_f32 v67, v67
v_mfma_f32_16x16x32_bf16 v[192:195], a[64:67], v[84:87], v[192:195]
v_cvt_pk_bf16_f32 v81, v66, v67
v_cvt_pk_bf16_f32 v129, v130, v131
v_mfma_f32_16x16x32_bf16 v[196:199], a[68:71], v[84:87], v[196:199]
v_exp_f32 v68, v68
v_mfma_f32_16x16x32_bf16 v[200:203], a[72:75], v[84:87], v[200:203]
v_cvt_pk_bf16_f32 v130, v132, v133
v_cvt_pk_bf16_f32 v131, v134, v135
v_mfma_f32_16x16x32_bf16 v[204:207], a[76:79], v[84:87], v[204:207]
v_exp_f32 v69, v69
v_mfma_f32_16x16x32_bf16 v[208:211], a[80:83], v[84:87], v[208:211]
ds_read_b64_tr_b16 a[96:97], v5 offset:6720
v_cvt_pk_bf16_f32 v82, v68, v69
v_mfma_f32_16x16x32_bf16 v[212:215], a[84:87], v[84:87], v[212:215]
v_exp_f32 v70, v70
v_mfma_f32_16x16x32_bf16 v[216:219], a[88:91], v[84:87], v[216:219]
ds_read_b64_tr_b16 a[98:99], v5 offset:10848
ds_read_b64_tr_b16 a[100:101], v5 offset:6728
v_mfma_f32_16x16x32_bf16 v[220:223], a[92:95], v[84:87], v[220:223]
v_exp_f32 v71, v71
v_mfma_f32_16x16x32_bf16 a[220:223], a[228:231], v[84:87], a[220:223]
ds_read_b64_tr_b16 a[102:103], v5 offset:10856
v_cvt_pk_bf16_f32 v83, v70, v71
v_mfma_f32_16x16x32_bf16 v[64:67], a[32:35], a[176:179], 0
buffer_store_dwordx4 v[128:131], v12, s[16:19], s61 offen offset:0 sc0 sc1
v_mfma_f32_16x16x32_bf16 v[64:67], a[36:39], a[180:183], v[64:67]
v_exp_f32 v72, v72
v_mfma_f32_16x16x32_bf16 v[64:67], a[40:43], a[184:187], v[64:67]
ds_read_b64_tr_b16 a[104:105], v6 offset:6720
ds_read_b64_tr_b16 a[106:107], v6 offset:10848
v_mfma_f32_16x16x32_bf16 v[64:67], a[44:47], a[188:191], v[64:67]
v_exp_f32 v73, v73
v_mfma_f32_16x16x32_bf16 v[68:71], a[48:51], a[176:179], 0
v_cvt_pk_bf16_f32 v84, v72, v73
v_mul_f32 v136, v91, v136
v_mfma_f32_16x16x32_bf16 v[68:71], a[52:55], a[180:183], v[68:71]
v_exp_f32 v74, v74
v_mfma_f32_16x16x32_bf16 v[68:71], a[56:59], a[184:187], v[68:71]
ds_read_b64_tr_b16 a[108:109], v6 offset:6728
ds_read_b64_tr_b16 a[110:111], v6 offset:10856
v_mfma_f32_16x16x32_bf16 v[68:71], a[60:63], a[188:191], v[68:71]
v_exp_f32 v75, v75
v_mfma_f32_16x16x32_bf16 v[224:227], a[64:67], v[80:83], v[224:227]
ds_read_b64_tr_b16 a[112:113], v7 offset:6720
v_cvt_pk_bf16_f32 v85, v74, v75
v_mfma_f32_16x16x32_bf16 v[228:231], a[68:71], v[80:83], v[228:231]
v_exp_f32 v76, v76
v_mfma_f32_16x16x32_bf16 v[232:235], a[72:75], v[80:83], v[232:235]
ds_read_b64_tr_b16 a[114:115], v7 offset:10848
v_mul_f32 v137, v91, v137
v_mfma_f32_16x16x32_bf16 v[236:239], a[76:79], v[80:83], v[236:239]
v_exp_f32 v77, v77
v_mfma_f32_16x16x32_bf16 v[240:243], a[80:83], v[80:83], v[240:243]
ds_read_b64_tr_b16 a[116:117], v7 offset:6728
v_cvt_pk_bf16_f32 v86, v76, v77
v_mfma_f32_16x16x32_bf16 v[244:247], a[84:87], v[80:83], v[244:247]
v_exp_f32 v78, v78
v_mfma_f32_16x16x32_bf16 v[248:251], a[88:91], v[80:83], v[248:251]
ds_read_b64_tr_b16 a[118:119], v7 offset:10856
ds_read_b64_tr_b16 a[120:121], v8 offset:6720
v_mfma_f32_16x16x32_bf16 v[252:255], a[92:95], v[80:83], v[252:255]
ds_read_b64_tr_b16 a[122:123], v8 offset:10848
v_exp_f32 v79, v79
v_mfma_f32_16x16x32_bf16 a[224:227], a[228:231], v[80:83], a[224:227]
ds_read_b64_tr_b16 a[124:125], v8 offset:6728
ds_read_b64_tr_b16 a[126:127], v8 offset:10856
v_cvt_pk_bf16_f32 v87, v78, v79
v_mfma_f32_16x16x32_bf16 v[72:75], a[32:35], a[192:195], 0
v_mul_f32 v138, v91, v138
v_mul_f32 v139, v91, v139
v_mfma_f32_16x16x32_bf16 v[72:75], a[36:39], a[196:199], v[72:75]
v_exp_f32 v64, v64
v_mfma_f32_16x16x32_bf16 v[72:75], a[40:43], a[200:203], v[72:75]
v_mul_f32 v140, v91, v140
v_mul_f32 v141, v91, v141
v_mfma_f32_16x16x32_bf16 v[72:75], a[44:47], a[204:207], v[72:75]
v_exp_f32 v65, v65
v_mfma_f32_16x16x32_bf16 v[76:79], a[48:51], a[192:195], 0
v_cvt_pk_bf16_f32 v80, v64, v65
v_mul_f32 v142, v91, v142
v_mfma_f32_16x16x32_bf16 v[76:79], a[52:55], a[196:199], v[76:79]
v_exp_f32 v66, v66
v_mfma_f32_16x16x32_bf16 v[76:79], a[56:59], a[200:203], v[76:79]
v_mul_f32 v143, v91, v143
v_cvt_pk_bf16_f32 v136, v136, v137
v_mfma_f32_16x16x32_bf16 v[76:79], a[60:63], a[204:207], v[76:79]
s_waitcnt lgkmcnt(0)
v_exp_f32 v67, v67
v_mfma_f32_16x16x32_bf16 v[160:163], a[96:99], v[84:87], v[160:163]
v_cvt_pk_bf16_f32 v81, v66, v67
v_cvt_pk_bf16_f32 v137, v138, v139
v_mfma_f32_16x16x32_bf16 v[164:167], a[100:103], v[84:87], v[164:167]
v_exp_f32 v68, v68
v_mfma_f32_16x16x32_bf16 v[168:171], a[104:107], v[84:87], v[168:171]
v_cvt_pk_bf16_f32 v138, v140, v141
v_cvt_pk_bf16_f32 v139, v142, v143
v_mfma_f32_16x16x32_bf16 v[172:175], a[108:111], v[84:87], v[172:175]
v_exp_f32 v69, v69
v_mfma_f32_16x16x32_bf16 v[176:179], a[112:115], v[84:87], v[176:179]
ds_read_b128 a[0:3], v1 offset:16384
v_cvt_pk_bf16_f32 v82, v68, v69
v_mfma_f32_16x16x32_bf16 v[180:183], a[116:119], v[84:87], v[180:183]
v_exp_f32 v70, v70
v_mfma_f32_16x16x32_bf16 v[184:187], a[120:123], v[84:87], v[184:187]
s_add_u32 s26, s22, 40960
s_waitcnt vmcnt(3)
ds_write_b32 v0, v92
ds_read_b128 a[4:7], v2 offset:16384
v_mfma_f32_16x16x32_bf16 v[188:191], a[124:127], v[84:87], v[188:191]
s_addc_u32 s27, s23, 0
v_exp_f32 v71, v71
v_mfma_f32_16x16x32_bf16 a[216:219], a[228:231], v[84:87], a[216:219]
s_add_u32 m0, s30, 129792
ds_read_b128 a[8:11], v3 offset:16384
v_cvt_pk_bf16_f32 v83, v70, v71
v_mfma_f32_16x16x32_bf16 v[64:67], a[32:35], v[16:19], 0
buffer_store_dwordx4 v[136:139], v12, s[16:19], s61 offen offset:64 sc0 sc1
v_mfma_f32_16x16x32_bf16 v[64:67], a[36:39], v[20:23], v[64:67]
v_exp_f32 v72, v72
v_mfma_f32_16x16x32_bf16 v[64:67], a[40:43], v[24:27], v[64:67]
global_load_lds_dwordx4 v11, s[26:27] offset:0
v_mfma_f32_16x16x32_bf16 v[64:67], a[44:47], v[28:31], v[64:67]
v_exp_f32 v73, v73
v_mfma_f32_16x16x32_bf16 v[68:71], a[48:51], v[16:19], 0
ds_read_b128 a[12:15], v4 offset:16384
v_cvt_pk_bf16_f32 v84, v72, v73
v_mfma_f32_16x16x32_bf16 v[68:71], a[52:55], v[20:23], v[68:71]
s_add_u32 m0, s30, 129800
v_exp_f32 v74, v74
v_mfma_f32_16x16x32_bf16 v[68:71], a[56:59], v[24:27], v[68:71]
ds_read_b128 a[16:19], v1 offset:20480
v_mul_f32 v144, v91, v144
v_mfma_f32_16x16x32_bf16 v[68:71], a[60:63], v[28:31], v[68:71]
v_exp_f32 v75, v75
v_mfma_f32_16x16x32_bf16 v[192:195], a[96:99], v[80:83], v[192:195]
ds_read_b128 a[20:23], v2 offset:20480
v_cvt_pk_bf16_f32 v85, v74, v75
v_mfma_f32_16x16x32_bf16 v[196:199], a[100:103], v[80:83], v[196:199]
v_exp_f32 v76, v76
v_mfma_f32_16x16x32_bf16 v[200:203], a[104:107], v[80:83], v[200:203]
ds_read_b32 v93, v90
v_mul_f32 v145, v91, v145
v_mfma_f32_16x16x32_bf16 v[204:207], a[108:111], v[80:83], v[204:207]
ds_read_b128 a[24:27], v3 offset:20480
v_exp_f32 v77, v77
v_mfma_f32_16x16x32_bf16 v[208:211], a[112:115], v[80:83], v[208:211]
global_load_lds_dwordx4 v11, s[26:27] offset:1024
v_cvt_pk_bf16_f32 v86, v76, v77
v_mfma_f32_16x16x32_bf16 v[212:215], a[116:119], v[80:83], v[212:215]
s_add_u32 s26, s22, 49152
ds_read_b128 a[28:31], v4 offset:20480
v_exp_f32 v78, v78
v_mfma_f32_16x16x32_bf16 v[216:219], a[120:123], v[80:83], v[216:219]
s_addc_u32 s27, s23, 0
v_mul_f32 v146, v91, v146
v_mul_f32 v147, v91, v147
v_mfma_f32_16x16x32_bf16 v[220:223], a[124:127], v[80:83], v[220:223]
s_add_u32 m0, s30, 121536
v_exp_f32 v79, v79
v_mfma_f32_16x16x32_bf16 a[220:223], a[228:231], v[80:83], a[220:223]
s_waitcnt lgkmcnt(2)
v_cmp_gt_u32 vcc, v92, v93
v_cvt_pk_bf16_f32 v87, v78, v79
v_mfma_f32_16x16x32_bf16 v[72:75], a[0:3], a[160:163], 0
s_cbranch_vccnz L_r18
L_b18:
global_load_lds_dwordx4 v11, s[26:27] offset:0
v_mul_f32 v148, v91, v148
v_mfma_f32_16x16x32_bf16 v[72:75], a[4:7], a[164:167], v[72:75]
v_exp_f32 v64, v64
v_mfma_f32_16x16x32_bf16 v[72:75], a[8:11], a[168:171], v[72:75]
v_mul_f32 v149, v91, v149
v_add_u32 v92, 1, v92
v_mfma_f32_16x16x32_bf16 v[72:75], a[12:15], a[172:175], v[72:75]
v_exp_f32 v65, v65
v_mfma_f32_16x16x32_bf16 v[76:79], a[16:19], a[160:163], 0
s_add_u32 m0, s30, 121544
v_cvt_pk_bf16_f32 v80, v64, v65
v_mul_f32 v150, v91, v150
v_mfma_f32_16x16x32_bf16 v[76:79], a[20:23], a[164:167], v[76:79]
s_waitcnt lgkmcnt(0)
v_exp_f32 v66, v66
v_mfma_f32_16x16x32_bf16 v[76:79], a[24:27], a[168:171], v[76:79]
v_mul_f32 v151, v91, v151
v_cvt_pk_bf16_f32 v144, v144, v145
v_mfma_f32_16x16x32_bf16 v[76:79], a[28:31], a[172:175], v[76:79]
v_exp_f32 v67, v67
v_mfma_f32_16x16x32_bf16 v[224:227], a[96:99], v[84:87], v[224:227]
v_cvt_pk_bf16_f32 v81, v66, v67
v_cvt_pk_bf16_f32 v145, v146, v147
v_mfma_f32_16x16x32_bf16 v[228:231], a[100:103], v[84:87], v[228:231]
v_exp_f32 v68, v68
v_mfma_f32_16x16x32_bf16 v[232:235], a[104:107], v[84:87], v[232:235]
global_load_lds_dwordx4 v11, s[26:27] offset:1024
v_mfma_f32_16x16x32_bf16 v[236:239], a[108:111], v[84:87], v[236:239]
v_exp_f32 v69, v69
v_mfma_f32_16x16x32_bf16 v[240:243], a[112:115], v[84:87], v[240:243]
s_add_u32 s26, s22, 57344
v_cvt_pk_bf16_f32 v82, v68, v69
v_cvt_pk_bf16_f32 v146, v148, v149
v_mfma_f32_16x16x32_bf16 v[244:247], a[116:119], v[84:87], v[244:247]
s_addc_u32 s27, s23, 0
v_exp_f32 v70, v70
v_mfma_f32_16x16x32_bf16 v[248:251], a[120:123], v[84:87], v[248:251]
s_add_u32 m0, s30, 138048
ds_read_b64_tr_b16 a[64:65], v5 offset:48000
v_cvt_pk_bf16_f32 v147, v150, v151
v_mfma_f32_16x16x32_bf16 v[252:255], a[124:127], v[84:87], v[252:255]
v_exp_f32 v71, v71
v_mfma_f32_16x16x32_bf16 a[224:227], a[228:231], v[84:87], a[224:227]
ds_read_b64_tr_b16 a[66:67], v5 offset:52128
v_cvt_pk_bf16_f32 v83, v70, v71
v_mfma_f32_16x16x32_bf16 v[64:67], a[0:3], a[176:179], 0
global_load_lds_dwordx4 v11, s[26:27] offset:0
v_mfma_f32_16x16x32_bf16 v[64:67], a[4:7], a[180:183], v[64:67]
v_exp_f32 v72, v72
v_mfma_f32_16x16x32_bf16 v[64:67], a[8:11], a[184:187], v[64:67]
buffer_store_dwordx4 v[144:147], v12, s[16:19], s61 offen offset:128 sc0 sc1
v_mfma_f32_16x16x32_bf16 v[64:67], a[12:15], a[188:191], v[64:67]
s_add_u32 m0, s30, 138056
v_exp_f32 v73, v73
v_mfma_f32_16x16x32_bf16 v[68:71], a[16:19], a[176:179], 0
v_cvt_pk_bf16_f32 v84, v72, v73
v_mul_f32 v152, v91, v152
v_mfma_f32_16x16x32_bf16 v[68:71], a[20:23], a[180:183], v[68:71]
v_exp_f32 v74, v74
v_mfma_f32_16x16x32_bf16 v[68:71], a[24:27], a[184:187], v[68:71]
v_mul_f32 v153, v91, v153
v_mul_f32 v154, v91, v154
v_mfma_f32_16x16x32_bf16 v[68:71], a[28:31], a[188:191], v[68:71]
v_exp_f32 v75, v75
v_mfma_f32_16x16x32_bf16 v[96:99], a[96:99], v[80:83], 0
global_load_lds_dwordx4 v11, s[26:27] offset:1024
v_cvt_pk_bf16_f32 v85, v74, v75
v_mfma_f32_16x16x32_bf16 v[100:103], a[100:103], v[80:83], 0
v_exp_f32 v76, v76
v_mfma_f32_16x16x32_bf16 v[104:107], a[104:107], v[80:83], 0
ds_read_b64_tr_b16 a[68:69], v5 offset:48008
ds_read_b64_tr_b16 a[70:71], v5 offset:52136
v_mfma_f32_16x16x32_bf16 v[108:111], a[108:111], v[80:83], 0
ds_read_b64_tr_b16 a[72:73], v6 offset:48000
v_exp_f32 v77, v77
v_mfma_f32_16x16x32_bf16 v[112:115], a[112:115], v[80:83], 0
ds_read_b64_tr_b16 a[74:75], v6 offset:52128
ds_read_b64_tr_b16 a[76:77], v6 offset:48008
v_cvt_pk_bf16_f32 v86, v76, v77
v_mfma_f32_16x16x32_bf16 v[116:119], a[116:119], v[80:83], 0
ds_read_b64_tr_b16 a[78:79], v6 offset:52136
v_exp_f32 v78, v78
v_mfma_f32_16x16x32_bf16 v[120:123], a[120:123], v[80:83], 0
ds_read_b64_tr_b16 a[80:81], v7 offset:48000
ds_read_b64_tr_b16 a[82:83], v7 offset:52128
v_mul_f32 v155, v91, v155
v_mfma_f32_16x16x32_bf16 v[124:127], a[124:127], v[80:83], 0
ds_read_b64_tr_b16 a[84:85], v7 offset:48008
v_exp_f32 v79, v79
v_mfma_f32_16x16x32_bf16 a[208:211], a[228:231], v[80:83], 0
ds_read_b64_tr_b16 a[86:87], v7 offset:52136
ds_read_b64_tr_b16 a[88:89], v8 offset:48000
v_mul_f32 v156, v91, v156
v_mfma_f32_16x16x32_bf16 v[72:75], a[0:3], a[192:195], 0
ds_read_b64_tr_b16 a[90:91], v8 offset:52128
ds_read_b64_tr_b16 a[92:93], v8 offset:48008
v_cvt_pk_bf16_f32 v87, v78, v79
v_mfma_f32_16x16x32_bf16 v[72:75], a[4:7], a[196:199], v[72:75]
ds_read_b64_tr_b16 a[94:95], v8 offset:52136
v_exp_f32 v64, v64
v_mfma_f32_16x16x32_bf16 v[72:75], a[8:11], a[200:203], v[72:75]
v_mul_f32 v157, v91, v157
v_mul_f32 v158, v91, v158
v_mfma_f32_16x16x32_bf16 v[72:75], a[12:15], a[204:207], v[72:75]
v_exp_f32 v65, v65
v_mfma_f32_16x16x32_bf16 v[76:79], a[16:19], a[192:195], 0
v_cvt_pk_bf16_f32 v80, v64, v65
v_mul_f32 v159, v91, v159
v_mfma_f32_16x16x32_bf16 v[76:79], a[20:23], a[196:199], v[76:79]
v_exp_f32 v66, v66
v_mfma_f32_16x16x32_bf16 v[76:79], a[24:27], a[200:203], v[76:79]
v_cvt_pk_bf16_f32 v152, v152, v153
v_cvt_pk_bf16_f32 v153, v154, v155
v_mfma_f32_16x16x32_bf16 v[76:79], a[28:31], a[204:207], v[76:79]
s_waitcnt lgkmcnt(0)
v_exp_f32 v67, v67
v_mfma_f32_16x16x32_bf16 v[160:163], a[64:67], v[84:87], v[160:163]
v_cvt_pk_bf16_f32 v81, v66, v67
v_cvt_pk_bf16_f32 v154, v156, v157
v_mfma_f32_16x16x32_bf16 v[164:167], a[68:71], v[84:87], v[164:167]
v_exp_f32 v68, v68
v_mfma_f32_16x16x32_bf16 v[168:171], a[72:75], v[84:87], v[168:171]
ds_read_b128 a[32:35], v1 offset:24576
v_cvt_pk_bf16_f32 v155, v158, v159
v_mfma_f32_16x16x32_bf16 v[172:175], a[76:79], v[84:87], v[172:175]
v_exp_f32 v69, v69
v_mfma_f32_16x16x32_bf16 v[176:179], a[80:83], v[84:87], v[176:179]
ds_read_b128 a[36:39], v2 offset:24576
v_cvt_pk_bf16_f32 v82, v68, v69
v_mfma_f32_16x16x32_bf16 v[180:183], a[84:87], v[84:87], v[180:183]
v_exp_f32 v70, v70
v_mfma_f32_16x16x32_bf16 v[184:187], a[88:91], v[84:87], v[184:187]
buffer_store_dwordx4 v[152:155], v12, s[16:19], s61 offen offset:192 sc0 sc1
v_mfma_f32_16x16x32_bf16 v[188:191], a[92:95], v[84:87], v[188:191]
v_exp_f32 v71, v71
v_mfma_f32_16x16x32_bf16 a[216:219], a[228:231], v[84:87], a[216:219]
ds_read_b128 a[40:43], v3 offset:24576
v_cvt_pk_bf16_f32 v83, v70, v71
v_mfma_f32_16x16x32_bf16 v[64:67], a[0:3], v[16:19], 0
ds_read_b128 a[44:47], v4 offset:24576
ds_read_b128 a[48:51], v1 offset:28672
v_mfma_f32_16x16x32_bf16 v[64:67], a[4:7], v[20:23], v[64:67]
v_exp_f32 v72, v72
v_mfma_f32_16x16x32_bf16 v[64:67], a[8:11], v[24:27], v[64:67]
ds_read_b128 a[52:55], v2 offset:28672
ds_read_b128 a[56:59], v3 offset:28672
v_mfma_f32_16x16x32_bf16 v[64:67], a[12:15], v[28:31], v[64:67]
v_exp_f32 v73, v73
v_accvgpr_read_b32 v91, a216
v_mfma_f32_16x16x32_bf16 v[68:71], a[16:19], v[16:19], 0
v_cvt_pk_bf16_f32 v84, v72, v73
v_subrev_u32 v88, s36, v91
v_mfma_f32_16x16x32_bf16 v[68:71], a[20:23], v[20:23], v[68:71]
v_exp_f32 v74, v74
v_mfma_f32_16x16x32_bf16 v[68:71], a[24:27], v[24:27], v[68:71]
ds_read_b128 a[60:63], v4 offset:28672
v_cmp_lt_u32 s[74:75], s33, v88
v_mfma_f32_16x16x32_bf16 v[68:71], a[28:31], v[28:31], v[68:71]
v_exp_f32 v75, v75
v_mfma_f32_16x16x32_bf16 v[192:195], a[64:67], v[80:83], v[192:195]
ds_read_b64_tr_b16 a[96:97], v5 offset:14976
v_cvt_pk_bf16_f32 v85, v74, v75
v_mfma_f32_16x16x32_bf16 v[196:199], a[68:71], v[80:83], v[196:199]
v_exp_f32 v76, v76
v_mfma_f32_16x16x32_bf16 v[200:203], a[72:75], v[80:83], v[200:203]
v_rcp_f32 v91, v91
v_mfma_f32_16x16x32_bf16 v[204:207], a[76:79], v[80:83], v[204:207]
v_exp_f32 v77, v77
v_mfma_f32_16x16x32_bf16 v[208:211], a[80:83], v[80:83], v[208:211]
v_cvt_pk_bf16_f32 v86, v76, v77
v_mul_f32 v160, v91, v160
v_mfma_f32_16x16x32_bf16 v[212:215], a[84:87], v[80:83], v[212:215]
v_exp_f32 v78, v78
v_mfma_f32_16x16x32_bf16 v[216:219], a[88:91], v[80:83], v[216:219]
v_mul_f32 v161, v91, v161
v_mul_f32 v162, v91, v162
v_mfma_f32_16x16x32_bf16 v[220:223], a[92:95], v[80:83], v[220:223]
v_exp_f32 v79, v79
v_mfma_f32_16x16x32_bf16 a[220:223], a[228:231], v[80:83], a[220:223]
s_waitcnt lgkmcnt(0)
v_cvt_pk_bf16_f32 v87, v78, v79
v_mul_f32 v163, v91, v163
v_mfma_f32_16x16x32_bf16 v[72:75], a[32:35], a[176:179], 0
v_mul_f32 v164, v91, v164
v_mul_f32 v165, v91, v165
v_mfma_f32_16x16x32_bf16 v[72:75], a[36:39], a[180:183], v[72:75]
v_exp_f32 v64, v64
v_mfma_f32_16x16x32_bf16 v[72:75], a[40:43], a[184:187], v[72:75]
v_mul_f32 v166, v91, v166
v_mul_f32 v167, v91, v167
v_mfma_f32_16x16x32_bf16 v[72:75], a[44:47], a[188:191], v[72:75]
v_exp_f32 v65, v65
v_mfma_f32_16x16x32_bf16 v[76:79], a[48:51], a[176:179], 0
v_cvt_pk_bf16_f32 v80, v64, v65
v_cvt_pk_bf16_f32 v160, v160, v161
v_mfma_f32_16x16x32_bf16 v[76:79], a[52:55], a[180:183], v[76:79]
v_exp_f32 v66, v66
v_mfma_f32_16x16x32_bf16 v[76:79], a[56:59], a[184:187], v[76:79]
v_cvt_pk_bf16_f32 v161, v162, v163
v_cvt_pk_bf16_f32 v162, v164, v165
v_mfma_f32_16x16x32_bf16 v[76:79], a[60:63], a[188:191], v[76:79]
v_exp_f32 v67, v67
v_mfma_f32_16x16x32_bf16 v[224:227], a[64:67], v[84:87], v[224:227]
ds_read_b64_tr_b16 a[98:99], v5 offset:19104
v_cvt_pk_bf16_f32 v81, v66, v67
v_mfma_f32_16x16x32_bf16 v[228:231], a[68:71], v[84:87], v[228:231]
v_exp_f32 v68, v68
v_mfma_f32_16x16x32_bf16 v[232:235], a[72:75], v[84:87], v[232:235]
ds_read_b64_tr_b16 a[100:101], v5 offset:14984
v_cvt_pk_bf16_f32 v163, v166, v167
v_mfma_f32_16x16x32_bf16 v[236:239], a[76:79], v[84:87], v[236:239]
v_exp_f32 v69, v69
v_mfma_f32_16x16x32_bf16 v[240:243], a[80:83], v[84:87], v[240:243]
ds_read_b64_tr_b16 a[102:103], v5 offset:19112
v_cvt_pk_bf16_f32 v82, v68, v69
v_mfma_f32_16x16x32_bf16 v[244:247], a[84:87], v[84:87], v[244:247]
v_exp_f32 v70, v70
v_mfma_f32_16x16x32_bf16 v[248:251], a[88:91], v[84:87], v[248:251]
ds_read_b64_tr_b16 a[104:105], v6 offset:14976
ds_read_b64_tr_b16 a[106:107], v6 offset:19104
v_mfma_f32_16x16x32_bf16 v[252:255], a[92:95], v[84:87], v[252:255]
v_exp_f32 v71, v71
v_mfma_f32_16x16x32_bf16 a[224:227], a[228:231], v[84:87], a[224:227]
ds_read_b64_tr_b16 a[108:109], v6 offset:14984
v_cvt_pk_bf16_f32 v83, v70, v71
v_mfma_f32_16x16x32_bf16 v[64:67], a[32:35], a[192:195], 0
ds_read_b64_tr_b16 a[110:111], v6 offset:19112
ds_read_b64_tr_b16 a[112:113], v7 offset:14976
v_mfma_f32_16x16x32_bf16 v[64:67], a[36:39], a[196:199], v[64:67]
v_exp_f32 v72, v72
v_mfma_f32_16x16x32_bf16 v[64:67], a[40:43], a[200:203], v[64:67]
buffer_store_dwordx4 v[160:163], v12, s[16:19], s62 offen offset:0 sc0 sc1
v_mfma_f32_16x16x32_bf16 v[64:67], a[44:47], a[204:207], v[64:67]
v_exp_f32 v73, v73
v_mfma_f32_16x16x32_bf16 v[68:71], a[48:51], a[192:195], 0
ds_read_b64_tr_b16 a[114:115], v7 offset:19104
v_cvt_pk_bf16_f32 v84, v72, v73
v_mfma_f32_16x16x32_bf16 v[68:71], a[52:55], a[196:199], v[68:71]
v_exp_f32 v74, v74
v_mfma_f32_16x16x32_bf16 v[68:71], a[56:59], a[200:203], v[68:71]
ds_read_b64_tr_b16 a[116:117], v7 offset:14984
ds_read_b64_tr_b16 a[118:119], v7 offset:19112
v_mfma_f32_16x16x32_bf16 v[68:71], a[60:63], a[204:207], v[68:71]
v_exp_f32 v75, v75
v_mfma_f32_16x16x32_bf16 v[96:99], a[64:67], v[80:83], v[96:99]
v_cvt_pk_bf16_f32 v85, v74, v75
v_mul_f32 v168, v91, v168
v_mfma_f32_16x16x32_bf16 v[100:103], a[68:71], v[80:83], v[100:103]
v_exp_f32 v76, v76
v_mfma_f32_16x16x32_bf16 v[104:107], a[72:75], v[80:83], v[104:107]
ds_read_b64_tr_b16 a[120:121], v8 offset:14976
ds_read_b64_tr_b16 a[122:123], v8 offset:19104
v_mfma_f32_16x16x32_bf16 v[108:111], a[76:79], v[80:83], v[108:111]
v_exp_f32 v77, v77
v_mfma_f32_16x16x32_bf16 v[112:115], a[80:83], v[80:83], v[112:115]
ds_read_b64_tr_b16 a[124:125], v8 offset:14984
v_cvt_pk_bf16_f32 v86, v76, v77
v_mfma_f32_16x16x32_bf16 v[116:119], a[84:87], v[80:83], v[116:119]
v_exp_f32 v78, v78
v_mfma_f32_16x16x32_bf16 v[120:123], a[88:91], v[80:83], v[120:123]
ds_read_b64_tr_b16 a[126:127], v8 offset:19112
v_mul_f32 v169, v91, v169
v_mfma_f32_16x16x32_bf16 v[124:127], a[92:95], v[80:83], v[124:127]
v_exp_f32 v79, v79
v_mfma_f32_16x16x32_bf16 a[208:211], a[228:231], v[80:83], a[208:211]
v_cvt_pk_bf16_f32 v87, v78, v79
v_mul_f32 v170, v91, v170
v_mfma_f32_16x16x32_bf16 v[72:75], a[32:35], v[16:19], 0
v_mul_f32 v171, v91, v171
v_mul_f32 v172, v91, v172
v_mfma_f32_16x16x32_bf16 v[72:75], a[36:39], v[20:23], v[72:75]
v_exp_f32 v64, v64
v_mfma_f32_16x16x32_bf16 v[72:75], a[40:43], v[24:27], v[72:75]
v_mul_f32 v173, v91, v173
v_mul_f32 v174, v91, v174
v_mfma_f32_16x16x32_bf16 v[72:75], a[44:47], v[28:31], v[72:75]
v_exp_f32 v65, v65
v_mfma_f32_16x16x32_bf16 v[76:79], a[48:51], v[16:19], 0
v_cvt_pk_bf16_f32 v80, v64, v65
v_mul_f32 v175, v91, v175
v_mfma_f32_16x16x32_bf16 v[76:79], a[52:55], v[20:23], v[76:79]
v_exp_f32 v66, v66
v_mfma_f32_16x16x32_bf16 v[76:79], a[56:59], v[24:27], v[76:79]
v_cvt_pk_bf16_f32 v168, v168, v169
v_cvt_pk_bf16_f32 v169, v170, v171
v_mfma_f32_16x16x32_bf16 v[76:79], a[60:63], v[28:31], v[76:79]
s_waitcnt lgkmcnt(0)
v_exp_f32 v67, v67
v_mfma_f32_16x16x32_bf16 v[192:195], a[96:99], v[84:87], v[192:195]
ds_read_b128 a[0:3], v1 offset:32768
v_cvt_pk_bf16_f32 v81, v66, v67
v_mfma_f32_16x16x32_bf16 v[196:199], a[100:103], v[84:87], v[196:199]
v_exp_f32 v68, v68
v_mfma_f32_16x16x32_bf16 v[200:203], a[104:107], v[84:87], v[200:203]
ds_read_b128 a[4:7], v2 offset:32768
ds_read_b128 a[8:11], v3 offset:32768
v_mfma_f32_16x16x32_bf16 v[204:207], a[108:111], v[84:87], v[204:207]
v_exp_f32 v69, v69
v_mfma_f32_16x16x32_bf16 v[208:211], a[112:115], v[84:87], v[208:211]
v_cvt_pk_bf16_f32 v82, v68, v69
v_cvt_pk_bf16_f32 v170, v172, v173
v_mfma_f32_16x16x32_bf16 v[212:215], a[116:119], v[84:87], v[212:215]
v_exp_f32 v70, v70
v_mfma_f32_16x16x32_bf16 v[216:219], a[120:123], v[84:87], v[216:219]
ds_read_b128 a[12:15], v4 offset:32768
ds_read_b128 a[16:19], v1 offset:36864
v_mfma_f32_16x16x32_bf16 v[220:223], a[124:127], v[84:87], v[220:223]
v_exp_f32 v71, v71
v_mfma_f32_16x16x32_bf16 a[220:223], a[228:231], v[84:87], a[220:223]
ds_read_b128 a[20:23], v2 offset:36864
v_cvt_pk_bf16_f32 v83, v70, v71
v_mfma_f32_16x16x32_bf16 v[64:67], a[32:35], v[32:35], 0
ds_read_b128 a[24:27], v3 offset:36864
v_cvt_pk_bf16_f32 v171, v174, v175
v_mfma_f32_16x16x32_bf16 v[64:67], a[36:39], v[36:39], v[64:67]
v_exp_f32 v72, v72
v_mfma_f32_16x16x32_bf16 v[64:67], a[40:43], v[40:43], v[64:67]
ds_read_b128 a[28:31], v4 offset:36864
ds_read_b64_tr_b16 a[64:65], v5 offset:56256
v_mfma_f32_16x16x32_bf16 v[64:67], a[44:47], v[44:47], v[64:67]
v_exp_f32 v73, v73
v_mfma_f32_16x16x32_bf16 v[68:71], a[48:51], v[32:35], 0
ds_read_b64_tr_b16 a[66:67], v5 offset:60384
v_cvt_pk_bf16_f32 v84, v72, v73
v_mfma_f32_16x16x32_bf16 v[68:71], a[52:55], v[36:39], v[68:71]
v_exp_f32 v74, v74
v_mfma_f32_16x16x32_bf16 v[68:71], a[56:59], v[40:43], v[68:71]
buffer_store_dwordx4 v[168:171], v12, s[16:19], s62 offen offset:64 sc0 sc1
v_mfma_f32_16x16x32_bf16 v[68:71], a[60:63], v[44:47], v[68:71]
v_exp_f32 v75, v75
v_mfma_f32_16x16x32_bf16 v[224:227], a[96:99], v[80:83], v[224:227]
v_cvt_pk_bf16_f32 v85, v74, v75
v_mul_f32 v176, v91, v176
v_mfma_f32_16x16x32_bf16 v[228:231], a[100:103], v[80:83], v[228:231]
v_exp_f32 v76, v76
v_mfma_f32_16x16x32_bf16 v[232:235], a[104:107], v[80:83], v[232:235]
v_mul_f32 v177, v91, v177
v_mul_f32 v178, v91, v178
v_mfma_f32_16x16x32_bf16 v[236:239], a[108:111], v[80:83], v[236:239]
v_exp_f32 v77, v77
v_mfma_f32_16x16x32_bf16 v[240:243], a[112:115], v[80:83], v[240:243]
v_cvt_pk_bf16_f32 v86, v76, v77
v_mul_f32 v179, v91, v179
v_mfma_f32_16x16x32_bf16 v[244:247], a[116:119], v[80:83], v[244:247]
v_exp_f32 v78, v78
v_mfma_f32_16x16x32_bf16 v[248:251], a[120:123], v[80:83], v[248:251]
v_mul_f32 v180, v91, v180
v_mul_f32 v181, v91, v181
v_mfma_f32_16x16x32_bf16 v[252:255], a[124:127], v[80:83], v[252:255]
v_exp_f32 v79, v79
v_mfma_f32_16x16x32_bf16 a[224:227], a[228:231], v[80:83], a[224:227]
s_waitcnt lgkmcnt(0)
v_cvt_pk_bf16_f32 v87, v78, v79
v_mul_f32 v182, v91, v182
v_mfma_f32_16x16x32_bf16 v[72:75], a[0:3], a[176:179], 0
v_mul_f32 v183, v91, v183
v_cvt_pk_bf16_f32 v176, v176, v177
v_mfma_f32_16x16x32_bf16 v[72:75], a[4:7], a[180:183], v[72:75]
v_exp_f32 v64, v64
v_mfma_f32_16x16x32_bf16 v[72:75], a[8:11], a[184:187], v[72:75]
v_cvt_pk_bf16_f32 v177, v178, v179
v_cvt_pk_bf16_f32 v178, v180, v181
v_mfma_f32_16x16x32_bf16 v[72:75], a[12:15], a[188:191], v[72:75]
v_exp_f32 v65, v65
v_mfma_f32_16x16x32_bf16 v[76:79], a[16:19], a[176:179], 0
ds_read_b64_tr_b16 a[68:69], v5 offset:56264
v_cvt_pk_bf16_f32 v80, v64, v65
v_mfma_f32_16x16x32_bf16 v[76:79], a[20:23], a[180:183], v[76:79]
v_exp_f32 v66, v66
v_mfma_f32_16x16x32_bf16 v[76:79], a[24:27], a[184:187], v[76:79]
ds_read_b64_tr_b16 a[70:71], v5 offset:60392
v_cvt_pk_bf16_f32 v179, v182, v183
v_mfma_f32_16x16x32_bf16 v[76:79], a[28:31], a[188:191], v[76:79]
v_exp_f32 v67, v67
v_mfma_f32_16x16x32_bf16 v[96:99], a[96:99], v[84:87], v[96:99]
ds_read_b64_tr_b16 a[72:73], v6 offset:56256
v_cvt_pk_bf16_f32 v81, v66, v67
v_mfma_f32_16x16x32_bf16 v[100:103], a[100:103], v[84:87], v[100:103]
v_exp_f32 v68, v68
v_mfma_f32_16x16x32_bf16 v[104:107], a[104:107], v[84:87], v[104:107]
ds_read_b64_tr_b16 a[74:75], v6 offset:60384
ds_read_b64_tr_b16 a[76:77], v6 offset:56264
v_mfma_f32_16x16x32_bf16 v[108:111], a[108:111], v[84:87], v[108:111]
v_exp_f32 v69, v69
v_mfma_f32_16x16x32_bf16 v[112:115], a[112:115], v[84:87], v[112:115]
ds_read_b64_tr_b16 a[78:79], v6 offset:60392
v_cvt_pk_bf16_f32 v82, v68, v69
v_mfma_f32_16x16x32_bf16 v[116:119], a[116:119], v[84:87], v[116:119]
v_exp_f32 v70, v70
v_mfma_f32_16x16x32_bf16 v[120:123], a[120:123], v[84:87], v[120:123]
ds_read_b64_tr_b16 a[80:81], v7 offset:56256
ds_read_b64_tr_b16 a[82:83], v7 offset:60384
v_mfma_f32_16x16x32_bf16 v[124:127], a[124:127], v[84:87], v[124:127]
v_exp_f32 v71, v71
v_mfma_f32_16x16x32_bf16 a[208:211], a[228:231], v[84:87], a[208:211]
ds_read_b64_tr_b16 a[84:85], v7 offset:56264
v_cvt_pk_bf16_f32 v83, v70, v71
v_mfma_f32_16x16x32_bf16 v[64:67], a[0:3], a[192:195], 0
ds_read_b64_tr_b16 a[86:87], v7 offset:60392
ds_read_b64_tr_b16 a[88:89], v8 offset:56256
v_mfma_f32_16x16x32_bf16 v[64:67], a[4:7], a[196:199], v[64:67]
v_exp_f32 v72, v72
v_mfma_f32_16x16x32_bf16 v[64:67], a[8:11], a[200:203], v[64:67]
ds_read_b64_tr_b16 a[90:91], v8 offset:60384
ds_read_b64_tr_b16 a[92:93], v8 offset:56264
v_mfma_f32_16x16x32_bf16 v[64:67], a[12:15], a[204:207], v[64:67]
v_exp_f32 v73, v73
v_mfma_f32_16x16x32_bf16 v[68:71], a[16:19], a[192:195], 0
ds_read_b64_tr_b16 a[94:95], v8 offset:60392
v_cvt_pk_bf16_f32 v84, v72, v73
v_mfma_f32_16x16x32_bf16 v[68:71], a[20:23], a[196:199], v[68:71]
v_exp_f32 v74, v74
v_mfma_f32_16x16x32_bf16 v[68:71], a[24:27], a[200:203], v[68:71]
buffer_store_dwordx4 v[176:179], v12, s[16:19], s62 offen offset:128 sc0 sc1
v_mfma_f32_16x16x32_bf16 v[68:71], a[28:31], a[204:207], v[68:71]
v_exp_f32 v75, v75
v_mfma_f32_16x16x32_bf16 v[128:131], a[96:99], v[80:83], 0
v_cvt_pk_bf16_f32 v85, v74, v75
v_mul_f32 v184, v91, v184
v_mfma_f32_16x16x32_bf16 v[132:135], a[100:103], v[80:83], 0
v_exp_f32 v76, v76
v_mfma_f32_16x16x32_bf16 v[136:139], a[104:107], v[80:83], 0
v_mul_f32 v185, v91, v185
v_mul_f32 v186, v91, v186
v_mfma_f32_16x16x32_bf16 v[140:143], a[108:111], v[80:83], 0
v_exp_f32 v77, v77
v_mfma_f32_16x16x32_bf16 v[144:147], a[112:115], v[80:83], 0
v_cvt_pk_bf16_f32 v86, v76, v77
v_mul_f32 v187, v91, v187
v_mfma_f32_16x16x32_bf16 v[148:151], a[116:119], v[80:83], 0
v_exp_f32 v78, v78
v_mfma_f32_16x16x32_bf16 v[152:155], a[120:123], v[80:83], 0
v_mul_f32 v188, v91, v188
v_mul_f32 v189, v91, v189
v_mfma_f32_16x16x32_bf16 v[156:159], a[124:127], v[80:83], 0
v_exp_f32 v79, v79
v_mfma_f32_16x16x32_bf16 a[212:215], a[228:231], v[80:83], 0
v_cvt_pk_bf16_f32 v87, v78, v79
v_mul_f32 v190, v91, v190
v_mfma_f32_16x16x32_bf16 v[72:75], a[0:3], v[16:19], 0
v_mul_f32 v191, v91, v191
v_cvt_pk_bf16_f32 v184, v184, v185
v_mfma_f32_16x16x32_bf16 v[72:75], a[4:7], v[20:23], v[72:75]
v_exp_f32 v64, v64
v_mfma_f32_16x16x32_bf16 v[72:75], a[8:11], v[24:27], v[72:75]
ds_read_b128 a[32:35], v1 offset:40960
ds_read_b128 a[36:39], v2 offset:40960
v_mfma_f32_16x16x32_bf16 v[72:75], a[12:15], v[28:31], v[72:75]
v_exp_f32 v65, v65
v_mfma_f32_16x16x32_bf16 v[76:79], a[16:19], v[16:19], 0
v_cvt_pk_bf16_f32 v80, v64, v65
v_cvt_pk_bf16_f32 v185, v186, v187
v_mfma_f32_16x16x32_bf16 v[76:79], a[20:23], v[20:23], v[76:79]
v_exp_f32 v66, v66
v_mfma_f32_16x16x32_bf16 v[76:79], a[24:27], v[24:27], v[76:79]
ds_read_b128 a[40:43], v3 offset:40960
ds_read_b128 a[44:47], v4 offset:40960
v_mfma_f32_16x16x32_bf16 v[76:79], a[28:31], v[28:31], v[76:79]
v_exp_f32 v67, v67
v_mfma_f32_16x16x32_bf16 v[192:195], a[64:67], v[84:87], v[192:195]
s_waitcnt lgkmcnt(2)
v_cvt_pk_bf16_f32 v81, v66, v67
v_cvt_pk_bf16_f32 v186, v188, v189
v_mfma_f32_16x16x32_bf16 v[196:199], a[68:71], v[84:87], v[196:199]
v_exp_f32 v68, v68
v_mfma_f32_16x16x32_bf16 v[200:203], a[72:75], v[84:87], v[200:203]
ds_read_b128 a[48:51], v1 offset:45056
ds_read_b128 a[52:55], v2 offset:45056
v_mfma_f32_16x16x32_bf16 v[204:207], a[76:79], v[84:87], v[204:207]
v_exp_f32 v69, v69
v_mfma_f32_16x16x32_bf16 v[208:211], a[80:83], v[84:87], v[208:211]
ds_read_b128 a[56:59], v3 offset:45056
v_cvt_pk_bf16_f32 v82, v68, v69
v_mfma_f32_16x16x32_bf16 v[212:215], a[84:87], v[84:87], v[212:215]
v_exp_f32 v70, v70
v_mfma_f32_16x16x32_bf16 v[216:219], a[88:91], v[84:87], v[216:219]
s_add_u32 s26, s22, 65536
s_waitcnt vmcnt(4)
ds_write_b32 v0, v92
v_cvt_pk_bf16_f32 v187, v190, v191
v_mfma_f32_16x16x32_bf16 v[220:223], a[92:95], v[84:87], v[220:223]
s_addc_u32 s27, s23, 0
v_exp_f32 v71, v71
v_mfma_f32_16x16x32_bf16 a[220:223], a[228:231], v[84:87], a[220:223]
s_add_u32 m0, s30, 105024
ds_read_b128 a[60:63], v4 offset:45056
v_cvt_pk_bf16_f32 v83, v70, v71
v_mfma_f32_16x16x32_bf16 v[64:67], a[0:3], v[32:35], 0
ds_read_b128 a[0:3], v1 offset:49152
v_mfma_f32_16x16x32_bf16 v[64:67], a[4:7], v[36:39], v[64:67]
v_exp_f32 v72, v72
v_mfma_f32_16x16x32_bf16 v[64:67], a[8:11], v[40:43], v[64:67]
global_load_lds_dwordx4 v11, s[26:27] offset:0
v_mfma_f32_16x16x32_bf16 v[64:67], a[12:15], v[44:47], v[64:67]
v_exp_f32 v73, v73
v_mfma_f32_16x16x32_bf16 v[68:71], a[16:19], v[32:35], 0
ds_read_b128 a[4:7], v2 offset:49152
v_cvt_pk_bf16_f32 v84, v72, v73
v_mfma_f32_16x16x32_bf16 v[68:71], a[20:23], v[36:39], v[68:71]
s_add_u32 m0, s30, 105032
v_exp_f32 v74, v74
v_mfma_f32_16x16x32_bf16 v[68:71], a[24:27], v[40:43], v[68:71]
buffer_store_dwordx4 v[184:187], v12, s[16:19], s62 offen offset:192 sc0 sc1
v_mfma_f32_16x16x32_bf16 v[68:71], a[28:31], v[44:47], v[68:71]
v_exp_f32 v75, v75
v_mfma_f32_16x16x32_bf16 v[224:227], a[64:67], v[80:83], v[224:227]
ds_read_b128 a[8:11], v3 offset:49152
v_cvt_pk_bf16_f32 v85, v74, v75
v_mfma_f32_16x16x32_bf16 v[228:231], a[68:71], v[80:83], v[228:231]
v_exp_f32 v76, v76
v_mfma_f32_16x16x32_bf16 v[232:235], a[72:75], v[80:83], v[232:235]
ds_read_b32 v93, v90
ds_read_b128 a[12:15], v4 offset:49152
v_mfma_f32_16x16x32_bf16 v[236:239], a[76:79], v[80:83], v[236:239]
v_exp_f32 v77, v77
v_mfma_f32_16x16x32_bf16 v[240:243], a[80:83], v[80:83], v[240:243]
global_load_lds_dwordx4 v11, s[26:27] offset:1024
v_cvt_pk_bf16_f32 v86, v76, v77
v_mfma_f32_16x16x32_bf16 v[244:247], a[84:87], v[80:83], v[244:247]
v_exp_f32 v78, v78
v_mfma_f32_16x16x32_bf16 v[248:251], a[88:91], v[80:83], v[248:251]
s_add_u32 s26, s22, 73728
ds_read_b128 a[16:19], v1 offset:53248
ds_read_b128 a[20:23], v2 offset:53248
v_mfma_f32_16x16x32_bf16 v[252:255], a[92:95], v[80:83], v[252:255]
s_addc_u32 s27, s23, 0
v_exp_f32 v79, v79
v_mfma_f32_16x16x32_bf16 a[224:227], a[228:231], v[80:83], a[224:227]
s_add_u32 m0, s30, 154560
s_waitcnt lgkmcnt(3)
v_cmp_gt_u32 vcc, v92, v93
v_cvt_pk_bf16_f32 v87, v78, v79
v_mfma_f32_16x16x32_bf16 v[72:75], a[32:35], a[176:179], 0
s_cbranch_vccnz L_r21
L_b21:
ds_read_b128 a[24:27], v3 offset:53248
v_add_u32 v92, 1, v92
v_mfma_f32_16x16x32_bf16 v[72:75], a[36:39], a[180:183], v[72:75]
v_exp_f32 v64, v64
v_mfma_f32_16x16x32_bf16 v[72:75], a[40:43], a[184:187], v[72:75]
global_load_lds_dwordx4 v11, s[26:27] offset:0
v_mfma_f32_16x16x32_bf16 v[72:75], a[44:47], a[188:191], v[72:75]
v_exp_f32 v65, v65
v_mfma_f32_16x16x32_bf16 v[76:79], a[48:51], a[176:179], 0
ds_read_b64_tr_b16 a[96:97], v5 offset:31488
v_cvt_pk_bf16_f32 v80, v64, v65
v_mfma_f32_16x16x32_bf16 v[76:79], a[52:55], a[180:183], v[76:79]
s_add_u32 m0, s30, 154568
v_exp_f32 v66, v66
v_mfma_f32_16x16x32_bf16 v[76:79], a[56:59], a[184:187], v[76:79]
ds_read_b64_tr_b16 a[98:99], v5 offset:35616
ds_read_b64_tr_b16 a[100:101], v5 offset:31496
v_mfma_f32_16x16x32_bf16 v[76:79], a[60:63], a[188:191], v[76:79]
v_exp_f32 v67, v67
v_mfma_f32_16x16x32_bf16 v[96:99], a[64:67], v[84:87], v[96:99]
ds_read_b64_tr_b16 a[102:103], v5 offset:35624
v_cvt_pk_bf16_f32 v81, v66, v67
v_mfma_f32_16x16x32_bf16 v[100:103], a[68:71], v[84:87], v[100:103]
v_exp_f32 v68, v68
v_mfma_f32_16x16x32_bf16 v[104:107], a[72:75], v[84:87], v[104:107]
global_load_lds_dwordx4 v11, s[26:27] offset:1024
v_mfma_f32_16x16x32_bf16 v[108:111], a[76:79], v[84:87], v[108:111]
v_exp_f32 v69, v69
v_mfma_f32_16x16x32_bf16 v[112:115], a[80:83], v[84:87], v[112:115]
ds_read_b64_tr_b16 a[104:105], v6 offset:31488
v_cvt_pk_bf16_f32 v82, v68, v69
v_mfma_f32_16x16x32_bf16 v[116:119], a[84:87], v[84:87], v[116:119]
v_exp_f32 v70, v70
v_mfma_f32_16x16x32_bf16 v[120:123], a[88:91], v[84:87], v[120:123]
ds_read_b64_tr_b16 a[106:107], v6 offset:35616
ds_read_b64_tr_b16 a[108:109], v6 offset:31496
v_mfma_f32_16x16x32_bf16 v[124:127], a[92:95], v[84:87], v[124:127]
v_exp_f32 v71, v71
v_mfma_f32_16x16x32_bf16 a[208:211], a[228:231], v[84:87], a[208:211]
ds_read_b64_tr_b16 a[110:111], v6 offset:35624
v_cvt_pk_bf16_f32 v83, v70, v71
v_mfma_f32_16x16x32_bf16 v[64:67], a[32:35], a[192:195], 0
ds_read_b64_tr_b16 a[112:113], v7 offset:31488
ds_read_b64_tr_b16 a[114:115], v7 offset:35616
v_mfma_f32_16x16x32_bf16 v[64:67], a[36:39], a[196:199], v[64:67]
v_exp_f32 v72, v72
v_mfma_f32_16x16x32_bf16 v[64:67], a[40:43], a[200:203], v[64:67]
ds_read_b64_tr_b16 a[116:117], v7 offset:31496
ds_read_b64_tr_b16 a[118:119], v7 offset:35624
v_mfma_f32_16x16x32_bf16 v[64:67], a[44:47], a[204:207], v[64:67]
v_exp_f32 v73, v73
v_mfma_f32_16x16x32_bf16 v[68:71], a[48:51], a[192:195], 0
ds_read_b64_tr_b16 a[120:121], v8 offset:31488
v_cvt_pk_bf16_f32 v84, v72, v73
v_mfma_f32_16x16x32_bf16 v[68:71], a[52:55], a[196:199], v[68:71]
v_exp_f32 v74, v74
v_mfma_f32_16x16x32_bf16 v[68:71], a[56:59], a[200:203], v[68:71]
ds_read_b64_tr_b16 a[122:123], v8 offset:35616
ds_read_b64_tr_b16 a[124:125], v8 offset:31496
v_mfma_f32_16x16x32_bf16 v[68:71], a[60:63], a[204:207], v[68:71]
v_exp_f32 v75, v75
v_mfma_f32_16x16x32_bf16 v[128:131], a[64:67], v[80:83], v[128:131]
ds_read_b64_tr_b16 a[126:127], v8 offset:35624
v_cvt_pk_bf16_f32 v85, v74, v75
v_mfma_f32_16x16x32_bf16 v[132:135], a[68:71], v[80:83], v[132:135]
v_exp_f32 v76, v76
v_mfma_f32_16x16x32_bf16 v[136:139], a[72:75], v[80:83], v[136:139]
ds_read_b128 a[28:31], v4 offset:53248
ds_read_b64_tr_b16 a[64:65], v5 offset:23232
v_mfma_f32_16x16x32_bf16 v[140:143], a[76:79], v[80:83], v[140:143]
v_exp_f32 v77, v77
v_mfma_f32_16x16x32_bf16 v[144:147], a[80:83], v[80:83], v[144:147]
ds_read_b64_tr_b16 a[66:67], v5 offset:27360
v_cvt_pk_bf16_f32 v86, v76, v77
v_mfma_f32_16x16x32_bf16 v[148:151], a[84:87], v[80:83], v[148:151]
v_exp_f32 v78, v78
v_mfma_f32_16x16x32_bf16 v[152:155], a[88:91], v[80:83], v[152:155]
ds_read_b64_tr_b16 a[68:69], v5 offset:23240
ds_read_b64_tr_b16 a[70:71], v5 offset:27368
v_mfma_f32_16x16x32_bf16 v[156:159], a[92:95], v[80:83], v[156:159]
v_exp_f32 v79, v79
v_mfma_f32_16x16x32_bf16 a[212:215], a[228:231], v[80:83], a[212:215]
ds_read_b64_tr_b16 a[72:73], v6 offset:23232
v_cvt_pk_bf16_f32 v87, v78, v79
v_mfma_f32_16x16x32_bf16 v[72:75], a[32:35], v[16:19], 0
ds_read_b64_tr_b16 a[74:75], v6 offset:27360
ds_read_b64_tr_b16 a[76:77], v6 offset:23240
v_mfma_f32_16x16x32_bf16 v[72:75], a[36:39], v[20:23], v[72:75]
v_exp_f32 v64, v64
v_mfma_f32_16x16x32_bf16 v[72:75], a[40:43], v[24:27], v[72:75]
ds_read_b64_tr_b16 a[78:79], v6 offset:27368
ds_read_b64_tr_b16 a[80:81], v7 offset:23232
v_mfma_f32_16x16x32_bf16 v[72:75], a[44:47], v[28:31], v[72:75]
v_exp_f32 v65, v65
v_mfma_f32_16x16x32_bf16 v[76:79], a[48:51], v[16:19], 0
ds_read_b64_tr_b16 a[82:83], v7 offset:27360
v_cvt_pk_bf16_f32 v80, v64, v65
v_mfma_f32_16x16x32_bf16 v[76:79], a[52:55], v[20:23], v[76:79]
v_exp_f32 v66, v66
v_mfma_f32_16x16x32_bf16 v[76:79], a[56:59], v[24:27], v[76:79]
ds_read_b64_tr_b16 a[84:85], v7 offset:23240
ds_read_b64_tr_b16 a[86:87], v7 offset:27368
v_mfma_f32_16x16x32_bf16 v[76:79], a[60:63], v[28:31], v[76:79]
s_waitcnt lgkmcnt(11)
v_exp_f32 v67, v67
v_mfma_f32_16x16x32_bf16 v[192:195], a[96:99], v[84:87], v[192:195]
ds_read_b64_tr_b16 a[88:89], v8 offset:23232
v_cvt_pk_bf16_f32 v81, v66, v67
v_mfma_f32_16x16x32_bf16 v[196:199], a[100:103], v[84:87], v[196:199]
v_exp_f32 v68, v68
v_mfma_f32_16x16x32_bf16 v[200:203], a[104:107], v[84:87], v[200:203]
ds_read_b64_tr_b16 a[90:91], v8 offset:27360
ds_read_b64_tr_b16 a[92:93], v8 offset:23240
v_mfma_f32_16x16x32_bf16 v[204:207], a[108:111], v[84:87], v[204:207]
v_exp_f32 v69, v69
v_mfma_f32_16x16x32_bf16 v[208:211], a[112:115], v[84:87], v[208:211]
ds_read_b64_tr_b16 a[94:95], v8 offset:27368
v_cvt_pk_bf16_f32 v82, v68, v69
v_mfma_f32_16x16x32_bf16 v[212:215], a[116:119], v[84:87], v[212:215]
v_exp_f32 v70, v70
v_mfma_f32_16x16x32_bf16 v[216:219], a[120:123], v[84:87], v[216:219]
v_mfma_f32_16x16x32_bf16 v[220:223], a[124:127], v[84:87], v[220:223]
v_exp_f32 v71, v71
v_mfma_f32_16x16x32_bf16 a[220:223], a[228:231], v[84:87], a[220:223]
v_cvt_pk_bf16_f32 v83, v70, v71
v_mfma_f32_16x16x32_bf16 v[64:67], a[32:35], v[32:35], 0
ds_read_b128 a[32:35], v1 offset:57344
v_mfma_f32_16x16x32_bf16 v[64:67], a[36:39], v[36:39], v[64:67]
v_exp_f32 v72, v72
v_mfma_f32_16x16x32_bf16 v[64:67], a[40:43], v[40:43], v[64:67]
ds_read_b128 a[36:39], v2 offset:57344
ds_read_b128 a[40:43], v3 offset:57344
v_mfma_f32_16x16x32_bf16 v[64:67], a[44:47], v[44:47], v[64:67]
v_exp_f32 v73, v73
v_mfma_f32_16x16x32_bf16 v[68:71], a[48:51], v[32:35], 0
v_cvt_pk_bf16_f32 v84, v72, v73
v_accvgpr_read_b32 v91, a220
v_mfma_f32_16x16x32_bf16 v[68:71], a[52:55], v[36:39], v[68:71]
v_exp_f32 v74, v74
v_mfma_f32_16x16x32_bf16 v[68:71], a[56:59], v[40:43], v[68:71]
v_subrev_u32 v88, s36, v91
v_cmp_lt_u32 s[76:77], s33, v88
v_mfma_f32_16x16x32_bf16 v[68:71], a[60:63], v[44:47], v[68:71]
v_exp_f32 v75, v75
v_mfma_f32_16x16x32_bf16 v[224:227], a[96:99], v[80:83], v[224:227]
ds_read_b128 a[44:47], v4 offset:57344
v_cvt_pk_bf16_f32 v85, v74, v75
v_mfma_f32_16x16x32_bf16 v[228:231], a[100:103], v[80:83], v[228:231]
v_exp_f32 v76, v76
v_mfma_f32_16x16x32_bf16 v[232:235], a[104:107], v[80:83], v[232:235]
v_rcp_f32 v91, v91
v_mfma_f32_16x16x32_bf16 v[236:239], a[108:111], v[80:83], v[236:239]
v_exp_f32 v77, v77
v_mfma_f32_16x16x32_bf16 v[240:243], a[112:115], v[80:83], v[240:243]
v_cvt_pk_bf16_f32 v86, v76, v77
v_mul_f32 v192, v91, v192
v_mfma_f32_16x16x32_bf16 v[244:247], a[116:119], v[80:83], v[244:247]
v_exp_f32 v78, v78
v_mfma_f32_16x16x32_bf16 v[248:251], a[120:123], v[80:83], v[248:251]
v_mul_f32 v193, v91, v193
v_mul_f32 v194, v91, v194
v_mfma_f32_16x16x32_bf16 v[252:255], a[124:127], v[80:83], v[252:255]
v_exp_f32 v79, v79
v_mfma_f32_16x16x32_bf16 a[224:227], a[228:231], v[80:83], a[224:227]
v_cvt_pk_bf16_f32 v87, v78, v79
v_mul_f32 v195, v91, v195
v_mfma_f32_16x16x32_bf16 v[72:75], a[0:3], a[192:195], 0
v_mul_f32 v196, v91, v196
v_mul_f32 v197, v91, v197
v_mfma_f32_16x16x32_bf16 v[72:75], a[4:7], a[196:199], v[72:75]
v_exp_f32 v64, v64
v_mfma_f32_16x16x32_bf16 v[72:75], a[8:11], a[200:203], v[72:75]
v_mul_f32 v198, v91, v198
v_mul_f32 v199, v91, v199
v_mfma_f32_16x16x32_bf16 v[72:75], a[12:15], a[204:207], v[72:75]
v_exp_f32 v65, v65
v_mfma_f32_16x16x32_bf16 v[76:79], a[16:19], a[192:195], 0
v_cvt_pk_bf16_f32 v80, v64, v65
v_cvt_pk_bf16_f32 v192, v192, v193
v_mfma_f32_16x16x32_bf16 v[76:79], a[20:23], a[196:199], v[76:79]
v_exp_f32 v66, v66
v_mfma_f32_16x16x32_bf16 v[76:79], a[24:27], a[200:203], v[76:79]
v_cvt_pk_bf16_f32 v193, v194, v195
v_cvt_pk_bf16_f32 v194, v196, v197
v_mfma_f32_16x16x32_bf16 v[76:79], a[28:31], a[204:207], v[76:79]
v_exp_f32 v67, v67
v_mfma_f32_16x16x32_bf16 v[96:99], a[96:99], v[84:87], v[96:99]
v_cvt_pk_bf16_f32 v81, v66, v67
v_cvt_pk_bf16_f32 v195, v198, v199
v_mfma_f32_16x16x32_bf16 v[100:103], a[100:103], v[84:87], v[100:103]
v_exp_f32 v68, v68
v_mfma_f32_16x16x32_bf16 v[104:107], a[104:107], v[84:87], v[104:107]
ds_read_b128 a[48:51], v1 offset:61440
ds_read_b128 a[52:55], v2 offset:61440
v_mfma_f32_16x16x32_bf16 v[108:111], a[108:111], v[84:87], v[108:111]
v_exp_f32 v69, v69
v_mfma_f32_16x16x32_bf16 v[112:115], a[112:115], v[84:87], v[112:115]
ds_read_b128 a[56:59], v3 offset:61440
v_cvt_pk_bf16_f32 v82, v68, v69
v_mfma_f32_16x16x32_bf16 v[116:119], a[116:119], v[84:87], v[116:119]
v_exp_f32 v70, v70
v_mfma_f32_16x16x32_bf16 v[120:123], a[120:123], v[84:87], v[120:123]
ds_read_b128 a[60:63], v4 offset:61440
v_xor_b32 v1, 0x10000, v1
v_xor_b32 v2, 0x10000, v2
v_mfma_f32_16x16x32_bf16 v[124:127], a[124:127], v[84:87], v[124:127]
v_exp_f32 v71, v71
v_xor_b32 v3, 0x10000, v3
v_mfma_f32_16x16x32_bf16 a[208:211], a[228:231], v[84:87], a[208:211]
v_xor_b32 v4, 0x10000, v4
v_cvt_pk_bf16_f32 v83, v70, v71
v_mfma_f32_16x16x32_bf16 v[64:67], a[0:3], v[16:19], 0
v_mfma_f32_16x16x32_bf16 v[64:67], a[4:7], v[20:23], v[64:67]
v_exp_f32 v72, v72
v_mfma_f32_16x16x32_bf16 v[64:67], a[8:11], v[24:27], v[64:67]
v_mfma_f32_16x16x32_bf16 v[64:67], a[12:15], v[28:31], v[64:67]
v_exp_f32 v73, v73
v_mfma_f32_16x16x32_bf16 v[68:71], a[16:19], v[16:19], 0
v_cvt_pk_bf16_f32 v84, v72, v73
v_mfma_f32_16x16x32_bf16 v[68:71], a[20:23], v[20:23], v[68:71]
v_exp_f32 v74, v74
v_mfma_f32_16x16x32_bf16 v[68:71], a[24:27], v[24:27], v[68:71]
v_mfma_f32_16x16x32_bf16 v[68:71], a[28:31], v[28:31], v[68:71]
v_exp_f32 v75, v75
v_mfma_f32_16x16x32_bf16 v[128:131], a[96:99], v[80:83], v[128:131]
ds_read_b64_tr_b16 a[96:97], v5 offset:39744
v_cvt_pk_bf16_f32 v85, v74, v75
v_mfma_f32_16x16x32_bf16 v[132:135], a[100:103], v[80:83], v[132:135]
v_exp_f32 v76, v76
v_mfma_f32_16x16x32_bf16 v[136:139], a[104:107], v[80:83], v[136:139]
ds_read_b64_tr_b16 a[98:99], v5 offset:43872
ds_read_b64_tr_b16 a[100:101], v5 offset:39752
v_mfma_f32_16x16x32_bf16 v[140:143], a[108:111], v[80:83], v[140:143]
v_exp_f32 v77, v77
v_mfma_f32_16x16x32_bf16 v[144:147], a[112:115], v[80:83], v[144:147]
ds_read_b64_tr_b16 a[102:103], v5 offset:43880
v_cvt_pk_bf16_f32 v86, v76, v77
v_mfma_f32_16x16x32_bf16 v[148:151], a[116:119], v[80:83], v[148:151]
v_exp_f32 v78, v78
v_mfma_f32_16x16x32_bf16 v[152:155], a[120:123], v[80:83], v[152:155]
buffer_store_dwordx4 v[192:195], v12, s[16:19], s63 offen offset:0 sc0 sc1
v_mfma_f32_16x16x32_bf16 v[156:159], a[124:127], v[80:83], v[156:159]
v_exp_f32 v79, v79
v_mfma_f32_16x16x32_bf16 a[212:215], a[228:231], v[80:83], a[212:215]
v_cvt_pk_bf16_f32 v87, v78, v79
v_mul_f32 v200, v91, v200
v_mfma_f32_16x16x32_bf16 v[72:75], a[0:3], v[32:35], 0
v_mul_f32 v201, v91, v201
v_mul_f32 v202, v91, v202
v_mfma_f32_16x16x32_bf16 v[72:75], a[4:7], v[36:39], v[72:75]
v_exp_f32 v64, v64
v_mfma_f32_16x16x32_bf16 v[72:75], a[8:11], v[40:43], v[72:75]
v_mul_f32 v203, v91, v203
v_mul_f32 v204, v91, v204
v_mfma_f32_16x16x32_bf16 v[72:75], a[12:15], v[44:47], v[72:75]
v_exp_f32 v65, v65
v_mfma_f32_16x16x32_bf16 v[76:79], a[16:19], v[32:35], 0
v_cvt_pk_bf16_f32 v80, v64, v65
v_mul_f32 v205, v91, v205
v_mfma_f32_16x16x32_bf16 v[76:79], a[20:23], v[36:39], v[76:79]
v_exp_f32 v66, v66
v_mfma_f32_16x16x32_bf16 v[76:79], a[24:27], v[40:43], v[76:79]
v_mul_f32 v206, v91, v206
v_mul_f32 v207, v91, v207
v_mfma_f32_16x16x32_bf16 v[76:79], a[28:31], v[44:47], v[76:79]
s_waitcnt lgkmcnt(10)
v_exp_f32 v67, v67
v_mfma_f32_16x16x32_bf16 v[224:227], a[64:67], v[84:87], v[224:227]
v_cvt_pk_bf16_f32 v81, v66, v67
v_cvt_pk_bf16_f32 v200, v200, v201
v_mfma_f32_16x16x32_bf16 v[228:231], a[68:71], v[84:87], v[228:231]
v_exp_f32 v68, v68
v_mfma_f32_16x16x32_bf16 v[232:235], a[72:75], v[84:87], v[232:235]
v_cvt_pk_bf16_f32 v201, v202, v203
v_cvt_pk_bf16_f32 v202, v204, v205
v_mfma_f32_16x16x32_bf16 v[236:239], a[76:79], v[84:87], v[236:239]
v_exp_f32 v69, v69
v_mfma_f32_16x16x32_bf16 v[240:243], a[80:83], v[84:87], v[240:243]
v_cvt_pk_bf16_f32 v82, v68, v69
v_cvt_pk_bf16_f32 v203, v206, v207
v_mfma_f32_16x16x32_bf16 v[244:247], a[84:87], v[84:87], v[244:247]
v_exp_f32 v70, v70
v_mfma_f32_16x16x32_bf16 v[248:251], a[88:91], v[84:87], v[248:251]
ds_read_b64_tr_b16 a[104:105], v6 offset:39744
ds_read_b64_tr_b16 a[106:107], v6 offset:43872
v_mfma_f32_16x16x32_bf16 v[252:255], a[92:95], v[84:87], v[252:255]
v_exp_f32 v71, v71
v_mfma_f32_16x16x32_bf16 a[224:227], a[228:231], v[84:87], a[224:227]
ds_read_b64_tr_b16 a[108:109], v6 offset:39752
v_cvt_pk_bf16_f32 v83, v70, v71
v_mfma_f32_16x16x32_bf16 v[64:67], a[0:3], v[48:51], 0
ds_read_b64_tr_b16 a[110:111], v6 offset:43880
ds_read_b64_tr_b16 a[112:113], v7 offset:39744
v_mfma_f32_16x16x32_bf16 v[64:67], a[4:7], v[52:55], v[64:67]
v_exp_f32 v72, v72
v_mfma_f32_16x16x32_bf16 v[64:67], a[8:11], v[56:59], v[64:67]
ds_read_b64_tr_b16 a[114:115], v7 offset:43872
ds_read_b64_tr_b16 a[116:117], v7 offset:39752
v_mfma_f32_16x16x32_bf16 v[64:67], a[12:15], v[60:63], v[64:67]
v_exp_f32 v73, v73
v_mfma_f32_16x16x32_bf16 v[68:71], a[16:19], v[48:51], 0
ds_read_b64_tr_b16 a[118:119], v7 offset:43880
v_cvt_pk_bf16_f32 v84, v72, v73
v_mfma_f32_16x16x32_bf16 v[68:71], a[20:23], v[52:55], v[68:71]
v_exp_f32 v74, v74
v_mfma_f32_16x16x32_bf16 v[68:71], a[24:27], v[56:59], v[68:71]
ds_read_b64_tr_b16 a[120:121], v8 offset:39744
ds_read_b64_tr_b16 a[122:123], v8 offset:43872
v_mfma_f32_16x16x32_bf16 v[68:71], a[28:31], v[60:63], v[68:71]
v_exp_f32 v75, v75
v_mfma_f32_16x16x32_bf16 v[96:99], a[64:67], v[80:83], v[96:99]
ds_read_b64_tr_b16 a[124:125], v8 offset:39752
v_cvt_pk_bf16_f32 v85, v74, v75
v_mfma_f32_16x16x32_bf16 v[100:103], a[68:71], v[80:83], v[100:103]
v_exp_f32 v76, v76
v_mfma_f32_16x16x32_bf16 v[104:107], a[72:75], v[80:83], v[104:107]
buffer_store_dwordx4 v[200:203], v12, s[16:19], s63 offen offset:64 sc0 sc1
v_mfma_f32_16x16x32_bf16 v[108:111], a[76:79], v[80:83], v[108:111]
v_exp_f32 v77, v77
v_mfma_f32_16x16x32_bf16 v[112:115], a[80:83], v[80:83], v[112:115]
v_cvt_pk_bf16_f32 v86, v76, v77
v_mul_f32 v208, v91, v208
v_mfma_f32_16x16x32_bf16 v[116:119], a[84:87], v[80:83], v[116:119]
v_exp_f32 v78, v78
v_mfma_f32_16x16x32_bf16 v[120:123], a[88:91], v[80:83], v[120:123]
v_mul_f32 v209, v91, v209
v_mul_f32 v210, v91, v210
v_mfma_f32_16x16x32_bf16 v[124:127], a[92:95], v[80:83], v[124:127]
v_exp_f32 v79, v79
v_mfma_f32_16x16x32_bf16 a[208:211], a[228:231], v[80:83], a[208:211]
v_cvt_pk_bf16_f32 v87, v78, v79
v_mul_f32 v211, v91, v211
v_mfma_f32_16x16x32_bf16 v[72:75], a[32:35], a[192:195], 0
v_mul_f32 v212, v91, v212
v_mul_f32 v213, v91, v213
v_mfma_f32_16x16x32_bf16 v[72:75], a[36:39], a[196:199], v[72:75]
s_waitcnt lgkmcnt(4)
v_exp_f32 v64, v64
v_mfma_f32_16x16x32_bf16 v[72:75], a[40:43], a[200:203], v[72:75]
v_mul_f32 v214, v91, v214
v_mul_f32 v215, v91, v215
v_mfma_f32_16x16x32_bf16 v[72:75], a[44:47], a[204:207], v[72:75]
v_exp_f32 v65, v65
v_mfma_f32_16x16x32_bf16 v[76:79], a[48:51], a[192:195], 0
v_cvt_pk_bf16_f32 v80, v64, v65
v_cvt_pk_bf16_f32 v208, v208, v209
v_mfma_f32_16x16x32_bf16 v[76:79], a[52:55], a[196:199], v[76:79]
v_exp_f32 v66, v66
v_mfma_f32_16x16x32_bf16 v[76:79], a[56:59], a[200:203], v[76:79]
v_cvt_pk_bf16_f32 v209, v210, v211
v_cvt_pk_bf16_f32 v210, v212, v213
v_mfma_f32_16x16x32_bf16 v[76:79], a[60:63], a[204:207], v[76:79]
v_exp_f32 v67, v67
v_mfma_f32_16x16x32_bf16 v[128:131], a[64:67], v[84:87], v[128:131]
v_cvt_pk_bf16_f32 v81, v66, v67
v_cvt_pk_bf16_f32 v211, v214, v215
v_mfma_f32_16x16x32_bf16 v[132:135], a[68:71], v[84:87], v[132:135]
v_exp_f32 v68, v68
v_mfma_f32_16x16x32_bf16 v[136:139], a[72:75], v[84:87], v[136:139]
ds_read_b64_tr_b16 a[126:127], v8 offset:43880
ds_read_b128 a[0:3], v1 offset:0
v_mfma_f32_16x16x32_bf16 v[140:143], a[76:79], v[84:87], v[140:143]
v_exp_f32 v69, v69
v_mfma_f32_16x16x32_bf16 v[144:147], a[80:83], v[84:87], v[144:147]
ds_read_b128 a[4:7], v2 offset:0
v_cvt_pk_bf16_f32 v82, v68, v69
v_mfma_f32_16x16x32_bf16 v[148:151], a[84:87], v[84:87], v[148:151]
v_exp_f32 v70, v70
v_mfma_f32_16x16x32_bf16 v[152:155], a[88:91], v[84:87], v[152:155]
ds_read_b128 a[8:11], v3 offset:0
ds_read_b128 a[12:15], v4 offset:0
v_mfma_f32_16x16x32_bf16 v[156:159], a[92:95], v[84:87], v[156:159]
v_exp_f32 v71, v71
v_mfma_f32_16x16x32_bf16 a[212:215], a[228:231], v[84:87], a[212:215]
ds_read_b128 a[16:19], v1 offset:4096
v_cvt_pk_bf16_f32 v83, v70, v71
v_mfma_f32_16x16x32_bf16 v[64:67], a[32:35], v[16:19], 0
ds_read_b128 a[20:23], v2 offset:4096
ds_read_b128 a[24:27], v3 offset:4096
v_mfma_f32_16x16x32_bf16 v[64:67], a[36:39], v[20:23], v[64:67]
v_exp_f32 v72, v72
v_mfma_f32_16x16x32_bf16 v[64:67], a[40:43], v[24:27], v[64:67]
ds_read_b128 a[28:31], v4 offset:4096
v_mfma_f32_16x16x32_bf16 v[64:67], a[44:47], v[28:31], v[64:67]
v_exp_f32 v73, v73
v_mfma_f32_16x16x32_bf16 v[68:71], a[48:51], v[16:19], 0
v_cvt_pk_bf16_f32 v84, v72, v73
v_mfma_f32_16x16x32_bf16 v[68:71], a[52:55], v[20:23], v[68:71]
v_exp_f32 v74, v74
v_mfma_f32_16x16x32_bf16 v[68:71], a[56:59], v[24:27], v[68:71]
v_mfma_f32_16x16x32_bf16 v[68:71], a[60:63], v[28:31], v[68:71]
v_exp_f32 v75, v75
v_mfma_f32_16x16x32_bf16 v[160:163], a[64:67], v[80:83], 0
buffer_store_dwordx4 v[208:211], v12, s[16:19], s63 offen offset:128 sc0 sc1
v_cvt_pk_bf16_f32 v85, v74, v75
v_mfma_f32_16x16x32_bf16 v[164:167], a[68:71], v[80:83], 0
v_exp_f32 v76, v76
v_mfma_f32_16x16x32_bf16 v[168:171], a[72:75], v[80:83], 0
v_mul_f32 v216, v91, v216
v_mul_f32 v217, v91, v217
v_mfma_f32_16x16x32_bf16 v[172:175], a[76:79], v[80:83], 0
v_exp_f32 v77, v77
v_mfma_f32_16x16x32_bf16 v[176:179], a[80:83], v[80:83], 0
v_cvt_pk_bf16_f32 v86, v76, v77
v_mul_f32 v218, v91, v218
v_mfma_f32_16x16x32_bf16 v[180:183], a[84:87], v[80:83], 0
v_exp_f32 v78, v78
v_mfma_f32_16x16x32_bf16 v[184:187], a[88:91], v[80:83], 0
v_mul_f32 v219, v91, v219
v_mul_f32 v220, v91, v220
v_mfma_f32_16x16x32_bf16 v[188:191], a[92:95], v[80:83], 0
v_exp_f32 v79, v79
v_mfma_f32_16x16x32_bf16 a[216:219], a[228:231], v[80:83], 0
v_cvt_pk_bf16_f32 v87, v78, v79
v_mul_f32 v221, v91, v221
v_mfma_f32_16x16x32_bf16 v[72:75], a[32:35], v[32:35], 0
v_mul_f32 v222, v91, v222
v_mul_f32 v223, v91, v223
v_mfma_f32_16x16x32_bf16 v[72:75], a[36:39], v[36:39], v[72:75]
v_exp_f32 v64, v64
v_mfma_f32_16x16x32_bf16 v[72:75], a[40:43], v[40:43], v[72:75]
v_cvt_pk_bf16_f32 v216, v216, v217
v_cvt_pk_bf16_f32 v217, v218, v219
v_mfma_f32_16x16x32_bf16 v[72:75], a[44:47], v[44:47], v[72:75]
v_exp_f32 v65, v65
v_mfma_f32_16x16x32_bf16 v[76:79], a[48:51], v[32:35], 0
v_cvt_pk_bf16_f32 v80, v64, v65
v_cvt_pk_bf16_f32 v218, v220, v221
v_mfma_f32_16x16x32_bf16 v[76:79], a[52:55], v[36:39], v[76:79]
v_exp_f32 v66, v66
v_mfma_f32_16x16x32_bf16 v[76:79], a[56:59], v[40:43], v[76:79]
v_cvt_pk_bf16_f32 v219, v222, v223
v_mfma_f32_16x16x32_bf16 v[76:79], a[60:63], v[44:47], v[76:79]
v_exp_f32 v67, v67
v_mfma_f32_16x16x32_bf16 v[224:227], a[96:99], v[84:87], v[224:227]
v_cvt_pk_bf16_f32 v81, v66, v67
v_mfma_f32_16x16x32_bf16 v[228:231], a[100:103], v[84:87], v[228:231]
v_exp_f32 v68, v68
v_mfma_f32_16x16x32_bf16 v[232:235], a[104:107], v[84:87], v[232:235]
v_mfma_f32_16x16x32_bf16 v[236:239], a[108:111], v[84:87], v[236:239]
v_exp_f32 v69, v69
v_mfma_f32_16x16x32_bf16 v[240:243], a[112:115], v[84:87], v[240:243]
s_waitcnt lgkmcnt(0)
v_cvt_pk_bf16_f32 v82, v68, v69
v_mfma_f32_16x16x32_bf16 v[244:247], a[116:119], v[84:87], v[244:247]
v_exp_f32 v70, v70
v_mfma_f32_16x16x32_bf16 v[248:251], a[120:123], v[84:87], v[248:251]
s_waitcnt vmcnt(3)
ds_write_b32 v0, v92
v_mfma_f32_16x16x32_bf16 v[252:255], a[124:127], v[84:87], v[252:255]
v_exp_f32 v71, v71
v_mfma_f32_16x16x32_bf16 a[224:227], a[228:231], v[84:87], a[224:227]
v_cvt_pk_bf16_f32 v83, v70, v71
v_mfma_f32_16x16x32_bf16 v[64:67], a[32:35], v[48:51], 0
ds_read_b128 a[32:35], v1 offset:8192
v_mfma_f32_16x16x32_bf16 v[64:67], a[36:39], v[52:55], v[64:67]
v_exp_f32 v72, v72
v_mfma_f32_16x16x32_bf16 v[64:67], a[40:43], v[56:59], v[64:67]
ds_read_b128 a[36:39], v2 offset:8192
ds_read_b128 a[40:43], v3 offset:8192
v_mfma_f32_16x16x32_bf16 v[64:67], a[44:47], v[60:63], v[64:67]
v_exp_f32 v73, v73
v_mfma_f32_16x16x32_bf16 v[68:71], a[48:51], v[48:51], 0
ds_read_b128 a[44:47], v4 offset:8192
v_cvt_pk_bf16_f32 v84, v72, v73
v_mfma_f32_16x16x32_bf16 v[68:71], a[52:55], v[52:55], v[68:71]
v_exp_f32 v74, v74
v_mfma_f32_16x16x32_bf16 v[68:71], a[56:59], v[56:59], v[68:71]
buffer_store_dwordx4 v[216:219], v12, s[16:19], s63 offen offset:192 sc0 sc1
v_mfma_f32_16x16x32_bf16 v[68:71], a[60:63], v[60:63], v[68:71]
v_exp_f32 v75, v75
v_mfma_f32_16x16x32_bf16 v[96:99], a[96:99], v[80:83], v[96:99]
ds_read_b128 a[48:51], v1 offset:12288
v_cvt_pk_bf16_f32 v85, v74, v75
v_mfma_f32_16x16x32_bf16 v[100:103], a[100:103], v[80:83], v[100:103]
v_exp_f32 v76, v76
v_mfma_f32_16x16x32_bf16 v[104:107], a[104:107], v[80:83], v[104:107]
ds_read_b32 v93, v90
ds_read_b128 a[52:55], v2 offset:12288
v_mfma_f32_16x16x32_bf16 v[108:111], a[108:111], v[80:83], v[108:111]
v_exp_f32 v77, v77
v_mfma_f32_16x16x32_bf16 v[112:115], a[112:115], v[80:83], v[112:115]
ds_read_b128 a[56:59], v3 offset:12288
v_cvt_pk_bf16_f32 v86, v76, v77
v_mfma_f32_16x16x32_bf16 v[116:119], a[116:119], v[80:83], v[116:119]
v_exp_f32 v78, v78
v_mfma_f32_16x16x32_bf16 v[120:123], a[120:123], v[80:83], v[120:123]
s_add_u32 s24, s20, 98304
ds_read_b128 a[60:63], v4 offset:12288
v_mfma_f32_16x16x32_bf16 v[124:127], a[124:127], v[80:83], v[124:127]
s_addc_u32 s25, s21, 0
v_exp_f32 v79, v79
v_mfma_f32_16x16x32_bf16 a[208:211], a[228:231], v[80:83], a[208:211]
s_add_u32 m0, s29, 49152
s_waitcnt lgkmcnt(3)
v_cmp_gt_u32 vcc, v92, v93
v_cvt_pk_bf16_f32 v87, v78, v79
v_mfma_f32_16x16x32_bf16 v[72:75], a[0:3], a[192:195], 0
s_cbranch_vccnz L_r24
L_b24:
v_add_u32 v92, 1, v92
v_mfma_f32_16x16x32_bf16 v[72:75], a[4:7], a[196:199], v[72:75]
v_exp_f32 v64, v64
v_mfma_f32_16x16x32_bf16 v[72:75], a[8:11], a[200:203], v[72:75]
global_load_lds_dwordx4 v9, s[24:25] offset:0
v_mfma_f32_16x16x32_bf16 v[72:75], a[12:15], a[204:207], v[72:75]
v_exp_f32 v65, v65
v_mfma_f32_16x16x32_bf16 v[76:79], a[16:19], a[192:195], 0
ds_read_b64_tr_b16 a[64:65], v5 offset:6720
v_cvt_pk_bf16_f32 v80, v64, v65
v_mfma_f32_16x16x32_bf16 v[76:79], a[20:23], a[196:199], v[76:79]
s_add_u32 m0, s29, 53248
v_exp_f32 v66, v66
v_mfma_f32_16x16x32_bf16 v[76:79], a[24:27], a[200:203], v[76:79]
ds_read_b64_tr_b16 a[66:67], v5 offset:10848
ds_read_b64_tr_b16 a[68:69], v5 offset:6728
v_mfma_f32_16x16x32_bf16 v[76:79], a[28:31], a[204:207], v[76:79]
v_exp_f32 v67, v67
v_mfma_f32_16x16x32_bf16 v[128:131], a[96:99], v[84:87], v[128:131]
ds_read_b64_tr_b16 a[70:71], v5 offset:10856
v_cvt_pk_bf16_f32 v81, v66, v67
v_mfma_f32_16x16x32_bf16 v[132:135], a[100:103], v[84:87], v[132:135]
v_exp_f32 v68, v68
v_mfma_f32_16x16x32_bf16 v[136:139], a[104:107], v[84:87], v[136:139]
global_load_lds_dwordx4 v10, s[24:25] offset:0
v_mfma_f32_16x16x32_bf16 v[140:143], a[108:111], v[84:87], v[140:143]
v_exp_f32 v69, v69
v_mfma_f32_16x16x32_bf16 v[144:147], a[112:115], v[84:87], v[144:147]
ds_read_b64_tr_b16 a[72:73], v6 offset:6720
v_cvt_pk_bf16_f32 v82, v68, v69
v_mfma_f32_16x16x32_bf16 v[148:151], a[116:119], v[84:87], v[148:151]
s_add_u32 s26, s22, 81920
v_exp_f32 v70, v70
v_mfma_f32_16x16x32_bf16 v[152:155], a[120:123], v[84:87], v[152:155]
s_addc_u32 s27, s23, 0
ds_read_b64_tr_b16 a[74:75], v6 offset:10848
ds_read_b64_tr_b16 a[76:77], v6 offset:6728
v_mfma_f32_16x16x32_bf16 v[156:159], a[124:127], v[84:87], v[156:159]
s_add_u32 m0, s30, 146304
v_exp_f32 v71, v71
v_mfma_f32_16x16x32_bf16 a[212:215], a[228:231], v[84:87], a[212:215]
ds_read_b64_tr_b16 a[78:79], v6 offset:10856
v_cvt_pk_bf16_f32 v83, v70, v71
v_mfma_f32_16x16x32_bf16 v[64:67], a[0:3], v[16:19], 0
global_load_lds_dwordx4 v11, s[26:27] offset:0
v_mfma_f32_16x16x32_bf16 v[64:67], a[4:7], v[20:23], v[64:67]
v_exp_f32 v72, v72
v_mfma_f32_16x16x32_bf16 v[64:67], a[8:11], v[24:27], v[64:67]
ds_read_b64_tr_b16 a[80:81], v7 offset:6720
ds_read_b64_tr_b16 a[82:83], v7 offset:10848
v_mfma_f32_16x16x32_bf16 v[64:67], a[12:15], v[28:31], v[64:67]
v_exp_f32 v73, v73
v_mfma_f32_16x16x32_bf16 v[68:71], a[16:19], v[16:19], 0
s_add_u32 m0, s30, 146312
ds_read_b64_tr_b16 a[84:85], v7 offset:6728
v_cvt_pk_bf16_f32 v84, v72, v73
v_mfma_f32_16x16x32_bf16 v[68:71], a[20:23], v[20:23], v[68:71]
v_exp_f32 v74, v74
v_mfma_f32_16x16x32_bf16 v[68:71], a[24:27], v[24:27], v[68:71]
ds_read_b64_tr_b16 a[86:87], v7 offset:10856
ds_read_b64_tr_b16 a[88:89], v8 offset:6720
v_mfma_f32_16x16x32_bf16 v[68:71], a[28:31], v[28:31], v[68:71]
v_exp_f32 v75, v75
v_mfma_f32_16x16x32_bf16 v[160:163], a[96:99], v[80:83], v[160:163]
ds_read_b64_tr_b16 a[90:91], v8 offset:10848
v_cvt_pk_bf16_f32 v85, v74, v75
v_mfma_f32_16x16x32_bf16 v[164:167], a[100:103], v[80:83], v[164:167]
v_exp_f32 v76, v76
v_mfma_f32_16x16x32_bf16 v[168:171], a[104:107], v[80:83], v[168:171]
global_load_lds_dwordx4 v11, s[26:27] offset:1024
v_mfma_f32_16x16x32_bf16 v[172:175], a[108:111], v[80:83], v[172:175]
v_exp_f32 v77, v77
v_mfma_f32_16x16x32_bf16 v[176:179], a[112:115], v[80:83], v[176:179]
s_add_u32 s26, s22, 90112
ds_read_b64_tr_b16 a[92:93], v8 offset:6728
v_cvt_pk_bf16_f32 v86, v76, v77
v_mfma_f32_16x16x32_bf16 v[180:183], a[116:119], v[80:83], v[180:183]
s_addc_u32 s27, s23, 0
v_exp_f32 v78, v78
v_mfma_f32_16x16x32_bf16 v[184:187], a[120:123], v[80:83], v[184:187]
s_add_u32 m0, s30, 113280
ds_read_b64_tr_b16 a[94:95], v8 offset:10856
ds_read_b64_tr_b16 a[96:97], v5 offset:56256
v_mfma_f32_16x16x32_bf16 v[188:191], a[124:127], v[80:83], v[188:191]
v_exp_f32 v79, v79
v_mfma_f32_16x16x32_bf16 a[216:219], a[228:231], v[80:83], a[216:219]
ds_read_b64_tr_b16 a[98:99], v5 offset:60384
v_cvt_pk_bf16_f32 v87, v78, v79
v_mfma_f32_16x16x32_bf16 v[72:75], a[0:3], v[32:35], 0
global_load_lds_dwordx4 v11, s[26:27] offset:0
v_mfma_f32_16x16x32_bf16 v[72:75], a[4:7], v[36:39], v[72:75]
s_add_u32 m0, s30, 113288
v_exp_f32 v64, v64
v_mfma_f32_16x16x32_bf16 v[72:75], a[8:11], v[40:43], v[72:75]
global_load_lds_dwordx4 v11, s[26:27] offset:1024
v_mfma_f32_16x16x32_bf16 v[72:75], a[12:15], v[44:47], v[72:75]
v_exp_f32 v65, v65
v_mfma_f32_16x16x32_bf16 v[76:79], a[16:19], v[32:35], 0
ds_read_b64_tr_b16 a[100:101], v5 offset:56264
v_cvt_pk_bf16_f32 v80, v64, v65
v_mfma_f32_16x16x32_bf16 v[76:79], a[20:23], v[36:39], v[76:79]
s_add_u32 s24, s20, 106496
v_exp_f32 v66, v66
v_mfma_f32_16x16x32_bf16 v[76:79], a[24:27], v[40:43], v[76:79]
s_addc_u32 s25, s21, 0
ds_read_b64_tr_b16 a[102:103], v5 offset:60392
ds_read_b64_tr_b16 a[104:105], v6 offset:56256
v_mfma_f32_16x16x32_bf16 v[76:79], a[28:31], v[44:47], v[76:79]
s_add_u32 m0, s29, 57344
v_exp_f32 v67, v67
s_waitcnt lgkmcnt(3)
v_mfma_f32_16x16x32_bf16 v[224:227], a[64:67], v[84:87], v[224:227]
ds_read_b64_tr_b16 a[106:107], v6 offset:60384
v_cvt_pk_bf16_f32 v81, v66, v67
v_mfma_f32_16x16x32_bf16 v[228:231], a[68:71], v[84:87], v[228:231]
v_exp_f32 v68, v68
v_mfma_f32_16x16x32_bf16 v[232:235], a[72:75], v[84:87], v[232:235]
global_load_lds_dwordx4 v9, s[24:25] offset:0
v_mfma_f32_16x16x32_bf16 v[236:239], a[76:79], v[84:87], v[236:239]
v_exp_f32 v69, v69
v_mfma_f32_16x16x32_bf16 v[240:243], a[80:83], v[84:87], v[240:243]
ds_read_b64_tr_b16 a[108:109], v6 offset:56264
v_cvt_pk_bf16_f32 v82, v68, v69
v_mfma_f32_16x16x32_bf16 v[244:247], a[84:87], v[84:87], v[244:247]
s_add_u32 m0, s29, 61440
v_exp_f32 v70, v70
v_mfma_f32_16x16x32_bf16 v[248:251], a[88:91], v[84:87], v[248:251]
ds_read_b64_tr_b16 a[110:111], v6 offset:60392
ds_read_b64_tr_b16 a[112:113], v7 offset:56256
v_mfma_f32_16x16x32_bf16 v[252:255], a[92:95], v[84:87], v[252:255]
v_exp_f32 v71, v71
v_mfma_f32_16x16x32_bf16 a[224:227], a[228:231], v[84:87], a[224:227]
ds_read_b64_tr_b16 a[114:115], v7 offset:60384
v_cvt_pk_bf16_f32 v83, v70, v71
v_mfma_f32_16x16x32_bf16 v[64:67], a[0:3], v[48:51], 0
global_load_lds_dwordx4 v10, s[24:25] offset:0
v_mfma_f32_16x16x32_bf16 v[64:67], a[4:7], v[52:55], v[64:67]
v_exp_f32 v72, v72
v_mfma_f32_16x16x32_bf16 v[64:67], a[8:11], v[56:59], v[64:67]
ds_read_b64_tr_b16 a[116:117], v7 offset:56264
ds_read_b64_tr_b16 a[118:119], v7 offset:60392
v_mfma_f32_16x16x32_bf16 v[64:67], a[12:15], v[60:63], v[64:67]
v_exp_f32 v73, v73
v_mfma_f32_16x16x32_bf16 v[68:71], a[16:19], v[48:51], 0
v_cvt_pk_bf16_f32 v84, v72, v73
v_accvgpr_read_b32 v91, a224
v_mfma_f32_16x16x32_bf16 v[68:71], a[20:23], v[52:55], v[68:71]
v_exp_f32 v74, v74
v_mfma_f32_16x16x32_bf16 v[68:71], a[24:27], v[56:59], v[68:71]
v_subrev_u32 v88, s36, v91
v_cmp_lt_u32 s[78:79], s33, v88
v_mfma_f32_16x16x32_bf16 v[68:71], a[28:31], v[60:63], v[68:71]
v_exp_f32 v75, v75
v_mfma_f32_16x16x32_bf16 v[96:99], a[64:67], v[80:83], v[96:99]
ds_read_b64_tr_b16 a[120:121], v8 offset:56256
v_cvt_pk_bf16_f32 v85, v74, v75
v_mfma_f32_16x16x32_bf16 v[100:103], a[68:71], v[80:83], v[100:103]
v_exp_f32 v76, v76
v_mfma_f32_16x16x32_bf16 v[104:107], a[72:75], v[80:83], v[104:107]
v_rcp_f32 v91, v91
v_mfma_f32_16x16x32_bf16 v[108:111], a[76:79], v[80:83], v[108:111]
v_exp_f32 v77, v77
v_mfma_f32_16x16x32_bf16 v[112:115], a[80:83], v[80:83], v[112:115]
v_cvt_pk_bf16_f32 v86, v76, v77
v_mul_f32 v224, v91, v224
v_mfma_f32_16x16x32_bf16 v[116:119], a[84:87], v[80:83], v[116:119]
v_exp_f32 v78, v78
v_mfma_f32_16x16x32_bf16 v[120:123], a[88:91], v[80:83], v[120:123]
ds_read_b64_tr_b16 a[122:123], v8 offset:60384
ds_read_b64_tr_b16 a[124:125], v8 offset:56264
v_mfma_f32_16x16x32_bf16 v[124:127], a[92:95], v[80:83], v[124:127]
v_exp_f32 v79, v79
v_mfma_f32_16x16x32_bf16 a[208:211], a[228:231], v[80:83], a[208:211]
ds_read_b64_tr_b16 a[126:127], v8 offset:60392
v_cvt_pk_bf16_f32 v87, v78, v79
v_mfma_f32_16x16x32_bf16 v[72:75], a[32:35], v[16:19], 0
v_mul_f32 v225, v91, v225
v_mul_f32 v226, v91, v226
v_mfma_f32_16x16x32_bf16 v[72:75], a[36:39], v[20:23], v[72:75]
v_exp_f32 v64, v64
v_mfma_f32_16x16x32_bf16 v[72:75], a[40:43], v[24:27], v[72:75]
ds_read_b128 a[0:3], v1 offset:16384
ds_read_b128 a[4:7], v2 offset:16384
v_mfma_f32_16x16x32_bf16 v[72:75], a[44:47], v[28:31], v[72:75]
v_exp_f32 v65, v65
v_mfma_f32_16x16x32_bf16 v[76:79], a[48:51], v[16:19], 0
ds_read_b128 a[8:11], v3 offset:16384
v_cvt_pk_bf16_f32 v80, v64, v65
v_mfma_f32_16x16x32_bf16 v[76:79], a[52:55], v[20:23], v[76:79]
v_exp_f32 v66, v66
v_mfma_f32_16x16x32_bf16 v[76:79], a[56:59], v[24:27], v[76:79]
ds_read_b128 a[12:15], v4 offset:16384
ds_read_b128 a[16:19], v1 offset:20480
v_mfma_f32_16x16x32_bf16 v[76:79], a[60:63], v[28:31], v[76:79]
v_exp_f32 v67, v67
v_mfma_f32_16x16x32_bf16 v[128:131], a[64:67], v[84:87], v[128:131]
ds_read_b128 a[20:23], v2 offset:20480
v_cvt_pk_bf16_f32 v81, v66, v67
v_mfma_f32_16x16x32_bf16 v[132:135], a[68:71], v[84:87], v[132:135]
v_exp_f32 v68, v68
v_mfma_f32_16x16x32_bf16 v[136:139], a[72:75], v[84:87], v[136:139]
ds_read_b128 a[24:27], v3 offset:20480
v_mul_f32 v227, v91, v227
v_mfma_f32_16x16x32_bf16 v[140:143], a[76:79], v[84:87], v[140:143]
v_exp_f32 v69, v69
v_mfma_f32_16x16x32_bf16 v[144:147], a[80:83], v[84:87], v[144:147]
ds_read_b128 a[28:31], v4 offset:20480
v_cvt_pk_bf16_f32 v82, v68, v69
v_mfma_f32_16x16x32_bf16 v[148:151], a[84:87], v[84:87], v[148:151]
v_exp_f32 v70, v70
v_mfma_f32_16x16x32_bf16 v[152:155], a[88:91], v[84:87], v[152:155]
v_mul_f32 v228, v91, v228
v_mul_f32 v229, v91, v229
v_mfma_f32_16x16x32_bf16 v[156:159], a[92:95], v[84:87], v[156:159]
v_exp_f32 v71, v71
v_mfma_f32_16x16x32_bf16 a[212:215], a[228:231], v[84:87], a[212:215]
v_cvt_pk_bf16_f32 v83, v70, v71
v_mul_f32 v230, v91, v230
v_mfma_f32_16x16x32_bf16 v[64:67], a[32:35], v[32:35], 0
v_mul_f32 v231, v91, v231
v_cvt_pk_bf16_f32 v224, v224, v225
v_mfma_f32_16x16x32_bf16 v[64:67], a[36:39], v[36:39], v[64:67]
v_exp_f32 v72, v72
v_mfma_f32_16x16x32_bf16 v[64:67], a[40:43], v[40:43], v[64:67]
v_cvt_pk_bf16_f32 v225, v226, v227
v_cvt_pk_bf16_f32 v226, v228, v229
v_mfma_f32_16x16x32_bf16 v[64:67], a[44:47], v[44:47], v[64:67]
v_exp_f32 v73, v73
v_mfma_f32_16x16x32_bf16 v[68:71], a[48:51], v[32:35], 0
v_cvt_pk_bf16_f32 v84, v72, v73
v_cvt_pk_bf16_f32 v227, v230, v231
v_mfma_f32_16x16x32_bf16 v[68:71], a[52:55], v[36:39], v[68:71]
v_exp_f32 v74, v74
v_mfma_f32_16x16x32_bf16 v[68:71], a[56:59], v[40:43], v[68:71]
v_mfma_f32_16x16x32_bf16 v[68:71], a[60:63], v[44:47], v[68:71]
v_exp_f32 v75, v75
v_mfma_f32_16x16x32_bf16 v[160:163], a[64:67], v[80:83], v[160:163]
v_cvt_pk_bf16_f32 v85, v74, v75
v_mfma_f32_16x16x32_bf16 v[164:167], a[68:71], v[80:83], v[164:167]
v_exp_f32 v76, v76
v_mfma_f32_16x16x32_bf16 v[168:171], a[72:75], v[80:83], v[168:171]
v_mfma_f32_16x16x32_bf16 v[172:175], a[76:79], v[80:83], v[172:175]
v_exp_f32 v77, v77
v_mfma_f32_16x16x32_bf16 v[176:179], a[80:83], v[80:83], v[176:179]
v_cvt_pk_bf16_f32 v86, v76, v77
v_mfma_f32_16x16x32_bf16 v[180:183], a[84:87], v[80:83], v[180:183]
v_exp_f32 v78, v78
v_mfma_f32_16x16x32_bf16 v[184:187], a[88:91], v[80:83], v[184:187]
v_mfma_f32_16x16x32_bf16 v[188:191], a[92:95], v[80:83], v[188:191]
v_exp_f32 v79, v79
v_mfma_f32_16x16x32_bf16 a[216:219], a[228:231], v[80:83], a[216:219]
v_cvt_pk_bf16_f32 v87, v78, v79
v_mfma_f32_16x16x32_bf16 v[72:75], a[32:35], v[48:51], 0
ds_read_b128 a[32:35], v1 offset:24576
v_mfma_f32_16x16x32_bf16 v[72:75], a[36:39], v[52:55], v[72:75]
v_exp_f32 v64, v64
v_mfma_f32_16x16x32_bf16 v[72:75], a[40:43], v[56:59], v[72:75]
ds_read_b128 a[36:39], v2 offset:24576
ds_read_b128 a[40:43], v3 offset:24576
v_mfma_f32_16x16x32_bf16 v[72:75], a[44:47], v[60:63], v[72:75]
s_waitcnt vmcnt(2)
ds_write_b32 v0, v92
v_exp_f32 v65, v65
v_mfma_f32_16x16x32_bf16 v[76:79], a[48:51], v[48:51], 0
ds_read_b128 a[44:47], v4 offset:24576
v_cvt_pk_bf16_f32 v80, v64, v65
v_mfma_f32_16x16x32_bf16 v[76:79], a[52:55], v[52:55], v[76:79]
v_exp_f32 v66, v66
v_mfma_f32_16x16x32_bf16 v[76:79], a[56:59], v[56:59], v[76:79]
ds_read_b128 a[48:51], v1 offset:28672
ds_read_b128 a[52:55], v2 offset:28672
v_mfma_f32_16x16x32_bf16 v[76:79], a[60:63], v[60:63], v[76:79]
v_exp_f32 v67, v67
v_mfma_f32_16x16x32_bf16 v[96:99], a[96:99], v[84:87], v[96:99]
ds_read_b128 a[56:59], v3 offset:28672
s_waitcnt lgkmcnt(12)
v_cvt_pk_bf16_f32 v81, v66, v67
v_mfma_f32_16x16x32_bf16 v[100:103], a[100:103], v[84:87], v[100:103]
v_exp_f32 v68, v68
v_mfma_f32_16x16x32_bf16 v[104:107], a[104:107], v[84:87], v[104:107]
ds_read_b32 v93, v90
ds_read_b128 a[60:63], v4 offset:28672
v_xor_b32 v1, 0x10000, v1
v_mfma_f32_16x16x32_bf16 v[108:111], a[108:111], v[84:87], v[108:111]
v_exp_f32 v69, v69
v_xor_b32 v2, 0x10000, v2
v_mfma_f32_16x16x32_bf16 v[112:115], a[112:115], v[84:87], v[112:115]
v_xor_b32 v3, 0x10000, v3
v_xor_b32 v4, 0x10000, v4
v_cvt_pk_bf16_f32 v82, v68, v69
v_mfma_f32_16x16x32_bf16 v[116:119], a[116:119], v[84:87], v[116:119]
v_exp_f32 v70, v70
v_mfma_f32_16x16x32_bf16 v[120:123], a[120:123], v[84:87], v[120:123]
s_add_u32 s24, s20, 114688
v_mfma_f32_16x16x32_bf16 v[124:127], a[124:127], v[84:87], v[124:127]
s_addc_u32 s25, s21, 0
v_exp_f32 v71, v71
v_mfma_f32_16x16x32_bf16 a[208:211], a[228:231], v[84:87], a[208:211]
s_add_u32 m0, s29, 65536
s_waitcnt lgkmcnt(1)
v_cmp_gt_u32 vcc, v92, v93
v_cvt_pk_bf16_f32 v83, v70, v71
v_mfma_f32_16x16x32_bf16 v[64:67], a[0:3], v[16:19], 0
s_cbranch_vccnz L_r26
L_b26:
v_add_u32 v92, 1, v92
v_mfma_f32_16x16x32_bf16 v[64:67], a[4:7], v[20:23], v[64:67]
v_exp_f32 v72, v72
v_mfma_f32_16x16x32_bf16 v[64:67], a[8:11], v[24:27], v[64:67]
global_load_lds_dwordx4 v9, s[24:25] offset:0
v_mfma_f32_16x16x32_bf16 v[64:67], a[12:15], v[28:31], v[64:67]
v_exp_f32 v73, v73
v_mfma_f32_16x16x32_bf16 v[68:71], a[16:19], v[16:19], 0
ds_read_b64_tr_b16 a[64:65], v5 offset:48000
v_cvt_pk_bf16_f32 v84, v72, v73
v_mfma_f32_16x16x32_bf16 v[68:71], a[20:23], v[20:23], v[68:71]
s_add_u32 m0, s29, 69632
v_exp_f32 v74, v74
v_mfma_f32_16x16x32_bf16 v[68:71], a[24:27], v[24:27], v[68:71]
ds_read_b64_tr_b16 a[66:67], v5 offset:52128
ds_read_b64_tr_b16 a[68:69], v5 offset:48008
v_mfma_f32_16x16x32_bf16 v[68:71], a[28:31], v[28:31], v[68:71]
v_exp_f32 v75, v75
v_mfma_f32_16x16x32_bf16 v[128:131], a[96:99], v[80:83], v[128:131]
ds_read_b64_tr_b16 a[70:71], v5 offset:52136
v_cvt_pk_bf16_f32 v85, v74, v75
v_mfma_f32_16x16x32_bf16 v[132:135], a[100:103], v[80:83], v[132:135]
v_exp_f32 v76, v76
v_mfma_f32_16x16x32_bf16 v[136:139], a[104:107], v[80:83], v[136:139]
global_load_lds_dwordx4 v10, s[24:25] offset:0
v_mfma_f32_16x16x32_bf16 v[140:143], a[108:111], v[80:83], v[140:143]
v_exp_f32 v77, v77
v_mfma_f32_16x16x32_bf16 v[144:147], a[112:115], v[80:83], v[144:147]
ds_read_b64_tr_b16 a[72:73], v6 offset:48000
v_cvt_pk_bf16_f32 v86, v76, v77
v_mfma_f32_16x16x32_bf16 v[148:151], a[116:119], v[80:83], v[148:151]
s_add_u32 s24, s20, 122880
v_exp_f32 v78, v78
v_mfma_f32_16x16x32_bf16 v[152:155], a[120:123], v[80:83], v[152:155]
s_addc_u32 s25, s21, 0
ds_read_b64_tr_b16 a[74:75], v6 offset:52128
ds_read_b64_tr_b16 a[76:77], v6 offset:48008
v_mfma_f32_16x16x32_bf16 v[156:159], a[124:127], v[80:83], v[156:159]
s_add_u32 m0, s29, 73728
v_exp_f32 v79, v79
v_mfma_f32_16x16x32_bf16 a[212:215], a[228:231], v[80:83], a[212:215]
ds_read_b64_tr_b16 a[78:79], v6 offset:52136
v_cvt_pk_bf16_f32 v87, v78, v79
v_mfma_f32_16x16x32_bf16 v[72:75], a[0:3], v[32:35], 0
global_load_lds_dwordx4 v9, s[24:25] offset:0
v_mfma_f32_16x16x32_bf16 v[72:75], a[4:7], v[36:39], v[72:75]
s_add_u32 m0, s29, 77824
v_exp_f32 v64, v64
v_mfma_f32_16x16x32_bf16 v[72:75], a[8:11], v[40:43], v[72:75]
global_load_lds_dwordx4 v10, s[24:25] offset:0
v_mfma_f32_16x16x32_bf16 v[72:75], a[12:15], v[44:47], v[72:75]
s_add_u32 s26, s22, 98304
v_exp_f32 v65, v65
v_mfma_f32_16x16x32_bf16 v[76:79], a[16:19], v[32:35], 0
s_addc_u32 s27, s23, 0
ds_read_b64_tr_b16 a[80:81], v7 offset:48000
v_cvt_pk_bf16_f32 v80, v64, v65
v_mfma_f32_16x16x32_bf16 v[76:79], a[20:23], v[36:39], v[76:79]
s_add_u32 m0, s30, 138048
v_exp_f32 v66, v66
v_mfma_f32_16x16x32_bf16 v[76:79], a[24:27], v[40:43], v[76:79]
global_load_lds_dwordx4 v11, s[26:27] offset:0
v_mfma_f32_16x16x32_bf16 v[76:79], a[28:31], v[44:47], v[76:79]
s_add_u32 m0, s30, 138056
v_exp_f32 v67, v67
v_mfma_f32_16x16x32_bf16 v[160:163], a[96:99], v[84:87], v[160:163]
global_load_lds_dwordx4 v11, s[26:27] offset:1024
v_cvt_pk_bf16_f32 v81, v66, v67
v_mfma_f32_16x16x32_bf16 v[164:167], a[100:103], v[84:87], v[164:167]
s_add_u32 s26, s22, 106496
v_exp_f32 v68, v68
v_mfma_f32_16x16x32_bf16 v[168:171], a[104:107], v[84:87], v[168:171]
s_addc_u32 s27, s23, 0
ds_read_b64_tr_b16 a[82:83], v7 offset:52128
ds_read_b64_tr_b16 a[84:85], v7 offset:48008
v_mfma_f32_16x16x32_bf16 v[172:175], a[108:111], v[84:87], v[172:175]
s_add_u32 m0, s30, 129792
v_exp_f32 v69, v69
v_mfma_f32_16x16x32_bf16 v[176:179], a[112:115], v[84:87], v[176:179]
global_load_lds_dwordx4 v11, s[26:27] offset:0
v_cvt_pk_bf16_f32 v82, v68, v69
v_mfma_f32_16x16x32_bf16 v[180:183], a[116:119], v[84:87], v[180:183]
s_add_u32 m0, s30, 129800
v_exp_f32 v70, v70
v_mfma_f32_16x16x32_bf16 v[184:187], a[120:123], v[84:87], v[184:187]
global_load_lds_dwordx4 v11, s[26:27] offset:1024
ds_read_b64_tr_b16 a[86:87], v7 offset:52136
v_mfma_f32_16x16x32_bf16 v[188:191], a[124:127], v[84:87], v[188:191]
s_add_u32 s26, s22, 114688
ds_read_b64_tr_b16 a[88:89], v8 offset:48000
v_exp_f32 v71, v71
v_mfma_f32_16x16x32_bf16 a[216:219], a[228:231], v[84:87], a[216:219]
s_addc_u32 s27, s23, 0
ds_read_b64_tr_b16 a[90:91], v8 offset:52128
ds_read_b64_tr_b16 a[92:93], v8 offset:48008
v_cvt_pk_bf16_f32 v83, v70, v71
v_mfma_f32_16x16x32_bf16 v[64:67], a[0:3], v[48:51], 0
s_add_u32 m0, s30, 121536
ds_read_b64_tr_b16 a[94:95], v8 offset:52136
ds_read_b64_tr_b16 a[96:97], v5 offset:14976
v_mfma_f32_16x16x32_bf16 v[64:67], a[4:7], v[52:55], v[64:67]
v_exp_f32 v72, v72
v_mfma_f32_16x16x32_bf16 v[64:67], a[8:11], v[56:59], v[64:67]
global_load_lds_dwordx4 v11, s[26:27] offset:0
v_mfma_f32_16x16x32_bf16 v[64:67], a[12:15], v[60:63], v[64:67]
s_add_u32 m0, s30, 121544
v_exp_f32 v73, v73
v_mfma_f32_16x16x32_bf16 v[68:71], a[16:19], v[48:51], 0
global_load_lds_dwordx4 v11, s[26:27] offset:1024
v_cvt_pk_bf16_f32 v84, v72, v73
v_mfma_f32_16x16x32_bf16 v[68:71], a[20:23], v[52:55], v[68:71]
s_add_u32 s26, s22, 122880
v_exp_f32 v74, v74
v_mfma_f32_16x16x32_bf16 v[68:71], a[24:27], v[56:59], v[68:71]
s_addc_u32 s27, s23, 0
ds_read_b64_tr_b16 a[98:99], v5 offset:19104
ds_read_b64_tr_b16 a[100:101], v5 offset:14984
v_mfma_f32_16x16x32_bf16 v[68:71], a[28:31], v[60:63], v[68:71]
s_add_u32 m0, s30, 154560
v_exp_f32 v75, v75
s_waitcnt lgkmcnt(2)
v_mfma_f32_16x16x32_bf16 v[96:99], a[64:67], v[80:83], v[96:99]
global_load_lds_dwordx4 v11, s[26:27] offset:0
v_cvt_pk_bf16_f32 v85, v74, v75
v_mfma_f32_16x16x32_bf16 v[100:103], a[68:71], v[80:83], v[100:103]
v_exp_f32 v76, v76
v_mfma_f32_16x16x32_bf16 v[104:107], a[72:75], v[80:83], v[104:107]
buffer_store_dwordx4 v[224:227], v12, s[16:19], s64 offen offset:0 sc0 sc1
v_mfma_f32_16x16x32_bf16 v[108:111], a[76:79], v[80:83], v[108:111]
s_add_u32 m0, s30, 154568
v_exp_f32 v77, v77
v_mfma_f32_16x16x32_bf16 v[112:115], a[80:83], v[80:83], v[112:115]
v_cvt_pk_bf16_f32 v86, v76, v77
v_mul_f32 v232, v91, v232
v_mfma_f32_16x16x32_bf16 v[116:119], a[84:87], v[80:83], v[116:119]
v_exp_f32 v78, v78
v_mfma_f32_16x16x32_bf16 v[120:123], a[88:91], v[80:83], v[120:123]
v_mul_f32 v233, v91, v233
v_mul_f32 v234, v91, v234
v_mfma_f32_16x16x32_bf16 v[124:127], a[92:95], v[80:83], v[124:127]
v_exp_f32 v79, v79
v_mfma_f32_16x16x32_bf16 a[208:211], a[228:231], v[80:83], a[208:211]
global_load_lds_dwordx4 v11, s[26:27] offset:1024
v_cvt_pk_bf16_f32 v87, v78, v79
v_mfma_f32_16x16x32_bf16 v[72:75], a[32:35], v[16:19], 0
ds_read_b64_tr_b16 a[102:103], v5 offset:19112
ds_read_b64_tr_b16 a[104:105], v6 offset:14976
v_mfma_f32_16x16x32_bf16 v[72:75], a[36:39], v[20:23], v[72:75]
v_exp_f32 v64, v64
v_mfma_f32_16x16x32_bf16 v[72:75], a[40:43], v[24:27], v[72:75]
s_add_u32 s26, s22, 0
ds_read_b64_tr_b16 a[106:107], v6 offset:19104
ds_read_b64_tr_b16 a[108:109], v6 offset:14984
v_mfma_f32_16x16x32_bf16 v[72:75], a[44:47], v[28:31], v[72:75]
s_addc_u32 s27, s23, 0
v_exp_f32 v65, v65
v_mfma_f32_16x16x32_bf16 v[76:79], a[48:51], v[16:19], 0
s_add_u32 m0, s30, 105024
ds_read_b64_tr_b16 a[110:111], v6 offset:19112
v_cvt_pk_bf16_f32 v80, v64, v65
v_mfma_f32_16x16x32_bf16 v[76:79], a[52:55], v[20:23], v[76:79]
v_exp_f32 v66, v66
v_mfma_f32_16x16x32_bf16 v[76:79], a[56:59], v[24:27], v[76:79]
global_load_lds_dwordx4 v11, s[26:27] offset:0
v_mfma_f32_16x16x32_bf16 v[76:79], a[60:63], v[28:31], v[76:79]
v_exp_f32 v67, v67
v_mfma_f32_16x16x32_bf16 v[128:131], a[64:67], v[84:87], v[128:131]
ds_read_b64_tr_b16 a[112:113], v7 offset:14976
v_cvt_pk_bf16_f32 v81, v66, v67
v_mfma_f32_16x16x32_bf16 v[132:135], a[68:71], v[84:87], v[132:135]
v_exp_f32 v68, v68
v_mfma_f32_16x16x32_bf16 v[136:139], a[72:75], v[84:87], v[136:139]
s_add_u32 m0, s30, 105032
ds_read_b64_tr_b16 a[114:115], v7 offset:19104
v_mul_f32 v235, v91, v235
v_mfma_f32_16x16x32_bf16 v[140:143], a[76:79], v[84:87], v[140:143]
v_exp_f32 v69, v69
v_mfma_f32_16x16x32_bf16 v[144:147], a[80:83], v[84:87], v[144:147]
ds_read_b64_tr_b16 a[116:117], v7 offset:14984
v_cvt_pk_bf16_f32 v82, v68, v69
v_mfma_f32_16x16x32_bf16 v[148:151], a[84:87], v[84:87], v[148:151]
v_exp_f32 v70, v70
v_mfma_f32_16x16x32_bf16 v[152:155], a[88:91], v[84:87], v[152:155]
global_load_lds_dwordx4 v11, s[26:27] offset:1024
v_mfma_f32_16x16x32_bf16 v[156:159], a[92:95], v[84:87], v[156:159]
v_exp_f32 v71, v71
v_mfma_f32_16x16x32_bf16 a[212:215], a[228:231], v[84:87], a[212:215]
ds_read_b64_tr_b16 a[118:119], v7 offset:19112
v_cvt_pk_bf16_f32 v83, v70, v71
v_mfma_f32_16x16x32_bf16 v[64:67], a[32:35], v[32:35], 0
ds_read_b64_tr_b16 a[120:121], v8 offset:14976
ds_read_b64_tr_b16 a[122:123], v8 offset:19104
v_mfma_f32_16x16x32_bf16 v[64:67], a[36:39], v[36:39], v[64:67]
v_exp_f32 v72, v72
v_mfma_f32_16x16x32_bf16 v[64:67], a[40:43], v[40:43], v[64:67]
ds_read_b64_tr_b16 a[124:125], v8 offset:14984
ds_read_b64_tr_b16 a[126:127], v8 offset:19112
v_mfma_f32_16x16x32_bf16 v[64:67], a[44:47], v[44:47], v[64:67]
v_exp_f32 v73, v73
v_mfma_f32_16x16x32_bf16 v[68:71], a[48:51], v[32:35], 0
v_cvt_pk_bf16_f32 v84, v72, v73
v_mul_f32 v236, v91, v236
v_mfma_f32_16x16x32_bf16 v[68:71], a[52:55], v[36:39], v[68:71]
v_exp_f32 v74, v74
v_mfma_f32_16x16x32_bf16 v[68:71], a[56:59], v[40:43], v[68:71]
ds_read_b128 a[0:3], v1 offset:49152
v_mul_f32 v237, v91, v237
v_mfma_f32_16x16x32_bf16 v[68:71], a[60:63], v[44:47], v[68:71]
v_exp_f32 v75, v75
v_mfma_f32_16x16x32_bf16 v[160:163], a[64:67], v[80:83], v[160:163]
ds_read_b128 a[4:7], v2 offset:49152
v_cvt_pk_bf16_f32 v85, v74, v75
v_mfma_f32_16x16x32_bf16 v[164:167], a[68:71], v[80:83], v[164:167]
v_exp_f32 v76, v76
v_mfma_f32_16x16x32_bf16 v[168:171], a[72:75], v[80:83], v[168:171]
ds_read_b128 a[8:11], v3 offset:49152
ds_read_b128 a[12:15], v4 offset:49152
v_mfma_f32_16x16x32_bf16 v[172:175], a[76:79], v[80:83], v[172:175]
v_exp_f32 v77, v77
v_mfma_f32_16x16x32_bf16 v[176:179], a[80:83], v[80:83], v[176:179]
ds_read_b128 a[16:19], v1 offset:53248
v_cvt_pk_bf16_f32 v86, v76, v77
v_mfma_f32_16x16x32_bf16 v[180:183], a[84:87], v[80:83], v[180:183]
v_exp_f32 v78, v78
v_mfma_f32_16x16x32_bf16 v[184:187], a[88:91], v[80:83], v[184:187]
ds_read_b128 a[20:23], v2 offset:53248
v_mul_f32 v238, v91, v238
v_mfma_f32_16x16x32_bf16 v[188:191], a[92:95], v[80:83], v[188:191]
v_exp_f32 v79, v79
v_mfma_f32_16x16x32_bf16 a[216:219], a[228:231], v[80:83], a[216:219]
ds_read_b128 a[24:27], v3 offset:53248
v_cvt_pk_bf16_f32 v87, v78, v79
v_mfma_f32_16x16x32_bf16 v[72:75], a[32:35], v[48:51], 0
ds_read_b128 a[28:31], v4 offset:53248
v_mul_f32 v239, v91, v239
v_mfma_f32_16x16x32_bf16 v[72:75], a[36:39], v[52:55], v[72:75]
v_exp_f32 v64, v64
v_mfma_f32_16x16x32_bf16 v[72:75], a[40:43], v[56:59], v[72:75]
v_cvt_pk_bf16_f32 v232, v232, v233
v_cvt_pk_bf16_f32 v233, v234, v235
v_mfma_f32_16x16x32_bf16 v[72:75], a[44:47], v[60:63], v[72:75]
s_waitcnt vmcnt(5)
ds_write_b32 v0, v92
v_exp_f32 v65, v65
v_mfma_f32_16x16x32_bf16 v[76:79], a[48:51], v[48:51], 0
v_cvt_pk_bf16_f32 v80, v64, v65
v_cvt_pk_bf16_f32 v234, v236, v237
v_mfma_f32_16x16x32_bf16 v[76:79], a[52:55], v[52:55], v[76:79]
v_exp_f32 v66, v66
v_mfma_f32_16x16x32_bf16 v[76:79], a[56:59], v[56:59], v[76:79]
v_cvt_pk_bf16_f32 v235, v238, v239
v_mfma_f32_16x16x32_bf16 v[76:79], a[60:63], v[60:63], v[76:79]
s_waitcnt lgkmcnt(7)
v_exp_f32 v67, v67
v_mfma_f32_16x16x32_bf16 v[96:99], a[96:99], v[84:87], v[96:99]
v_cvt_pk_bf16_f32 v81, v66, v67
v_mfma_f32_16x16x32_bf16 v[100:103], a[100:103], v[84:87], v[100:103]
v_exp_f32 v68, v68
v_mfma_f32_16x16x32_bf16 v[104:107], a[104:107], v[84:87], v[104:107]
ds_read_b32 v93, v90
v_mfma_f32_16x16x32_bf16 v[108:111], a[108:111], v[84:87], v[108:111]
v_exp_f32 v69, v69
v_mfma_f32_16x16x32_bf16 v[112:115], a[112:115], v[84:87], v[112:115]
v_cvt_pk_bf16_f32 v82, v68, v69
v_mfma_f32_16x16x32_bf16 v[116:119], a[116:119], v[84:87], v[116:119]
v_exp_f32 v70, v70
v_mfma_f32_16x16x32_bf16 v[120:123], a[120:123], v[84:87], v[120:123]
s_add_u32 s26, s22, 8192
v_mfma_f32_16x16x32_bf16 v[124:127], a[124:127], v[84:87], v[124:127]
s_addc_u32 s27, s23, 0
v_exp_f32 v71, v71
v_mfma_f32_16x16x32_bf16 a[208:211], a[228:231], v[84:87], a[208:211]
s_add_u32 m0, s30, 146304
s_waitcnt lgkmcnt(0)
v_cmp_gt_u32 vcc, v92, v93
v_cvt_pk_bf16_f32 v83, v70, v71
v_mfma_f32_16x16x32_bf16 v[64:67], a[0:3], v[16:19], 0
s_cbranch_vccnz L_r28
L_b28:
v_add_u32 v92, 1, v92
v_mfma_f32_16x16x32_bf16 v[64:67], a[4:7], v[20:23], v[64:67]
v_exp_f32 v72, v72
v_mfma_f32_16x16x32_bf16 v[64:67], a[8:11], v[24:27], v[64:67]
global_load_lds_dwordx4 v11, s[26:27] offset:0
v_mfma_f32_16x16x32_bf16 v[64:67], a[12:15], v[28:31], v[64:67]
v_exp_f32 v73, v73
v_mfma_f32_16x16x32_bf16 v[68:71], a[16:19], v[16:19], 0
ds_read_b64_tr_b16 a[64:65], v5 offset:39744
v_cvt_pk_bf16_f32 v84, v72, v73
v_mfma_f32_16x16x32_bf16 v[68:71], a[20:23], v[20:23], v[68:71]
s_add_u32 m0, s30, 146312
v_exp_f32 v74, v74
v_mfma_f32_16x16x32_bf16 v[68:71], a[24:27], v[24:27], v[68:71]
ds_read_b64_tr_b16 a[66:67], v5 offset:43872
ds_read_b64_tr_b16 a[68:69], v5 offset:39752
v_mfma_f32_16x16x32_bf16 v[68:71], a[28:31], v[28:31], v[68:71]
v_exp_f32 v75, v75
v_mfma_f32_16x16x32_bf16 v[128:131], a[96:99], v[80:83], v[128:131]
ds_read_b64_tr_b16 a[70:71], v5 offset:43880
v_cvt_pk_bf16_f32 v85, v74, v75
v_mfma_f32_16x16x32_bf16 v[132:135], a[100:103], v[80:83], v[132:135]
v_exp_f32 v76, v76
v_mfma_f32_16x16x32_bf16 v[136:139], a[104:107], v[80:83], v[136:139]
global_load_lds_dwordx4 v11, s[26:27] offset:1024
v_mfma_f32_16x16x32_bf16 v[140:143], a[108:111], v[80:83], v[140:143]
v_exp_f32 v77, v77
v_mfma_f32_16x16x32_bf16 v[144:147], a[112:115], v[80:83], v[144:147]
ds_read_b64_tr_b16 a[72:73], v6 offset:39744
v_cvt_pk_bf16_f32 v86, v76, v77
v_mfma_f32_16x16x32_bf16 v[148:151], a[116:119], v[80:83], v[148:151]
v_exp_f32 v78, v78
v_mfma_f32_16x16x32_bf16 v[152:155], a[120:123], v[80:83], v[152:155]
ds_read_b64_tr_b16 a[74:75], v6 offset:43872
ds_read_b64_tr_b16 a[76:77], v6 offset:39752
v_mfma_f32_16x16x32_bf16 v[156:159], a[124:127], v[80:83], v[156:159]
v_exp_f32 v79, v79
v_mfma_f32_16x16x32_bf16 a[212:215], a[228:231], v[80:83], a[212:215]
ds_read_b64_tr_b16 a[78:79], v6 offset:43880
v_cvt_pk_bf16_f32 v87, v78, v79
v_mfma_f32_16x16x32_bf16 v[72:75], a[0:3], v[32:35], 0
ds_read_b64_tr_b16 a[80:81], v7 offset:39744
ds_read_b64_tr_b16 a[82:83], v7 offset:43872
v_mfma_f32_16x16x32_bf16 v[72:75], a[4:7], v[36:39], v[72:75]
v_exp_f32 v64, v64
v_mfma_f32_16x16x32_bf16 v[72:75], a[8:11], v[40:43], v[72:75]
ds_read_b64_tr_b16 a[84:85], v7 offset:39752
ds_read_b64_tr_b16 a[86:87], v7 offset:43880
v_mfma_f32_16x16x32_bf16 v[72:75], a[12:15], v[44:47], v[72:75]
v_exp_f32 v65, v65
v_mfma_f32_16x16x32_bf16 v[76:79], a[16:19], v[32:35], 0
ds_read_b64_tr_b16 a[88:89], v8 offset:39744
v_cvt_pk_bf16_f32 v80, v64, v65
v_mfma_f32_16x16x32_bf16 v[76:79], a[20:23], v[36:39], v[76:79]
v_exp_f32 v66, v66
v_mfma_f32_16x16x32_bf16 v[76:79], a[24:27], v[40:43], v[76:79]
buffer_store_dwordx4 v[232:235], v12, s[16:19], s64 offen offset:64 sc0 sc1
v_mfma_f32_16x16x32_bf16 v[76:79], a[28:31], v[44:47], v[76:79]
v_exp_f32 v67, v67
v_mfma_f32_16x16x32_bf16 v[160:163], a[96:99], v[84:87], v[160:163]
ds_read_b64_tr_b16 a[90:91], v8 offset:43872
v_cvt_pk_bf16_f32 v81, v66, v67
v_mfma_f32_16x16x32_bf16 v[164:167], a[100:103], v[84:87], v[164:167]
v_exp_f32 v68, v68
v_mfma_f32_16x16x32_bf16 v[168:171], a[104:107], v[84:87], v[168:171]
ds_read_b64_tr_b16 a[92:93], v8 offset:39752
ds_read_b64_tr_b16 a[94:95], v8 offset:43880
v_mfma_f32_16x16x32_bf16 v[172:175], a[108:111], v[84:87], v[172:175]
v_exp_f32 v69, v69
v_mfma_f32_16x16x32_bf16 v[176:179], a[112:115], v[84:87], v[176:179]
v_cvt_pk_bf16_f32 v82, v68, v69
v_mul_f32 v240, v91, v240
v_mfma_f32_16x16x32_bf16 v[180:183], a[116:119], v[84:87], v[180:183]
v_exp_f32 v70, v70
v_mfma_f32_16x16x32_bf16 v[184:187], a[120:123], v[84:87], v[184:187]
ds_read_b128 a[32:35], v1 offset:57344
ds_read_b128 a[36:39], v2 offset:57344
v_mfma_f32_16x16x32_bf16 v[188:191], a[124:127], v[84:87], v[188:191]
v_exp_f32 v71, v71
v_mfma_f32_16x16x32_bf16 a[216:219], a[228:231], v[84:87], a[216:219]
ds_read_b128 a[40:43], v3 offset:57344
v_cvt_pk_bf16_f32 v83, v70, v71
v_mfma_f32_16x16x32_bf16 v[64:67], a[0:3], v[48:51], 0
ds_read_b128 a[44:47], v4 offset:57344
ds_read_b128 a[48:51], v1 offset:61440
v_mfma_f32_16x16x32_bf16 v[64:67], a[4:7], v[52:55], v[64:67]
v_exp_f32 v72, v72
v_mfma_f32_16x16x32_bf16 v[64:67], a[8:11], v[56:59], v[64:67]
ds_read_b128 a[52:55], v2 offset:61440
v_mul_f32 v241, v91, v241
v_mfma_f32_16x16x32_bf16 v[64:67], a[12:15], v[60:63], v[64:67]
v_exp_f32 v73, v73
v_mfma_f32_16x16x32_bf16 v[68:71], a[16:19], v[48:51], 0
ds_read_b128 a[56:59], v3 offset:61440
v_cvt_pk_bf16_f32 v84, v72, v73
v_mfma_f32_16x16x32_bf16 v[68:71], a[20:23], v[52:55], v[68:71]
v_exp_f32 v74, v74
v_mfma_f32_16x16x32_bf16 v[68:71], a[24:27], v[56:59], v[68:71]
ds_read_b128 a[60:63], v4 offset:61440
v_xor_b32 v1, 0x10000, v1
v_xor_b32 v2, 0x10000, v2
v_mfma_f32_16x16x32_bf16 v[68:71], a[28:31], v[60:63], v[68:71]
s_waitcnt lgkmcnt(6)
v_exp_f32 v75, v75
v_xor_b32 v3, 0x10000, v3
v_mfma_f32_16x16x32_bf16 v[96:99], a[64:67], v[80:83], v[96:99]
v_xor_b32 v4, 0x10000, v4
v_cvt_pk_bf16_f32 v85, v74, v75
v_mfma_f32_16x16x32_bf16 v[100:103], a[68:71], v[80:83], v[100:103]
v_exp_f32 v76, v76
v_mfma_f32_16x16x32_bf16 v[104:107], a[72:75], v[80:83], v[104:107]
v_mul_f32 v242, v91, v242
v_mul_f32 v243, v91, v243
v_mfma_f32_16x16x32_bf16 v[108:111], a[76:79], v[80:83], v[108:111]
v_exp_f32 v77, v77
v_mfma_f32_16x16x32_bf16 v[112:115], a[80:83], v[80:83], v[112:115]
v_cvt_pk_bf16_f32 v86, v76, v77
v_mul_f32 v244, v91, v244
v_mfma_f32_16x16x32_bf16 v[116:119], a[84:87], v[80:83], v[116:119]
v_exp_f32 v78, v78
v_mfma_f32_16x16x32_bf16 v[120:123], a[88:91], v[80:83], v[120:123]
v_mul_f32 v245, v91, v245
v_mul_f32 v246, v91, v246
v_mfma_f32_16x16x32_bf16 v[124:127], a[92:95], v[80:83], v[124:127]
v_exp_f32 v79, v79
v_mfma_f32_16x16x32_bf16 a[208:211], a[228:231], v[80:83], a[208:211]
ds_read_b64_tr_b16 a[96:97], v5 offset:31488
v_cvt_pk_bf16_f32 v87, v78, v79
v_mfma_f32_16x16x32_bf16 v[72:75], a[32:35], v[16:19], 0
ds_read_b64_tr_b16 a[98:99], v5 offset:35616
ds_read_b64_tr_b16 a[100:101], v5 offset:31496
v_mfma_f32_16x16x32_bf16 v[72:75], a[36:39], v[20:23], v[72:75]
s_waitcnt lgkmcnt(3)
v_exp_f32 v64, v64
v_mfma_f32_16x16x32_bf16 v[72:75], a[40:43], v[24:27], v[72:75]
ds_read_b64_tr_b16 a[102:103], v5 offset:35624
ds_read_b64_tr_b16 a[104:105], v6 offset:31488
v_mfma_f32_16x16x32_bf16 v[72:75], a[44:47], v[28:31], v[72:75]
v_exp_f32 v65, v65
v_mfma_f32_16x16x32_bf16 v[76:79], a[48:51], v[16:19], 0
ds_read_b64_tr_b16 a[106:107], v6 offset:35616
v_cvt_pk_bf16_f32 v80, v64, v65
v_mfma_f32_16x16x32_bf16 v[76:79], a[52:55], v[20:23], v[76:79]
v_exp_f32 v66, v66
v_mfma_f32_16x16x32_bf16 v[76:79], a[56:59], v[24:27], v[76:79]
ds_read_b64_tr_b16 a[108:109], v6 offset:31496
ds_read_b64_tr_b16 a[110:111], v6 offset:35624
v_mfma_f32_16x16x32_bf16 v[76:79], a[60:63], v[28:31], v[76:79]
v_exp_f32 v67, v67
v_mfma_f32_16x16x32_bf16 v[128:131], a[64:67], v[84:87], v[128:131]
ds_read_b64_tr_b16 a[112:113], v7 offset:31488
v_cvt_pk_bf16_f32 v81, v66, v67
v_mfma_f32_16x16x32_bf16 v[132:135], a[68:71], v[84:87], v[132:135]
v_exp_f32 v68, v68
v_mfma_f32_16x16x32_bf16 v[136:139], a[72:75], v[84:87], v[136:139]
ds_read_b64_tr_b16 a[114:115], v7 offset:35616
ds_read_b64_tr_b16 a[116:117], v7 offset:31496
v_mfma_f32_16x16x32_bf16 v[140:143], a[76:79], v[84:87], v[140:143]
v_exp_f32 v69, v69
v_mfma_f32_16x16x32_bf16 v[144:147], a[80:83], v[84:87], v[144:147]
ds_read_b64_tr_b16 a[118:119], v7 offset:35624
v_cvt_pk_bf16_f32 v82, v68, v69
v_mfma_f32_16x16x32_bf16 v[148:151], a[84:87], v[84:87], v[148:151]
v_exp_f32 v70, v70
v_mfma_f32_16x16x32_bf16 v[152:155], a[88:91], v[84:87], v[152:155]
s_add_u32 s26, s22, 16384
ds_read_b64_tr_b16 a[120:121], v8 offset:31488
v_mul_f32 v247, v91, v247
v_mfma_f32_16x16x32_bf16 v[156:159], a[92:95], v[84:87], v[156:159]
s_addc_u32 s27, s23, 0
v_exp_f32 v71, v71
v_mfma_f32_16x16x32_bf16 a[212:215], a[228:231], v[84:87], a[212:215]
s_add_u32 m0, s30, 113280
ds_read_b64_tr_b16 a[122:123], v8 offset:35616
v_cvt_pk_bf16_f32 v83, v70, v71
v_mfma_f32_16x16x32_bf16 v[64:67], a[32:35], v[32:35], 0
ds_read_b64_tr_b16 a[124:125], v8 offset:31496
ds_read_b64_tr_b16 a[126:127], v8 offset:35624
v_mfma_f32_16x16x32_bf16 v[64:67], a[36:39], v[36:39], v[64:67]
v_exp_f32 v72, v72
v_mfma_f32_16x16x32_bf16 v[64:67], a[40:43], v[40:43], v[64:67]
global_load_lds_dwordx4 v11, s[26:27] offset:0
v_mfma_f32_16x16x32_bf16 v[64:67], a[44:47], v[44:47], v[64:67]
v_exp_f32 v73, v73
v_mfma_f32_16x16x32_bf16 v[68:71], a[48:51], v[32:35], 0
v_cvt_pk_bf16_f32 v84, v72, v73
v_cvt_pk_bf16_f32 v240, v240, v241
v_mfma_f32_16x16x32_bf16 v[68:71], a[52:55], v[36:39], v[68:71]
s_add_u32 m0, s30, 113288
v_exp_f32 v74, v74
v_mfma_f32_16x16x32_bf16 v[68:71], a[56:59], v[40:43], v[68:71]
ds_read_b128 a[0:3], v1 offset:0
ds_read_b128 a[4:7], v2 offset:0
v_mfma_f32_16x16x32_bf16 v[68:71], a[60:63], v[44:47], v[68:71]
v_exp_f32 v75, v75
v_mfma_f32_16x16x32_bf16 v[160:163], a[64:67], v[80:83], v[160:163]
ds_read_b128 a[8:11], v3 offset:0
v_cvt_pk_bf16_f32 v85, v74, v75
v_mfma_f32_16x16x32_bf16 v[164:167], a[68:71], v[80:83], v[164:167]
v_exp_f32 v76, v76
v_mfma_f32_16x16x32_bf16 v[168:171], a[72:75], v[80:83], v[168:171]
global_load_lds_dwordx4 v11, s[26:27] offset:1024
v_mfma_f32_16x16x32_bf16 v[172:175], a[76:79], v[80:83], v[172:175]
v_exp_f32 v77, v77
v_mfma_f32_16x16x32_bf16 v[176:179], a[80:83], v[80:83], v[176:179]
ds_read_b128 a[12:15], v4 offset:0
v_cvt_pk_bf16_f32 v86, v76, v77
v_mfma_f32_16x16x32_bf16 v[180:183], a[84:87], v[80:83], v[180:183]
v_exp_f32 v78, v78
v_mfma_f32_16x16x32_bf16 v[184:187], a[88:91], v[80:83], v[184:187]
ds_read_b128 a[16:19], v1 offset:4096
ds_read_b128 a[20:23], v2 offset:4096
v_mfma_f32_16x16x32_bf16 v[188:191], a[92:95], v[80:83], v[188:191]
v_exp_f32 v79, v79
v_mfma_f32_16x16x32_bf16 a[216:219], a[228:231], v[80:83], a[216:219]
v_cvt_pk_bf16_f32 v87, v78, v79
v_cvt_pk_bf16_f32 v241, v242, v243
v_mfma_f32_16x16x32_bf16 v[72:75], a[32:35], v[48:51], 0
ds_read_b128 a[24:27], v3 offset:4096
ds_read_b128 a[28:31], v4 offset:4096
v_mfma_f32_16x16x32_bf16 v[72:75], a[36:39], v[52:55], v[72:75]
v_exp_f32 v64, v64
v_mfma_f32_16x16x32_bf16 v[72:75], a[40:43], v[56:59], v[72:75]
v_cvt_pk_bf16_f32 v242, v244, v245
v_cvt_pk_bf16_f32 v243, v246, v247
v_mfma_f32_16x16x32_bf16 v[72:75], a[44:47], v[60:63], v[72:75]
v_exp_f32 v65, v65
v_mfma_f32_16x16x32_bf16 v[76:79], a[48:51], v[48:51], 0
ds_read_b64_tr_b16 a[64:65], v5 offset:23232
v_cvt_pk_bf16_f32 v80, v64, v65
v_mfma_f32_16x16x32_bf16 v[76:79], a[52:55], v[52:55], v[76:79]
v_exp_f32 v66, v66
v_mfma_f32_16x16x32_bf16 v[76:79], a[56:59], v[56:59], v[76:79]
ds_read_b64_tr_b16 a[66:67], v5 offset:27360
ds_read_b64_tr_b16 a[68:69], v5 offset:23240
v_mfma_f32_16x16x32_bf16 v[76:79], a[60:63], v[60:63], v[76:79]
s_waitcnt lgkmcnt(9)
v_exp_f32 v67, v67
v_mfma_f32_16x16x32_bf16 v[96:99], a[96:99], v[84:87], v[96:99]
ds_read_b64_tr_b16 a[70:71], v5 offset:27368
v_cvt_pk_bf16_f32 v81, v66, v67
v_mfma_f32_16x16x32_bf16 v[100:103], a[100:103], v[84:87], v[100:103]
v_exp_f32 v68, v68
v_mfma_f32_16x16x32_bf16 v[104:107], a[104:107], v[84:87], v[104:107]
ds_read_b64_tr_b16 a[72:73], v6 offset:23232
ds_read_b64_tr_b16 a[74:75], v6 offset:27360
v_mfma_f32_16x16x32_bf16 v[108:111], a[108:111], v[84:87], v[108:111]
v_exp_f32 v69, v69
v_mfma_f32_16x16x32_bf16 v[112:115], a[112:115], v[84:87], v[112:115]
ds_read_b64_tr_b16 a[76:77], v6 offset:23240
v_cvt_pk_bf16_f32 v82, v68, v69
v_mfma_f32_16x16x32_bf16 v[116:119], a[116:119], v[84:87], v[116:119]
v_exp_f32 v70, v70
v_mfma_f32_16x16x32_bf16 v[120:123], a[120:123], v[84:87], v[120:123]
ds_read_b64_tr_b16 a[78:79], v6 offset:27368
ds_read_b64_tr_b16 a[80:81], v7 offset:23232
v_mfma_f32_16x16x32_bf16 v[124:127], a[124:127], v[84:87], v[124:127]
v_exp_f32 v71, v71
v_mfma_f32_16x16x32_bf16 a[208:211], a[228:231], v[84:87], a[208:211]
ds_read_b64_tr_b16 a[82:83], v7 offset:27360
v_cvt_pk_bf16_f32 v83, v70, v71
v_mfma_f32_16x16x32_bf16 v[64:67], a[0:3], v[16:19], 0
ds_read_b64_tr_b16 a[84:85], v7 offset:23240
ds_read_b64_tr_b16 a[86:87], v7 offset:27368
v_mfma_f32_16x16x32_bf16 v[64:67], a[4:7], v[20:23], v[64:67]
s_waitcnt lgkmcnt(5)
v_exp_f32 v72, v72
v_mfma_f32_16x16x32_bf16 v[64:67], a[8:11], v[24:27], v[64:67]
buffer_store_dwordx4 v[240:243], v12, s[16:19], s64 offen offset:128 sc0 sc1
v_mfma_f32_16x16x32_bf16 v[64:67], a[12:15], v[28:31], v[64:67]
v_exp_f32 v73, v73
v_mfma_f32_16x16x32_bf16 v[68:71], a[16:19], v[16:19], 0
v_cvt_pk_bf16_f32 v84, v72, v73
v_mul_f32 v248, v91, v248
v_mfma_f32_16x16x32_bf16 v[68:71], a[20:23], v[20:23], v[68:71]
v_exp_f32 v74, v74
v_mfma_f32_16x16x32_bf16 v[68:71], a[24:27], v[24:27], v[68:71]
ds_read_b64_tr_b16 a[88:89], v8 offset:23232
v_mul_f32 v249, v91, v249
v_mfma_f32_16x16x32_bf16 v[68:71], a[28:31], v[28:31], v[68:71]
v_exp_f32 v75, v75
v_mfma_f32_16x16x32_bf16 v[128:131], a[96:99], v[80:83], v[128:131]
ds_read_b64_tr_b16 a[90:91], v8 offset:27360
v_cvt_pk_bf16_f32 v85, v74, v75
v_mfma_f32_16x16x32_bf16 v[132:135], a[100:103], v[80:83], v[132:135]
v_exp_f32 v76, v76
v_mfma_f32_16x16x32_bf16 v[136:139], a[104:107], v[80:83], v[136:139]
ds_read_b64_tr_b16 a[92:93], v8 offset:23240
ds_read_b64_tr_b16 a[94:95], v8 offset:27368
v_mfma_f32_16x16x32_bf16 v[140:143], a[108:111], v[80:83], v[140:143]
v_exp_f32 v77, v77
v_mfma_f32_16x16x32_bf16 v[144:147], a[112:115], v[80:83], v[144:147]
v_cvt_pk_bf16_f32 v86, v76, v77
v_mul_f32 v250, v91, v250
v_mfma_f32_16x16x32_bf16 v[148:151], a[116:119], v[80:83], v[148:151]
v_exp_f32 v78, v78
v_mfma_f32_16x16x32_bf16 v[152:155], a[120:123], v[80:83], v[152:155]
ds_read_b128 a[32:35], v1 offset:8192
v_mul_f32 v251, v91, v251
v_mfma_f32_16x16x32_bf16 v[156:159], a[124:127], v[80:83], v[156:159]
v_exp_f32 v79, v79
v_mfma_f32_16x16x32_bf16 a[212:215], a[228:231], v[80:83], a[212:215]
ds_read_b128 a[36:39], v2 offset:8192
v_cvt_pk_bf16_f32 v87, v78, v79
v_mfma_f32_16x16x32_bf16 v[72:75], a[0:3], v[32:35], 0
ds_read_b128 a[40:43], v3 offset:8192
ds_read_b128 a[44:47], v4 offset:8192
v_mfma_f32_16x16x32_bf16 v[72:75], a[4:7], v[36:39], v[72:75]
v_exp_f32 v64, v64
v_mfma_f32_16x16x32_bf16 v[72:75], a[8:11], v[40:43], v[72:75]
ds_read_b128 a[48:51], v1 offset:12288
ds_read_b128 a[52:55], v2 offset:12288
v_mfma_f32_16x16x32_bf16 v[72:75], a[12:15], v[44:47], v[72:75]
v_exp_f32 v65, v65
v_mfma_f32_16x16x32_bf16 v[76:79], a[16:19], v[32:35], 0
v_cvt_pk_bf16_f32 v80, v64, v65
v_mul_f32 v252, v91, v252
v_mfma_f32_16x16x32_bf16 v[76:79], a[20:23], v[36:39], v[76:79]
v_exp_f32 v66, v66
v_mfma_f32_16x16x32_bf16 v[76:79], a[24:27], v[40:43], v[76:79]
ds_read_b128 a[56:59], v3 offset:12288
ds_read_b128 a[60:63], v4 offset:12288
v_xor_b32 v1, 0x10000, v1
v_mfma_f32_16x16x32_bf16 v[76:79], a[28:31], v[44:47], v[76:79]
v_exp_f32 v67, v67
v_xor_b32 v2, 0x10000, v2
v_mfma_f32_16x16x32_bf16 v[160:163], a[96:99], v[84:87], v[160:163]
v_xor_b32 v3, 0x10000, v3
v_xor_b32 v4, 0x10000, v4
v_cvt_pk_bf16_f32 v81, v66, v67
v_mfma_f32_16x16x32_bf16 v[164:167], a[100:103], v[84:87], v[164:167]
v_exp_f32 v68, v68
v_mfma_f32_16x16x32_bf16 v[168:171], a[104:107], v[84:87], v[168:171]
v_mul_f32 v253, v91, v253
v_mul_f32 v254, v91, v254
v_mfma_f32_16x16x32_bf16 v[172:175], a[108:111], v[84:87], v[172:175]
v_exp_f32 v69, v69
v_mfma_f32_16x16x32_bf16 v[176:179], a[112:115], v[84:87], v[176:179]
v_cvt_pk_bf16_f32 v82, v68, v69
v_mul_f32 v255, v91, v255
v_mfma_f32_16x16x32_bf16 v[180:183], a[116:119], v[84:87], v[180:183]
v_exp_f32 v70, v70
v_mfma_f32_16x16x32_bf16 v[184:187], a[120:123], v[84:87], v[184:187]
v_cvt_pk_bf16_f32 v248, v248, v249
v_cvt_pk_bf16_f32 v249, v250, v251
v_mfma_f32_16x16x32_bf16 v[188:191], a[124:127], v[84:87], v[188:191]
v_exp_f32 v71, v71
v_mfma_f32_16x16x32_bf16 a[216:219], a[228:231], v[84:87], a[216:219]
v_cvt_pk_bf16_f32 v83, v70, v71
v_cvt_pk_bf16_f32 v250, v252, v253
v_mfma_f32_16x16x32_bf16 v[64:67], a[0:3], v[48:51], 0
ds_read_b128 a[0:3], v1 offset:0
v_cvt_pk_bf16_f32 v251, v254, v255
v_mfma_f32_16x16x32_bf16 v[64:67], a[4:7], v[52:55], v[64:67]
v_exp_f32 v72, v72
v_mfma_f32_16x16x32_bf16 v[64:67], a[8:11], v[56:59], v[64:67]
ds_read_b128 a[4:7], v2 offset:0
ds_read_b128 a[8:11], v3 offset:0
v_mfma_f32_16x16x32_bf16 v[64:67], a[12:15], v[60:63], v[64:67]
s_waitcnt vmcnt(4)
ds_write_b32 v0, v92
v_exp_f32 v73, v73
v_mfma_f32_16x16x32_bf16 v[68:71], a[16:19], v[48:51], 0
ds_read_b128 a[12:15], v4 offset:0
v_cvt_pk_bf16_f32 v84, v72, v73
v_mfma_f32_16x16x32_bf16 v[68:71], a[20:23], v[52:55], v[68:71]
v_exp_f32 v74, v74
v_mfma_f32_16x16x32_bf16 v[68:71], a[24:27], v[56:59], v[68:71]
ds_read_b128 a[16:19], v1 offset:4096
ds_read_b128 a[20:23], v2 offset:4096
v_mfma_f32_16x16x32_bf16 v[68:71], a[28:31], v[60:63], v[68:71]
v_exp_f32 v75, v75
v_mfma_f32_16x16x32_bf16 v[96:99], a[64:67], v[80:83], v[96:99]
ds_read_b128 a[24:27], v3 offset:4096
v_cvt_pk_bf16_f32 v85, v74, v75
v_mfma_f32_16x16x32_bf16 v[100:103], a[68:71], v[80:83], v[100:103]
v_exp_f32 v76, v76
v_mfma_f32_16x16x32_bf16 v[104:107], a[72:75], v[80:83], v[104:107]
ds_read_b32 v93, v90
ds_read_b128 a[28:31], v4 offset:4096
s_waitcnt lgkmcnt(10)
v_mfma_f32_16x16x32_bf16 v[108:111], a[76:79], v[80:83], v[108:111]
v_exp_f32 v77, v77
v_mfma_f32_16x16x32_bf16 v[112:115], a[80:83], v[80:83], v[112:115]
v_cvt_pk_bf16_f32 v86, v76, v77
v_mfma_f32_16x16x32_bf16 v[116:119], a[84:87], v[80:83], v[116:119]
v_exp_f32 v78, v78
v_mfma_f32_16x16x32_bf16 v[120:123], a[88:91], v[80:83], v[120:123]
s_add_u32 s26, s22, 24576
v_mfma_f32_16x16x32_bf16 v[124:127], a[92:95], v[80:83], v[124:127]
s_addc_u32 s27, s23, 0
v_exp_f32 v79, v79
v_mfma_f32_16x16x32_bf16 a[208:211], a[228:231], v[80:83], a[208:211]
s_add_u32 m0, s30, 138048
s_waitcnt lgkmcnt(1)
v_cmp_gt_u32 vcc, v92, v93
v_cvt_pk_bf16_f32 v87, v78, v79
v_mfma_f32_16x16x32_bf16 v[72:75], a[32:35], v[16:19], 0
s_cbranch_vccnz L_r31
L_b31:
v_add_u32 v92, 1, v92
v_mfma_f32_16x16x32_bf16 v[72:75], a[36:39], v[20:23], v[72:75]
v_exp_f32 v64, v64
v_mfma_f32_16x16x32_bf16 v[72:75], a[40:43], v[24:27], v[72:75]
global_load_lds_dwordx4 v11, s[26:27] offset:0
v_mfma_f32_16x16x32_bf16 v[72:75], a[44:47], v[28:31], v[72:75]
v_exp_f32 v65, v65
v_mfma_f32_16x16x32_bf16 v[76:79], a[48:51], v[16:19], 0
ds_read_b64_tr_b16 a[96:97], v5 offset:56256
v_cvt_pk_bf16_f32 v80, v64, v65
v_mfma_f32_16x16x32_bf16 v[76:79], a[52:55], v[20:23], v[76:79]
s_add_u32 m0, s30, 138056
v_exp_f32 v66, v66
v_mfma_f32_16x16x32_bf16 v[76:79], a[56:59], v[24:27], v[76:79]
ds_read_b64_tr_b16 a[98:99], v5 offset:60384
ds_read_b64_tr_b16 a[100:101], v5 offset:56264
v_mfma_f32_16x16x32_bf16 v[76:79], a[60:63], v[28:31], v[76:79]
v_exp_f32 v67, v67
v_mfma_f32_16x16x32_bf16 v[128:131], a[64:67], v[84:87], v[128:131]
ds_read_b64_tr_b16 a[102:103], v5 offset:60392
v_cvt_pk_bf16_f32 v81, v66, v67
v_mfma_f32_16x16x32_bf16 v[132:135], a[68:71], v[84:87], v[132:135]
v_exp_f32 v68, v68
v_mfma_f32_16x16x32_bf16 v[136:139], a[72:75], v[84:87], v[136:139]
global_load_lds_dwordx4 v11, s[26:27] offset:1024
v_mfma_f32_16x16x32_bf16 v[140:143], a[76:79], v[84:87], v[140:143]
v_exp_f32 v69, v69
v_mfma_f32_16x16x32_bf16 v[144:147], a[80:83], v[84:87], v[144:147]
ds_read_b64_tr_b16 a[104:105], v6 offset:56256
v_cvt_pk_bf16_f32 v82, v68, v69
v_mfma_f32_16x16x32_bf16 v[148:151], a[84:87], v[84:87], v[148:151]
s_add_u32 s26, s22, 32768
v_exp_f32 v70, v70
v_mfma_f32_16x16x32_bf16 v[152:155], a[88:91], v[84:87], v[152:155]
s_addc_u32 s27, s23, 0
ds_read_b64_tr_b16 a[106:107], v6 offset:60384
ds_read_b64_tr_b16 a[108:109], v6 offset:56264
v_mfma_f32_16x16x32_bf16 v[156:159], a[92:95], v[84:87], v[156:159]
s_add_u32 m0, s30, 129792
v_exp_f32 v71, v71
v_mfma_f32_16x16x32_bf16 a[212:215], a[228:231], v[84:87], a[212:215]
ds_read_b64_tr_b16 a[110:111], v6 offset:60392
v_cvt_pk_bf16_f32 v83, v70, v71
v_mfma_f32_16x16x32_bf16 v[64:67], a[32:35], v[32:35], 0
global_load_lds_dwordx4 v11, s[26:27] offset:0
v_mfma_f32_16x16x32_bf16 v[64:67], a[36:39], v[36:39], v[64:67]
v_exp_f32 v72, v72
v_mfma_f32_16x16x32_bf16 v[64:67], a[40:43], v[40:43], v[64:67]
ds_read_b64_tr_b16 a[112:113], v7 offset:56256
ds_read_b64_tr_b16 a[114:115], v7 offset:60384
v_mfma_f32_16x16x32_bf16 v[64:67], a[44:47], v[44:47], v[64:67]
v_exp_f32 v73, v73
v_mfma_f32_16x16x32_bf16 v[68:71], a[48:51], v[32:35], 0
s_add_u32 m0, s30, 129800
ds_read_b64_tr_b16 a[116:117], v7 offset:56264
v_cvt_pk_bf16_f32 v84, v72, v73
v_mfma_f32_16x16x32_bf16 v[68:71], a[52:55], v[36:39], v[68:71]
v_exp_f32 v74, v74
v_mfma_f32_16x16x32_bf16 v[68:71], a[56:59], v[40:43], v[68:71]
ds_read_b64_tr_b16 a[118:119], v7 offset:60392
ds_read_b64_tr_b16 a[120:121], v8 offset:56256
v_mfma_f32_16x16x32_bf16 v[68:71], a[60:63], v[44:47], v[68:71]
v_exp_f32 v75, v75
v_mfma_f32_16x16x32_bf16 v[160:163], a[64:67], v[80:83], v[160:163]
ds_read_b64_tr_b16 a[122:123], v8 offset:60384
v_cvt_pk_bf16_f32 v85, v74, v75
v_mfma_f32_16x16x32_bf16 v[164:167], a[68:71], v[80:83], v[164:167]
v_exp_f32 v76, v76
v_mfma_f32_16x16x32_bf16 v[168:171], a[72:75], v[80:83], v[168:171]
global_load_lds_dwordx4 v11, s[26:27] offset:1024
v_mfma_f32_16x16x32_bf16 v[172:175], a[76:79], v[80:83], v[172:175]
v_exp_f32 v77, v77
v_mfma_f32_16x16x32_bf16 v[176:179], a[80:83], v[80:83], v[176:179]
s_add_u32 s26, s22, 40960
ds_read_b64_tr_b16 a[124:125], v8 offset:56264
v_cvt_pk_bf16_f32 v86, v76, v77
v_mfma_f32_16x16x32_bf16 v[180:183], a[84:87], v[80:83], v[180:183]
s_addc_u32 s27, s23, 0
v_exp_f32 v78, v78
v_mfma_f32_16x16x32_bf16 v[184:187], a[88:91], v[80:83], v[184:187]
s_add_u32 m0, s30, 121536
ds_read_b64_tr_b16 a[126:127], v8 offset:60392
ds_read_b64_tr_b16 a[64:65], v5 offset:6720
v_mfma_f32_16x16x32_bf16 v[188:191], a[92:95], v[80:83], v[188:191]
v_exp_f32 v79, v79
v_mfma_f32_16x16x32_bf16 a[216:219], a[228:231], v[80:83], a[216:219]
ds_read_b64_tr_b16 a[66:67], v5 offset:10848
v_cvt_pk_bf16_f32 v87, v78, v79
v_mfma_f32_16x16x32_bf16 v[72:75], a[32:35], v[48:51], 0
global_load_lds_dwordx4 v11, s[26:27] offset:0
v_mfma_f32_16x16x32_bf16 v[72:75], a[36:39], v[52:55], v[72:75]
v_exp_f32 v64, v64
v_mfma_f32_16x16x32_bf16 v[72:75], a[40:43], v[56:59], v[72:75]
buffer_store_dwordx4 v[248:251], v12, s[16:19], s64 offen offset:192 sc0 sc1
v_mfma_f32_16x16x32_bf16 v[72:75], a[44:47], v[60:63], v[72:75]
s_add_u32 m0, s30, 121544
v_exp_f32 v65, v65
v_mfma_f32_16x16x32_bf16 v[76:79], a[48:51], v[48:51], 0
ds_read_b64_tr_b16 a[68:69], v5 offset:6728
v_cvt_pk_bf16_f32 v80, v64, v65
v_mfma_f32_16x16x32_bf16 v[76:79], a[52:55], v[52:55], v[76:79]
v_exp_f32 v66, v66
v_mfma_f32_16x16x32_bf16 v[76:79], a[56:59], v[56:59], v[76:79]
ds_read_b64_tr_b16 a[70:71], v5 offset:10856
ds_read_b64_tr_b16 a[72:73], v6 offset:6720
v_mfma_f32_16x16x32_bf16 v[76:79], a[60:63], v[60:63], v[76:79]
s_waitcnt lgkmcnt(3)
v_exp_f32 v67, v67
v_mfma_f32_16x16x32_bf16 v[96:99], a[96:99], v[84:87], v[96:99]
global_load_lds_dwordx4 v11, s[26:27] offset:1024
v_cvt_pk_bf16_f32 v81, v66, v67
v_mfma_f32_16x16x32_bf16 v[100:103], a[100:103], v[84:87], v[100:103]
v_exp_f32 v68, v68
v_mfma_f32_16x16x32_bf16 v[104:107], a[104:107], v[84:87], v[104:107]
ds_read_b64_tr_b16 a[74:75], v6 offset:10848
ds_read_b64_tr_b16 a[76:77], v6 offset:6728
v_mfma_f32_16x16x32_bf16 v[108:111], a[108:111], v[84:87], v[108:111]
v_exp_f32 v69, v69
v_mfma_f32_16x16x32_bf16 v[112:115], a[112:115], v[84:87], v[112:115]
ds_read_b64_tr_b16 a[78:79], v6 offset:10856
v_cvt_pk_bf16_f32 v82, v68, v69
v_mfma_f32_16x16x32_bf16 v[116:119], a[116:119], v[84:87], v[116:119]
v_exp_f32 v70, v70
v_mfma_f32_16x16x32_bf16 v[120:123], a[120:123], v[84:87], v[120:123]
ds_read_b64_tr_b16 a[80:81], v7 offset:6720
ds_read_b64_tr_b16 a[82:83], v7 offset:10848
v_mfma_f32_16x16x32_bf16 v[124:127], a[124:127], v[84:87], v[124:127]
v_exp_f32 v71, v71
v_mfma_f32_16x16x32_bf16 a[208:211], a[228:231], v[84:87], a[208:211]
ds_read_b64_tr_b16 a[84:85], v7 offset:6728
v_cvt_pk_bf16_f32 v83, v70, v71
v_mfma_f32_16x16x32_bf16 v[64:67], a[0:3], v[16:19], 0
ds_read_b64_tr_b16 a[86:87], v7 offset:10856
ds_read_b64_tr_b16 a[88:89], v8 offset:6720
v_mfma_f32_16x16x32_bf16 v[64:67], a[4:7], v[20:23], v[64:67]
v_exp_f32 v72, v72
v_mfma_f32_16x16x32_bf16 v[64:67], a[8:11], v[24:27], v[64:67]
ds_read_b64_tr_b16 a[90:91], v8 offset:10848
ds_read_b64_tr_b16 a[92:93], v8 offset:6728
v_mfma_f32_16x16x32_bf16 v[64:67], a[12:15], v[28:31], v[64:67]
v_exp_f32 v73, v73
v_mfma_f32_16x16x32_bf16 v[68:71], a[16:19], v[16:19], 0
ds_read_b64_tr_b16 a[94:95], v8 offset:10856
v_cvt_pk_bf16_f32 v84, v72, v73
v_mfma_f32_16x16x32_bf16 v[68:71], a[20:23], v[20:23], v[68:71]
v_exp_f32 v74, v74
v_mfma_f32_16x16x32_bf16 v[68:71], a[24:27], v[24:27], v[68:71]
ds_read_b128 a[32:35], v1 offset:8192
ds_read_b128 a[36:39], v2 offset:8192
v_mfma_f32_16x16x32_bf16 v[68:71], a[28:31], v[28:31], v[68:71]
v_exp_f32 v75, v75
v_mfma_f32_16x16x32_bf16 v[128:131], a[96:99], v[80:83], v[128:131]
ds_read_b128 a[40:43], v3 offset:8192
v_cvt_pk_bf16_f32 v85, v74, v75
v_mfma_f32_16x16x32_bf16 v[132:135], a[100:103], v[80:83], v[132:135]
v_exp_f32 v76, v76
v_mfma_f32_16x16x32_bf16 v[136:139], a[104:107], v[80:83], v[136:139]
ds_read_b128 a[44:47], v4 offset:8192
ds_read_b128 a[48:51], v1 offset:12288
v_mfma_f32_16x16x32_bf16 v[140:143], a[108:111], v[80:83], v[140:143]
v_exp_f32 v77, v77
v_mfma_f32_16x16x32_bf16 v[144:147], a[112:115], v[80:83], v[144:147]
ds_read_b128 a[52:55], v2 offset:12288
v_cvt_pk_bf16_f32 v86, v76, v77
v_mfma_f32_16x16x32_bf16 v[148:151], a[116:119], v[80:83], v[148:151]
v_exp_f32 v78, v78
v_mfma_f32_16x16x32_bf16 v[152:155], a[120:123], v[80:83], v[152:155]
ds_read_b128 a[56:59], v3 offset:12288
ds_read_b128 a[60:63], v4 offset:12288
v_mfma_f32_16x16x32_bf16 v[156:159], a[124:127], v[80:83], v[156:159]
v_exp_f32 v79, v79
v_mfma_f32_16x16x32_bf16 a[212:215], a[228:231], v[80:83], a[212:215]
v_cvt_pk_bf16_f32 v87, v78, v79
v_mfma_f32_16x16x32_bf16 v[72:75], a[0:3], v[32:35], 0
v_mfma_f32_16x16x32_bf16 v[72:75], a[4:7], v[36:39], v[72:75]
v_exp_f32 v64, v64
v_mfma_f32_16x16x32_bf16 v[72:75], a[8:11], v[40:43], v[72:75]
v_mfma_f32_16x16x32_bf16 v[72:75], a[12:15], v[44:47], v[72:75]
v_exp_f32 v65, v65
v_mfma_f32_16x16x32_bf16 v[76:79], a[16:19], v[32:35], 0
v_cvt_pk_bf16_f32 v80, v64, v65
v_mfma_f32_16x16x32_bf16 v[76:79], a[20:23], v[36:39], v[76:79]
v_exp_f32 v66, v66
v_mfma_f32_16x16x32_bf16 v[76:79], a[24:27], v[40:43], v[76:79]
v_mfma_f32_16x16x32_bf16 v[76:79], a[28:31], v[44:47], v[76:79]
v_exp_f32 v67, v67
v_mfma_f32_16x16x32_bf16 v[160:163], a[96:99], v[84:87], v[160:163]
ds_read_b64_tr_b16 a[96:97], v5 offset:48000
v_cvt_pk_bf16_f32 v81, v66, v67
v_mfma_f32_16x16x32_bf16 v[164:167], a[100:103], v[84:87], v[164:167]
v_exp_f32 v68, v68
v_mfma_f32_16x16x32_bf16 v[168:171], a[104:107], v[84:87], v[168:171]
ds_read_b64_tr_b16 a[98:99], v5 offset:52128
ds_read_b64_tr_b16 a[100:101], v5 offset:48008
v_mfma_f32_16x16x32_bf16 v[172:175], a[108:111], v[84:87], v[172:175]
v_exp_f32 v69, v69
v_mfma_f32_16x16x32_bf16 v[176:179], a[112:115], v[84:87], v[176:179]
ds_read_b64_tr_b16 a[102:103], v5 offset:52136
v_cvt_pk_bf16_f32 v82, v68, v69
v_mfma_f32_16x16x32_bf16 v[180:183], a[116:119], v[84:87], v[180:183]
v_exp_f32 v70, v70
v_mfma_f32_16x16x32_bf16 v[184:187], a[120:123], v[84:87], v[184:187]
ds_read_b64_tr_b16 a[104:105], v6 offset:48000
ds_read_b64_tr_b16 a[106:107], v6 offset:52128
v_mfma_f32_16x16x32_bf16 v[188:191], a[124:127], v[84:87], v[188:191]
v_exp_f32 v71, v71
v_mfma_f32_16x16x32_bf16 a[216:219], a[228:231], v[84:87], a[216:219]
ds_read_b64_tr_b16 a[108:109], v6 offset:48008
v_cvt_pk_bf16_f32 v83, v70, v71
v_mfma_f32_16x16x32_bf16 v[64:67], a[0:3], v[48:51], 0
ds_read_b128 a[0:3], v1 offset:16384
ds_read_b64_tr_b16 a[110:111], v6 offset:52136
v_mfma_f32_16x16x32_bf16 v[64:67], a[4:7], v[52:55], v[64:67]
v_exp_f32 v72, v72
v_mfma_f32_16x16x32_bf16 v[64:67], a[8:11], v[56:59], v[64:67]
ds_read_b128 a[4:7], v2 offset:16384
ds_read_b128 a[8:11], v3 offset:16384
v_mfma_f32_16x16x32_bf16 v[64:67], a[12:15], v[60:63], v[64:67]
v_exp_f32 v73, v73
v_mfma_f32_16x16x32_bf16 v[68:71], a[16:19], v[48:51], 0
ds_read_b128 a[12:15], v4 offset:16384
v_cvt_pk_bf16_f32 v84, v72, v73
v_mfma_f32_16x16x32_bf16 v[68:71], a[20:23], v[52:55], v[68:71]
v_exp_f32 v74, v74
v_mfma_f32_16x16x32_bf16 v[68:71], a[24:27], v[56:59], v[68:71]
ds_read_b128 a[16:19], v1 offset:20480
ds_read_b128 a[20:23], v2 offset:20480
v_mfma_f32_16x16x32_bf16 v[68:71], a[28:31], v[60:63], v[68:71]
v_exp_f32 v75, v75
v_mfma_f32_16x16x32_bf16 a[208:211], a[228:231], v[80:83], a[208:211]
ds_read_b128 a[24:27], v3 offset:20480
v_cvt_pk_bf16_f32 v85, v74, v75
v_mfma_f32_16x16x32_bf16 v[96:99], a[64:67], v[80:83], v[96:99]
s_waitcnt lgkmcnt(15)
v_exp_f32 v76, v76
v_mfma_f32_16x16x32_bf16 v[100:103], a[68:71], v[80:83], v[100:103]
ds_read_b128 a[28:31], v4 offset:20480
ds_read_b64_tr_b16 a[112:113], v7 offset:48000
v_mfma_f32_16x16x32_bf16 v[104:107], a[72:75], v[80:83], v[104:107]
v_exp_f32 v77, v77
v_mfma_f32_16x16x32_bf16 v[108:111], a[76:79], v[80:83], v[108:111]
v_accvgpr_read_b32 v91, a208
v_subrev_u32 v88, s36, v91
v_cmp_lt_u32 s[80:81], s33, v88
v_mfma_f32_16x16x32_bf16 v[112:115], a[80:83], v[80:83], v[112:115]
v_exp_f32 v78, v78
v_cvt_pk_bf16_f32 v86, v76, v77
v_mfma_f32_16x16x32_bf16 v[116:119], a[84:87], v[80:83], v[116:119]
v_rcp_f32 v91, v91
v_mfma_f32_16x16x32_bf16 v[120:123], a[88:91], v[80:83], v[120:123]
v_exp_f32 v79, v79
v_mul_f32 v96, v91, v96
v_mfma_f32_16x16x32_bf16 v[124:127], a[92:95], v[80:83], v[124:127]
v_mul_f32 v97, v91, v97
v_mul_f32 v98, v91, v98
v_mul_f32 v99, v91, v99
v_mfma_f32_16x16x32_bf16 v[72:75], a[32:35], v[32:35], 0
v_mul_f32 v100, v91, v100
v_mul_f32 v101, v91, v101
v_mul_f32 v102, v91, v102
v_mfma_f32_16x16x32_bf16 v[72:75], a[36:39], v[36:39], v[72:75]
v_exp_f32 v64, v64
v_mul_f32 v103, v91, v103
v_mfma_f32_16x16x32_bf16 v[72:75], a[40:43], v[40:43], v[72:75]
v_cvt_pk_bf16_f32 v96, v96, v97
v_cvt_pk_bf16_f32 v97, v98, v99
v_cvt_pk_bf16_f32 v98, v100, v101
v_mfma_f32_16x16x32_bf16 v[72:75], a[44:47], v[44:47], v[72:75]
v_cvt_pk_bf16_f32 v87, v78, v79
v_exp_f32 v65, v65
v_mfma_f32_16x16x32_bf16 v[76:79], a[48:51], v[32:35], 0
v_cvt_pk_bf16_f32 v99, v102, v103
v_cvt_pk_bf16_f32 v80, v64, v65
v_mfma_f32_16x16x32_bf16 v[76:79], a[52:55], v[36:39], v[76:79]
v_exp_f32 v66, v66
v_mfma_f32_16x16x32_bf16 v[76:79], a[56:59], v[40:43], v[76:79]
buffer_store_dwordx4 v[96:99], v12, s[16:19], s65 offen offset:0 sc0 sc1
v_mul_f32 v104, v91, v104
v_mfma_f32_16x16x32_bf16 v[76:79], a[60:63], v[44:47], v[76:79]
v_exp_f32 v67, v67
v_mul_f32 v105, v91, v105
v_mfma_f32_16x16x32_bf16 v[128:131], a[64:67], v[84:87], v[128:131]
v_mul_f32 v106, v91, v106
v_mul_f32 v107, v91, v107
v_mul_f32 v108, v91, v108
v_mfma_f32_16x16x32_bf16 v[132:135], a[68:71], v[84:87], v[132:135]
v_exp_f32 v68, v68
v_mul_f32 v109, v91, v109
v_mfma_f32_16x16x32_bf16 v[136:139], a[72:75], v[84:87], v[136:139]
v_mul_f32 v110, v91, v110
v_mul_f32 v111, v91, v111
v_cvt_pk_bf16_f32 v104, v104, v105
v_mfma_f32_16x16x32_bf16 v[140:143], a[76:79], v[84:87], v[140:143]
v_exp_f32 v69, v69
v_cvt_pk_bf16_f32 v105, v106, v107
v_mfma_f32_16x16x32_bf16 v[144:147], a[80:83], v[84:87], v[144:147]
v_cvt_pk_bf16_f32 v106, v108, v109
v_cvt_pk_bf16_f32 v107, v110, v111
v_cvt_pk_bf16_f32 v81, v66, v67
v_mfma_f32_16x16x32_bf16 v[148:151], a[84:87], v[84:87], v[148:151]
v_exp_f32 v70, v70
v_cvt_pk_bf16_f32 v82, v68, v69
v_mfma_f32_16x16x32_bf16 v[152:155], a[88:91], v[84:87], v[152:155]
s_waitcnt vmcnt(1)
ds_write_b32 v0, v92
ds_read_b64_tr_b16 a[114:115], v7 offset:52128
v_mfma_f32_16x16x32_bf16 v[156:159], a[92:95], v[84:87], v[156:159]
v_exp_f32 v71, v71
buffer_store_dwordx4 v[104:107], v12, s[16:19], s65 offen offset:64 sc0 sc1
v_mul_f32 v112, v91, v112
v_mul_f32 v113, v91, v113
v_mul_f32 v114, v91, v114
v_mul_f32 v115, v91, v115
v_mul_f32 v116, v91, v116
v_mul_f32 v117, v91, v117
v_mul_f32 v118, v91, v118
v_mul_f32 v119, v91, v119
v_cvt_pk_bf16_f32 v112, v112, v113
v_cvt_pk_bf16_f32 v113, v114, v115
v_cvt_pk_bf16_f32 v114, v116, v117
v_cvt_pk_bf16_f32 v115, v118, v119
buffer_store_dwordx4 v[112:115], v12, s[16:19], s65 offen offset:128 sc0 sc1
v_mul_f32 v120, v91, v120
v_mul_f32 v121, v91, v121
v_mul_f32 v122, v91, v122
v_mul_f32 v123, v91, v123
v_mul_f32 v124, v91, v124
v_mul_f32 v125, v91, v125
v_mul_f32 v126, v91, v126
v_mul_f32 v127, v91, v127
v_cvt_pk_bf16_f32 v120, v120, v121
v_cvt_pk_bf16_f32 v121, v122, v123
v_cvt_pk_bf16_f32 v122, v124, v125
v_cvt_pk_bf16_f32 v123, v126, v127
buffer_store_dwordx4 v[120:123], v12, s[16:19], s65 offen offset:192 sc0 sc1
v_mfma_f32_16x16x32_bf16 a[212:215], a[228:231], v[84:87], a[212:215]
ds_read_b64_tr_b16 a[116:117], v7 offset:48008
v_cvt_pk_bf16_f32 v83, v70, v71
v_mfma_f32_16x16x32_bf16 v[64:67], a[32:35], v[48:51], 0
ds_read_b64_tr_b16 a[118:119], v7 offset:52136
ds_read_b64_tr_b16 a[120:121], v8 offset:48000
v_mfma_f32_16x16x32_bf16 v[64:67], a[36:39], v[52:55], v[64:67]
v_exp_f32 v72, v72
v_mfma_f32_16x16x32_bf16 v[64:67], a[40:43], v[56:59], v[64:67]
ds_read_b64_tr_b16 a[122:123], v8 offset:52128
ds_read_b64_tr_b16 a[124:125], v8 offset:48008
v_mfma_f32_16x16x32_bf16 v[64:67], a[44:47], v[60:63], v[64:67]
v_exp_f32 v73, v73
v_mfma_f32_16x16x32_bf16 v[68:71], a[48:51], v[48:51], 0
ds_read_b64_tr_b16 a[126:127], v8 offset:52136
v_cvt_pk_bf16_f32 v84, v72, v73
v_mfma_f32_16x16x32_bf16 v[68:71], a[52:55], v[52:55], v[68:71]
v_exp_f32 v74, v74
v_mfma_f32_16x16x32_bf16 v[68:71], a[56:59], v[56:59], v[68:71]
ds_read_b128 a[32:35], v1 offset:24576
ds_read_b128 a[36:39], v2 offset:24576
v_mfma_f32_16x16x32_bf16 v[68:71], a[60:63], v[60:63], v[68:71]
v_exp_f32 v75, v75
v_mfma_f32_16x16x32_bf16 v[160:163], a[64:67], v[80:83], v[160:163]
ds_read_b128 a[40:43], v3 offset:24576
v_cvt_pk_bf16_f32 v85, v74, v75
v_mfma_f32_16x16x32_bf16 v[164:167], a[68:71], v[80:83], v[164:167]
v_exp_f32 v76, v76
v_mfma_f32_16x16x32_bf16 v[168:171], a[72:75], v[80:83], v[168:171]
ds_read_b32 v93, v90
ds_read_b128 a[44:47], v4 offset:24576
v_mfma_f32_16x16x32_bf16 v[172:175], a[76:79], v[80:83], v[172:175]
v_exp_f32 v77, v77
v_mfma_f32_16x16x32_bf16 v[176:179], a[80:83], v[80:83], v[176:179]
ds_read_b128 a[48:51], v1 offset:28672
v_cvt_pk_bf16_f32 v86, v76, v77
v_mfma_f32_16x16x32_bf16 v[180:183], a[84:87], v[80:83], v[180:183]
v_exp_f32 v78, v78
v_mfma_f32_16x16x32_bf16 v[184:187], a[88:91], v[80:83], v[184:187]
ds_read_b128 a[52:55], v2 offset:28672
ds_read_b128 a[56:59], v3 offset:28672
v_mfma_f32_16x16x32_bf16 v[188:191], a[92:95], v[80:83], v[188:191]
v_exp_f32 v79, v79
v_mfma_f32_16x16x32_bf16 a[216:219], a[228:231], v[80:83], a[216:219]
s_waitcnt lgkmcnt(4)
v_cmp_gt_u32 vcc, v92, v93
v_cvt_pk_bf16_f32 v87, v78, v79
v_mfma_f32_16x16x32_bf16 v[72:75], a[0:3], v[32:35], 0
s_cbranch_vccnz L_r34
L_b34:
ds_read_b128 a[60:63], v4 offset:28672
v_add_u32 v92, 1, v92
v_mfma_f32_16x16x32_bf16 v[72:75], a[4:7], v[36:39], v[72:75]
v_exp_f32 v64, v64
v_mfma_f32_16x16x32_bf16 v[72:75], a[8:11], v[40:43], v[72:75]
ds_read_b64_tr_b16 a[64:65], v5 offset:14976
ds_read_b64_tr_b16 a[66:67], v5 offset:19104
v_mfma_f32_16x16x32_bf16 v[72:75], a[12:15], v[44:47], v[72:75]
v_exp_f32 v65, v65
v_mfma_f32_16x16x32_bf16 v[76:79], a[16:19], v[32:35], 0
ds_read_b64_tr_b16 a[68:69], v5 offset:14984
v_cvt_pk_bf16_f32 v80, v64, v65
v_mfma_f32_16x16x32_bf16 v[76:79], a[20:23], v[36:39], v[76:79]
v_exp_f32 v66, v66
v_mfma_f32_16x16x32_bf16 v[76:79], a[24:27], v[40:43], v[76:79]
ds_read_b64_tr_b16 a[70:71], v5 offset:19112
ds_read_b64_tr_b16 a[72:73], v6 offset:14976
v_mfma_f32_16x16x32_bf16 v[76:79], a[28:31], v[44:47], v[76:79]
v_exp_f32 v67, v67
v_mfma_f32_16x16x32_bf16 v[128:131], a[96:99], v[84:87], v[128:131]
ds_read_b64_tr_b16 a[74:75], v6 offset:19104
v_cvt_pk_bf16_f32 v81, v66, v67
v_mfma_f32_16x16x32_bf16 v[132:135], a[100:103], v[84:87], v[132:135]
v_exp_f32 v68, v68
v_mfma_f32_16x16x32_bf16 v[136:139], a[104:107], v[84:87], v[136:139]
ds_read_b64_tr_b16 a[76:77], v6 offset:14984
ds_read_b64_tr_b16 a[78:79], v6 offset:19112
v_mfma_f32_16x16x32_bf16 v[140:143], a[108:111], v[84:87], v[140:143]
v_exp_f32 v69, v69
v_mfma_f32_16x16x32_bf16 v[144:147], a[112:115], v[84:87], v[144:147]
ds_read_b64_tr_b16 a[80:81], v7 offset:14976
v_cvt_pk_bf16_f32 v82, v68, v69
v_mfma_f32_16x16x32_bf16 v[148:151], a[116:119], v[84:87], v[148:151]
v_exp_f32 v70, v70
v_mfma_f32_16x16x32_bf16 v[152:155], a[120:123], v[84:87], v[152:155]
ds_read_b64_tr_b16 a[82:83], v7 offset:19104
ds_read_b64_tr_b16 a[84:85], v7 offset:14984
v_mfma_f32_16x16x32_bf16 v[156:159], a[124:127], v[84:87], v[156:159]
v_exp_f32 v71, v71
v_mfma_f32_16x16x32_bf16 a[212:215], a[228:231], v[84:87], a[212:215]
ds_read_b64_tr_b16 a[86:87], v7 offset:19112
v_cvt_pk_bf16_f32 v83, v70, v71
v_mfma_f32_16x16x32_bf16 v[64:67], a[0:3], v[48:51], 0
ds_read_b64_tr_b16 a[88:89], v8 offset:14976
ds_read_b64_tr_b16 a[90:91], v8 offset:19104
v_mfma_f32_16x16x32_bf16 v[64:67], a[4:7], v[52:55], v[64:67]
v_exp_f32 v72, v72
v_mfma_f32_16x16x32_bf16 v[64:67], a[8:11], v[56:59], v[64:67]
ds_read_b64_tr_b16 a[92:93], v8 offset:14984
ds_read_b64_tr_b16 a[94:95], v8 offset:19112
v_mfma_f32_16x16x32_bf16 v[64:67], a[12:15], v[60:63], v[64:67]
v_exp_f32 v73, v73
v_mfma_f32_16x16x32_bf16 v[68:71], a[16:19], v[48:51], 0
ds_read_b128 a[0:3], v1 offset:32768
v_cvt_pk_bf16_f32 v84, v72, v73
v_mfma_f32_16x16x32_bf16 v[68:71], a[20:23], v[52:55], v[68:71]
v_exp_f32 v74, v74
v_mfma_f32_16x16x32_bf16 v[68:71], a[24:27], v[56:59], v[68:71]
ds_read_b128 a[4:7], v2 offset:32768
ds_read_b128 a[8:11], v3 offset:32768
v_mfma_f32_16x16x32_bf16 v[68:71], a[28:31], v[60:63], v[68:71]
v_exp_f32 v75, v75
v_mfma_f32_16x16x32_bf16 v[160:163], a[96:99], v[80:83], v[160:163]
ds_read_b128 a[12:15], v4 offset:32768
v_cvt_pk_bf16_f32 v85, v74, v75
v_mfma_f32_16x16x32_bf16 v[164:167], a[100:103], v[80:83], v[164:167]
v_exp_f32 v76, v76
v_mfma_f32_16x16x32_bf16 v[168:171], a[104:107], v[80:83], v[168:171]
ds_read_b128 a[16:19], v1 offset:36864
ds_read_b128 a[20:23], v2 offset:36864
v_mfma_f32_16x16x32_bf16 v[172:175], a[108:111], v[80:83], v[172:175]
v_exp_f32 v77, v77
v_mfma_f32_16x16x32_bf16 v[176:179], a[112:115], v[80:83], v[176:179]
ds_read_b128 a[24:27], v3 offset:36864
v_cvt_pk_bf16_f32 v86, v76, v77
v_mfma_f32_16x16x32_bf16 v[180:183], a[116:119], v[80:83], v[180:183]
v_exp_f32 v78, v78
v_mfma_f32_16x16x32_bf16 v[184:187], a[120:123], v[80:83], v[184:187]
ds_read_b128 a[28:31], v4 offset:36864
ds_read_b64_tr_b16 a[96:97], v5 offset:39744
v_mfma_f32_16x16x32_bf16 v[188:191], a[124:127], v[80:83], v[188:191]
v_exp_f32 v79, v79
v_mfma_f32_16x16x32_bf16 a[216:219], a[228:231], v[80:83], a[216:219]
ds_read_b64_tr_b16 a[98:99], v5 offset:43872
v_cvt_pk_bf16_f32 v87, v78, v79
v_mfma_f32_16x16x32_bf16 v[72:75], a[32:35], v[48:51], 0
ds_read_b128 a[32:35], v1 offset:40960
ds_read_b64_tr_b16 a[100:101], v5 offset:39752
v_mfma_f32_16x16x32_bf16 v[72:75], a[36:39], v[52:55], v[72:75]
v_exp_f32 v64, v64
v_mfma_f32_16x16x32_bf16 v[72:75], a[40:43], v[56:59], v[72:75]
ds_read_b128 a[36:39], v2 offset:40960
ds_read_b128 a[40:43], v3 offset:40960
s_waitcnt lgkmcnt(15)
v_mfma_f32_16x16x32_bf16 v[72:75], a[44:47], v[60:63], v[72:75]
v_exp_f32 v65, v65
v_mfma_f32_16x16x32_bf16 v[76:79], a[48:51], v[48:51], 0
ds_read_b128 a[44:47], v4 offset:40960
v_cvt_pk_bf16_f32 v80, v64, v65
v_mfma_f32_16x16x32_bf16 v[76:79], a[52:55], v[52:55], v[76:79]
v_exp_f32 v66, v66
v_mfma_f32_16x16x32_bf16 v[76:79], a[56:59], v[56:59], v[76:79]
ds_read_b128 a[48:51], v1 offset:45056
ds_read_b128 a[52:55], v2 offset:45056
v_mfma_f32_16x16x32_bf16 v[76:79], a[60:63], v[60:63], v[76:79]
v_exp_f32 v67, v67
v_mfma_f32_16x16x32_bf16 a[212:215], a[228:231], v[84:87], a[212:215]
ds_read_b64_tr_b16 a[102:103], v5 offset:43880
v_cvt_pk_bf16_f32 v81, v66, v67
v_mfma_f32_16x16x32_bf16 v[128:131], a[64:67], v[84:87], v[128:131]
v_exp_f32 v68, v68
v_mfma_f32_16x16x32_bf16 v[132:135], a[68:71], v[84:87], v[132:135]
ds_read_b128 a[56:59], v3 offset:45056
ds_read_b64_tr_b16 a[104:105], v6 offset:39744
v_mfma_f32_16x16x32_bf16 v[136:139], a[72:75], v[84:87], v[136:139]
v_exp_f32 v69, v69
v_mfma_f32_16x16x32_bf16 v[140:143], a[76:79], v[84:87], v[140:143]
v_accvgpr_read_b32 v91, a212
v_subrev_u32 v88, s36, v91
v_cmp_lt_u32 s[82:83], s33, v88
v_mfma_f32_16x16x32_bf16 v[144:147], a[80:83], v[84:87], v[144:147]
v_exp_f32 v70, v70
v_cvt_pk_bf16_f32 v82, v68, v69
v_mfma_f32_16x16x32_bf16 v[148:151], a[84:87], v[84:87], v[148:151]
v_rcp_f32 v91, v91
v_mfma_f32_16x16x32_bf16 v[152:155], a[88:91], v[84:87], v[152:155]
s_waitcnt lgkmcnt(4)
v_exp_f32 v71, v71
v_mul_f32 v128, v91, v128
v_mfma_f32_16x16x32_bf16 v[156:159], a[92:95], v[84:87], v[156:159]
v_mul_f32 v129, v91, v129
v_mul_f32 v130, v91, v130
v_mul_f32 v131, v91, v131
v_mfma_f32_16x16x32_bf16 v[64:67], a[0:3], v[48:51], 0
v_mul_f32 v132, v91, v132
v_mul_f32 v133, v91, v133
v_mul_f32 v134, v91, v134
v_mfma_f32_16x16x32_bf16 v[64:67], a[4:7], v[52:55], v[64:67]
v_exp_f32 v72, v72
v_mul_f32 v135, v91, v135
v_mfma_f32_16x16x32_bf16 v[64:67], a[8:11], v[56:59], v[64:67]
v_cvt_pk_bf16_f32 v128, v128, v129
v_cvt_pk_bf16_f32 v129, v130, v131
v_cvt_pk_bf16_f32 v130, v132, v133
v_mfma_f32_16x16x32_bf16 v[64:67], a[12:15], v[60:63], v[64:67]
v_cvt_pk_bf16_f32 v83, v70, v71
v_exp_f32 v73, v73
v_mfma_f32_16x16x32_bf16 v[68:71], a[16:19], v[48:51], 0
v_cvt_pk_bf16_f32 v131, v134, v135
v_cvt_pk_bf16_f32 v84, v72, v73
v_mfma_f32_16x16x32_bf16 v[68:71], a[20:23], v[52:55], v[68:71]
v_exp_f32 v74, v74
v_mfma_f32_16x16x32_bf16 v[68:71], a[24:27], v[56:59], v[68:71]
buffer_store_dwordx4 v[128:131], v12, s[16:19], s66 offen offset:0 sc0 sc1
v_mul_f32 v136, v91, v136
v_mfma_f32_16x16x32_bf16 v[68:71], a[28:31], v[60:63], v[68:71]
v_exp_f32 v75, v75
v_mul_f32 v137, v91, v137
v_mfma_f32_16x16x32_bf16 v[160:163], a[64:67], v[80:83], v[160:163]
v_mul_f32 v138, v91, v138
v_mul_f32 v139, v91, v139
v_mul_f32 v140, v91, v140
v_mfma_f32_16x16x32_bf16 v[164:167], a[68:71], v[80:83], v[164:167]
v_exp_f32 v76, v76
v_mul_f32 v141, v91, v141
v_mfma_f32_16x16x32_bf16 v[168:171], a[72:75], v[80:83], v[168:171]
v_mul_f32 v142, v91, v142
v_mul_f32 v143, v91, v143
v_cvt_pk_bf16_f32 v136, v136, v137
v_mfma_f32_16x16x32_bf16 v[172:175], a[76:79], v[80:83], v[172:175]
v_exp_f32 v77, v77
v_cvt_pk_bf16_f32 v137, v138, v139
v_mfma_f32_16x16x32_bf16 v[176:179], a[80:83], v[80:83], v[176:179]
v_cvt_pk_bf16_f32 v138, v140, v141
v_cvt_pk_bf16_f32 v139, v142, v143
v_cvt_pk_bf16_f32 v85, v74, v75
v_mfma_f32_16x16x32_bf16 v[180:183], a[84:87], v[80:83], v[180:183]
ds_read_b64_tr_b16 a[106:107], v6 offset:43872
v_exp_f32 v78, v78
v_mfma_f32_16x16x32_bf16 v[184:187], a[88:91], v[80:83], v[184:187]
buffer_store_dwordx4 v[136:139], v12, s[16:19], s66 offen offset:64 sc0 sc1
v_mul_f32 v144, v91, v144
v_mfma_f32_16x16x32_bf16 v[188:191], a[92:95], v[80:83], v[188:191]
v_exp_f32 v79, v79
v_mul_f32 v145, v91, v145
v_mul_f32 v146, v91, v146
v_mul_f32 v147, v91, v147
v_mul_f32 v148, v91, v148
v_mul_f32 v149, v91, v149
v_mul_f32 v150, v91, v150
v_mul_f32 v151, v91, v151
v_cvt_pk_bf16_f32 v144, v144, v145
v_cvt_pk_bf16_f32 v145, v146, v147
v_cvt_pk_bf16_f32 v146, v148, v149
v_cvt_pk_bf16_f32 v147, v150, v151
buffer_store_dwordx4 v[144:147], v12, s[16:19], s66 offen offset:128 sc0 sc1
v_mul_f32 v152, v91, v152
v_mul_f32 v153, v91, v153
v_mul_f32 v154, v91, v154
v_mul_f32 v155, v91, v155
v_mul_f32 v156, v91, v156
v_mul_f32 v157, v91, v157
v_mul_f32 v158, v91, v158
v_mul_f32 v159, v91, v159
v_cvt_pk_bf16_f32 v152, v152, v153
v_cvt_pk_bf16_f32 v153, v154, v155
v_cvt_pk_bf16_f32 v154, v156, v157
v_cvt_pk_bf16_f32 v155, v158, v159
buffer_store_dwordx4 v[152:155], v12, s[16:19], s66 offen offset:192 sc0 sc1
v_mfma_f32_16x16x32_bf16 a[216:219], a[228:231], v[80:83], a[216:219]
ds_read_b128 a[60:63], v4 offset:45056
ds_read_b64_tr_b16 a[108:109], v6 offset:39752
v_cvt_pk_bf16_f32 v86, v76, v77
v_mfma_f32_16x16x32_bf16 v[72:75], a[32:35], v[48:51], 0
ds_read_b64_tr_b16 a[110:111], v6 offset:43880
ds_read_b64_tr_b16 a[112:113], v7 offset:39744
v_cvt_pk_bf16_f32 v87, v78, v79
v_mfma_f32_16x16x32_bf16 v[72:75], a[36:39], v[52:55], v[72:75]
ds_read_b64_tr_b16 a[114:115], v7 offset:43872
v_exp_f32 v64, v64
v_mfma_f32_16x16x32_bf16 v[72:75], a[40:43], v[56:59], v[72:75]
ds_read_b64_tr_b16 a[116:117], v7 offset:39752
ds_read_b64_tr_b16 a[118:119], v7 offset:43880
v_mfma_f32_16x16x32_bf16 v[72:75], a[44:47], v[60:63], v[72:75]
ds_read_b64_tr_b16 a[120:121], v8 offset:39744
v_exp_f32 v65, v65
v_mfma_f32_16x16x32_bf16 v[76:79], a[48:51], v[48:51], 0
ds_read_b64_tr_b16 a[122:123], v8 offset:43872
ds_read_b64_tr_b16 a[124:125], v8 offset:39752
s_waitcnt lgkmcnt(10)
v_cvt_pk_bf16_f32 v80, v64, v65
v_mfma_f32_16x16x32_bf16 v[76:79], a[52:55], v[52:55], v[76:79]
ds_read_b64_tr_b16 a[126:127], v8 offset:43880
v_exp_f32 v66, v66
v_mfma_f32_16x16x32_bf16 v[76:79], a[56:59], v[56:59], v[76:79]
ds_read_b64_tr_b16 a[64:65], v5 offset:31488
ds_read_b64_tr_b16 a[66:67], v5 offset:35616
s_waitcnt lgkmcnt(9)
v_mfma_f32_16x16x32_bf16 v[76:79], a[60:63], v[60:63], v[76:79]
ds_read_b64_tr_b16 a[68:69], v5 offset:31496
v_exp_f32 v67, v67
v_mfma_f32_16x16x32_bf16 v[160:163], a[96:99], v[84:87], v[160:163]
ds_read_b64_tr_b16 a[70:71], v5 offset:35624
ds_read_b64_tr_b16 a[72:73], v6 offset:31488
v_cvt_pk_bf16_f32 v81, v66, v67
v_mfma_f32_16x16x32_bf16 v[164:167], a[100:103], v[84:87], v[164:167]
ds_read_b64_tr_b16 a[74:75], v6 offset:35616
v_exp_f32 v68, v68
v_mfma_f32_16x16x32_bf16 v[168:171], a[104:107], v[84:87], v[168:171]
ds_read_b64_tr_b16 a[76:77], v6 offset:31496
ds_read_b64_tr_b16 a[78:79], v6 offset:35624
v_mfma_f32_16x16x32_bf16 v[172:175], a[108:111], v[84:87], v[172:175]
ds_read_b64_tr_b16 a[80:81], v7 offset:31488
s_waitcnt lgkmcnt(9)
v_exp_f32 v69, v69
v_mfma_f32_16x16x32_bf16 v[176:179], a[112:115], v[84:87], v[176:179]
ds_read_b64_tr_b16 a[82:83], v7 offset:35616
ds_read_b64_tr_b16 a[84:85], v7 offset:31496
ds_read_b64_tr_b16 a[86:87], v7 offset:35624
v_mfma_f32_16x16x32_bf16 v[180:183], a[116:119], v[84:87], v[180:183]
ds_read_b64_tr_b16 a[88:89], v8 offset:31488
v_exp_f32 v70, v70
v_mfma_f32_16x16x32_bf16 v[184:187], a[120:123], v[84:87], v[184:187]
ds_read_b64_tr_b16 a[90:91], v8 offset:35616
v_exp_f32 v71, v71
v_mfma_f32_16x16x32_bf16 v[188:191], a[124:127], v[84:87], v[188:191]
ds_read_b64_tr_b16 a[92:93], v8 offset:31496
v_cvt_pk_bf16_f32 v82, v68, v69
v_cvt_pk_bf16_f32 v83, v70, v71
v_mfma_f32_16x16x32_bf16 a[216:219], a[228:231], v[84:87], a[216:219]
ds_read_b64_tr_b16 a[94:95], v8 offset:35624
ds_read_b64_tr_b16 a[96:97], v5 offset:23232
s_waitcnt lgkmcnt(9)
v_mfma_f32_16x16x32_bf16 v[160:163], a[64:67], v[80:83], v[160:163]
ds_read_b64_tr_b16 a[98:99], v5 offset:27360
v_exp_f32 v72, v72
v_mfma_f32_16x16x32_bf16 v[164:167], a[68:71], v[80:83], v[164:167]
ds_read_b64_tr_b16 a[100:101], v5 offset:23240
v_exp_f32 v73, v73
v_mfma_f32_16x16x32_bf16 v[168:171], a[72:75], v[80:83], v[168:171]
ds_read_b64_tr_b16 a[102:103], v5 offset:27368
v_exp_f32 v74, v74
v_mfma_f32_16x16x32_bf16 v[172:175], a[76:79], v[80:83], v[172:175]
ds_read_b64_tr_b16 a[104:105], v6 offset:23232
s_waitcnt lgkmcnt(7)
v_exp_f32 v75, v75
v_mfma_f32_16x16x32_bf16 v[176:179], a[80:83], v[80:83], v[176:179]
ds_read_b64_tr_b16 a[106:107], v6 offset:27360
v_exp_f32 v76, v76
v_mfma_f32_16x16x32_bf16 v[180:183], a[84:87], v[80:83], v[180:183]
ds_read_b64_tr_b16 a[108:109], v6 offset:23240
ds_read_b64_tr_b16 a[110:111], v6 offset:27368
v_exp_f32 v77, v77
v_mfma_f32_16x16x32_bf16 v[184:187], a[88:91], v[80:83], v[184:187]
ds_read_b64_tr_b16 a[112:113], v7 offset:23232
ds_read_b64_tr_b16 a[114:115], v7 offset:27360
s_waitcnt lgkmcnt(8)
v_exp_f32 v78, v78
v_exp_f32 v79, v79
v_mfma_f32_16x16x32_bf16 v[188:191], a[92:95], v[80:83], v[188:191]
ds_read_b64_tr_b16 a[116:117], v7 offset:23240
ds_read_b64_tr_b16 a[118:119], v7 offset:27368
v_cvt_pk_bf16_f32 v84, v72, v73
v_cvt_pk_bf16_f32 v85, v74, v75
v_cvt_pk_bf16_f32 v86, v76, v77
v_cvt_pk_bf16_f32 v87, v78, v79
v_mfma_f32_16x16x32_bf16 a[216:219], a[228:231], v[80:83], a[216:219]
ds_read_b64_tr_b16 a[120:121], v8 offset:23232
ds_read_b64_tr_b16 a[122:123], v8 offset:27360
ds_read_b64_tr_b16 a[124:125], v8 offset:23240
v_mfma_f32_16x16x32_bf16 a[216:219], a[228:231], v[84:87], a[216:219]
ds_read_b64_tr_b16 a[126:127], v8 offset:27368
v_mfma_f32_16x16x32_bf16 v[160:163], a[96:99], v[84:87], v[160:163]
s_waitcnt lgkmcnt(10)
v_mfma_f32_16x16x32_bf16 v[164:167], a[100:103], v[84:87], v[164:167]
v_mfma_f32_16x16x32_bf16 v[168:171], a[104:107], v[84:87], v[168:171]
s_waitcnt lgkmcnt(6)
v_mfma_f32_16x16x32_bf16 v[172:175], a[108:111], v[84:87], v[172:175]
s_nop 2
v_accvgpr_read_b32 v91, a216
v_subrev_u32 v88, s36, v91
v_cmp_lt_u32 s[84:85], s33, v88
v_mfma_f32_16x16x32_bf16 v[176:179], a[112:115], v[84:87], v[176:179]
s_waitcnt lgkmcnt(1)
v_rcp_f32 v91, v91
v_mfma_f32_16x16x32_bf16 v[180:183], a[116:119], v[84:87], v[180:183]
v_mul_f32 v160, v91, v160
v_mul_f32 v161, v91, v161
v_mul_f32 v162, v91, v162
v_mfma_f32_16x16x32_bf16 v[184:187], a[120:123], v[84:87], v[184:187]
s_waitcnt lgkmcnt(0)
v_mul_f32 v163, v91, v163
v_mul_f32 v164, v91, v164
v_mul_f32 v165, v91, v165
v_mfma_f32_16x16x32_bf16 v[188:191], a[124:127], v[84:87], v[188:191]
v_mul_f32 v166, v91, v166
v_mul_f32 v167, v91, v167
v_cvt_pk_bf16_f32 v160, v160, v161
v_cvt_pk_bf16_f32 v161, v162, v163
v_cvt_pk_bf16_f32 v162, v164, v165
v_cvt_pk_bf16_f32 v163, v166, v167
buffer_store_dwordx4 v[160:163], v12, s[16:19], s67 offen offset:0 sc0 sc1
v_mul_f32 v168, v91, v168
v_mul_f32 v169, v91, v169
v_mul_f32 v170, v91, v170
v_mul_f32 v171, v91, v171
v_mul_f32 v172, v91, v172
v_mul_f32 v173, v91, v173
v_mul_f32 v174, v91, v174
v_mul_f32 v175, v91, v175
v_cvt_pk_bf16_f32 v168, v168, v169
v_cvt_pk_bf16_f32 v169, v170, v171
v_cvt_pk_bf16_f32 v170, v172, v173
v_cvt_pk_bf16_f32 v171, v174, v175
buffer_store_dwordx4 v[168:171], v12, s[16:19], s67 offen offset:64 sc0 sc1
v_mul_f32 v176, v91, v176
v_mul_f32 v177, v91, v177
v_mul_f32 v178, v91, v178
v_mul_f32 v179, v91, v179
v_mul_f32 v180, v91, v180
v_mul_f32 v181, v91, v181
v_mul_f32 v182, v91, v182
v_mul_f32 v183, v91, v183
v_cvt_pk_bf16_f32 v176, v176, v177
v_cvt_pk_bf16_f32 v177, v178, v179
v_cvt_pk_bf16_f32 v178, v180, v181
v_cvt_pk_bf16_f32 v179, v182, v183
buffer_store_dwordx4 v[176:179], v12, s[16:19], s67 offen offset:128 sc0 sc1
v_mul_f32 v184, v91, v184
v_mul_f32 v185, v91, v185
v_mul_f32 v186, v91, v186
v_mul_f32 v187, v91, v187
v_mul_f32 v188, v91, v188
v_mul_f32 v189, v91, v189
v_mul_f32 v190, v91, v190
v_mul_f32 v191, v91, v191
v_cvt_pk_bf16_f32 v184, v184, v185
v_cvt_pk_bf16_f32 v185, v186, v187
v_cvt_pk_bf16_f32 v186, v188, v189
v_cvt_pk_bf16_f32 v187, v190, v191
buffer_store_dwordx4 v[184:187], v12, s[16:19], s67 offen offset:192 sc0 sc1
s_or_b64 s[38:39], s[38:39], s[70:71]
s_or_b64 s[38:39], s[38:39], s[72:73]
s_or_b64 s[38:39], s[38:39], s[74:75]
s_or_b64 s[38:39], s[38:39], s[76:77]
s_or_b64 s[38:39], s[38:39], s[78:79]
s_or_b64 s[38:39], s[38:39], s[80:81]
s_or_b64 s[38:39], s[38:39], s[82:83]
s_or_b64 s[38:39], s[38:39], s[84:85]
s_cmp_eq_u64 s[38:39], 0
s_cbranch_scc1 L_end
L_slow:
s_waitcnt vmcnt(0) lgkmcnt(0)
s_barrier
s_mul_i32 s46, s28, 40960
s_lshl_b32 s47, s28, 11
s_sub_u32 s48, s46, 98304
v_subrev_u32 v11, s47, v11
v_add_u32 v9, 0x1000, v12
v_add_u32 v5, s48, v5
v_add_u32 v6, s48, v6
v_add_u32 v7, s48, v7
v_add_u32 v8, s48, v8
s_mov_b32 s44, 0
L_sj:
s_lshl_b32 s32, s44, 14
s_add_u32 s32, s32, s31
buffer_load_dwordx4 a[128:131], v12, s[12:15], s32 offen offset:0
buffer_load_dwordx4 a[132:135], v12, s[12:15], s32 offen offset:64
buffer_load_dwordx4 a[136:139], v12, s[12:15], s32 offen offset:128
buffer_load_dwordx4 a[140:143], v12, s[12:15], s32 offen offset:192
v_mov_b32 v88, 0xff800000
s_mov_b64 s[24:25], s[20:21]
s_mov_b32 s45, 0
L_s1:
global_load_dwordx4 a[0:3], v12, s[24:25] offset:0
global_load_dwordx4 a[4:7], v12, s[24:25] offset:64
global_load_dwordx4 a[8:11], v12, s[24:25] offset:128
global_load_dwordx4 a[12:15], v12, s[24:25] offset:192
global_load_dwordx4 a[16:19], v9, s[24:25] offset:0
global_load_dwordx4 a[20:23], v9, s[24:25] offset:64
global_load_dwordx4 a[24:27], v9, s[24:25] offset:128
global_load_dwordx4 a[28:31], v9, s[24:25] offset:192
s_waitcnt vmcnt(0)
v_mfma_f32_16x16x32_bf16 v[64:67], a[0:3], a[128:131], 0
v_mfma_f32_16x16x32_bf16 v[64:67], a[4:7], a[132:135], v[64:67]
v_mfma_f32_16x16x32_bf16 v[64:67], a[8:11], a[136:139], v[64:67]
v_mfma_f32_16x16x32_bf16 v[64:67], a[12:15], a[140:143], v[64:67]
v_mfma_f32_16x16x32_bf16 v[68:71], a[16:19], a[128:131], 0
v_mfma_f32_16x16x32_bf16 v[68:71], a[20:23], a[132:135], v[68:71]
v_mfma_f32_16x16x32_bf16 v[68:71], a[24:27], a[136:139], v[68:71]
v_mfma_f32_16x16x32_bf16 v[68:71], a[28:31], a[140:143], v[68:71]
s_nop 7
s_nop 1
v_max3_f32 v88, v88, v64, v65
v_max3_f32 v88, v88, v66, v67
v_max3_f32 v88, v88, v68, v69
v_max3_f32 v88, v88, v70, v71
s_add_u32 s24, s24, 8192
s_addc_u32 s25, s25, 0
s_add_u32 s45, s45, 1
s_cmp_lt_u32 s45, 16
s_cbranch_scc1 L_s1
v_mov_b32 v89, v88
s_nop 1
v_permlane32_swap_b32 v88, v89
s_nop 1
v_max_f32 v88, v89, v88
v_mov_b32 v89, v88
s_nop 1
v_permlane16_swap_b32 v88, v89
s_nop 1
v_max_f32 v88, v89, v88
v_mul_f32 v88, s37, v88
v_mov_b32 v96, 0
v_mov_b32 v97, 0
v_mov_b32 v98, 0
v_mov_b32 v99, 0
v_mov_b32 v100, 0
v_mov_b32 v101, 0
v_mov_b32 v102, 0
v_mov_b32 v103, 0
v_mov_b32 v104, 0
v_mov_b32 v105, 0
v_mov_b32 v106, 0
v_mov_b32 v107, 0
v_mov_b32 v108, 0
v_mov_b32 v109, 0
v_mov_b32 v110, 0
v_mov_b32 v111, 0
v_mov_b32 v112, 0
v_mov_b32 v113, 0
v_mov_b32 v114, 0
v_mov_b32 v115, 0
v_mov_b32 v116, 0
v_mov_b32 v117, 0
v_mov_b32 v118, 0
v_mov_b32 v119, 0
v_mov_b32 v120, 0
v_mov_b32 v121, 0
v_mov_b32 v122, 0
v_mov_b32 v123, 0
v_mov_b32 v124, 0
v_mov_b32 v125, 0
v_mov_b32 v126, 0
v_mov_b32 v127, 0
v_accvgpr_write_b32 a208, 0
v_accvgpr_write_b32 a209, 0
v_accvgpr_write_b32 a210, 0
v_accvgpr_write_b32 a211, 0
s_mov_b64 s[24:25], s[20:21]
s_mov_b64 s[26:27], s[22:23]
s_mov_b32 s45, 0
L_s2:
global_load_dwordx4 a[0:3], v12, s[24:25] offset:0
global_load_dwordx4 a[4:7], v12, s[24:25] offset:64
global_load_dwordx4 a[8:11], v12, s[24:25] offset:128
global_load_dwordx4 a[12:15], v12, s[24:25] offset:192
global_load_dwordx4 a[16:19], v9, s[24:25] offset:0
global_load_dwordx4 a[20:23], v9, s[24:25] offset:64
global_load_dwordx4 a[24:27], v9, s[24:25] offset:128
global_load_dwordx4 a[28:31], v9, s[24:25] offset:192
s_add_u32 m0, s46, 0
s_nop 0
global_load_lds_dwordx4 v11, s[26:27] offset:0
s_add_u32 m0, s46, 8
s_nop 0
global_load_lds_dwordx4 v11, s[26:27] offset:1024
s_add_u32 m0, s46, 16
s_nop 0
global_load_lds_dwordx4 v11, s[26:27] offset:2048
s_add_u32 m0, s46, 24
s_nop 0
global_load_lds_dwordx4 v11, s[26:27] offset:3072
s_add_u32 s26, s26, 4096
s_addc_u32 s27, s27, 0
s_add_u32 m0, s46, 4128
s_nop 0
global_load_lds_dwordx4 v11, s[26:27] offset:0
s_add_u32 m0, s46, 4136
s_nop 0
global_load_lds_dwordx4 v11, s[26:27] offset:1024
s_add_u32 m0, s46, 4144
s_nop 0
global_load_lds_dwordx4 v11, s[26:27] offset:2048
s_add_u32 m0, s46, 4152
s_nop 0
global_load_lds_dwordx4 v11, s[26:27] offset:3072
s_add_u32 s26, s26, 4096
s_addc_u32 s27, s27, 0
s_waitcnt vmcnt(0)
ds_read_b64_tr_b16 a[64:65], v5 offset:0
ds_read_b64_tr_b16 a[66:67], v5 offset:4128
ds_read_b64_tr_b16 a[68:69], v5 offset:8
ds_read_b64_tr_b16 a[70:71], v5 offset:4136
ds_read_b64_tr_b16 a[72:73], v6 offset:0
ds_read_b64_tr_b16 a[74:75], v6 offset:4128
ds_read_b64_tr_b16 a[76:77], v6 offset:8
ds_read_b64_tr_b16 a[78:79], v6 offset:4136
ds_read_b64_tr_b16 a[80:81], v7 offset:0
ds_read_b64_tr_b16 a[82:83], v7 offset:4128
ds_read_b64_tr_b16 a[84:85], v7 offset:8
ds_read_b64_tr_b16 a[86:87], v7 offset:4136
ds_read_b64_tr_b16 a[88:89], v8 offset:0
ds_read_b64_tr_b16 a[90:91], v8 offset:4128
ds_read_b64_tr_b16 a[92:93], v8 offset:8
ds_read_b64_tr_b16 a[94:95], v8 offset:4136
v_mfma_f32_16x16x32_bf16 v[64:67], a[0:3], a[128:131], 0
v_mfma_f32_16x16x32_bf16 v[64:67], a[4:7], a[132:135], v[64:67]
v_mfma_f32_16x16x32_bf16 v[64:67], a[8:11], a[136:139], v[64:67]
v_mfma_f32_16x16x32_bf16 v[64:67], a[12:15], a[140:143], v[64:67]
v_mfma_f32_16x16x32_bf16 v[68:71], a[16:19], a[128:131], 0
v_mfma_f32_16x16x32_bf16 v[68:71], a[20:23], a[132:135], v[68:71]
v_mfma_f32_16x16x32_bf16 v[68:71], a[24:27], a[136:139], v[68:71]
v_mfma_f32_16x16x32_bf16 v[68:71], a[28:31], a[140:143], v[68:71]
s_nop 7
s_nop 1
v_fma_f32 v64, v64, s34, v88
v_fma_f32 v65, v65, s34, v88
v_fma_f32 v66, v66, s34, v88
v_fma_f32 v67, v67, s34, v88
v_fma_f32 v68, v68, s34, v88
v_fma_f32 v69, v69, s34, v88
v_fma_f32 v70, v70, s34, v88
v_fma_f32 v71, v71, s34, v88
v_exp_f32 v64, v64
v_exp_f32 v65, v65
v_exp_f32 v66, v66
v_exp_f32 v67, v67
v_exp_f32 v68, v68
v_exp_f32 v69, v69
v_exp_f32 v70, v70
v_exp_f32 v71, v71
s_nop 0
v_cvt_pk_bf16_f32 v80, v64, v65
v_cvt_pk_bf16_f32 v81, v66, v67
v_cvt_pk_bf16_f32 v82, v68, v69
v_cvt_pk_bf16_f32 v83, v70, v71
s_waitcnt lgkmcnt(0)
s_nop 1
v_mfma_f32_16x16x32_bf16 v[96:99], a[64:67], v[80:83], v[96:99]
v_mfma_f32_16x16x32_bf16 v[100:103], a[68:71], v[80:83], v[100:103]
v_mfma_f32_16x16x32_bf16 v[104:107], a[72:75], v[80:83], v[104:107]
v_mfma_f32_16x16x32_bf16 v[108:111], a[76:79], v[80:83], v[108:111]
v_mfma_f32_16x16x32_bf16 v[112:115], a[80:83], v[80:83], v[112:115]
v_mfma_f32_16x16x32_bf16 v[116:119], a[84:87], v[80:83], v[116:119]
v_mfma_f32_16x16x32_bf16 v[120:123], a[88:91], v[80:83], v[120:123]
v_mfma_f32_16x16x32_bf16 v[124:127], a[92:95], v[80:83], v[124:127]
v_mfma_f32_16x16x32_bf16 a[208:211], a[228:231], v[80:83], a[208:211]
s_nop 7
s_nop 1
s_add_u32 s24, s24, 8192
s_addc_u32 s25, s25, 0
s_add_u32 s45, s45, 1
s_cmp_lt_u32 s45, 16
s_cbranch_scc1 L_s2
v_accvgpr_read_b32 v91, a208
v_rcp_f32 v91, v91
s_nop 0
v_mul_f32 v96, v91, v96
v_mul_f32 v97, v91, v97
v_mul_f32 v98, v91, v98
v_mul_f32 v99, v91, v99
v_mul_f32 v100, v91, v100
v_mul_f32 v101, v91, v101
v_mul_f32 v102, v91, v102
v_mul_f32 v103, v91, v103
v_mul_f32 v104, v91, v104
v_mul_f32 v105, v91, v105
v_mul_f32 v106, v91, v106
v_mul_f32 v107, v91, v107
v_mul_f32 v108, v91, v108
v_mul_f32 v109, v91, v109
v_mul_f32 v110, v91, v110
v_mul_f32 v111, v91, v111
v_mul_f32 v112, v91, v112
v_mul_f32 v113, v91, v113
v_mul_f32 v114, v91, v114
v_mul_f32 v115, v91, v115
v_mul_f32 v116, v91, v116
v_mul_f32 v117, v91, v117
v_mul_f32 v118, v91, v118
v_mul_f32 v119, v91, v119
v_mul_f32 v120, v91, v120
v_mul_f32 v121, v91, v121
v_mul_f32 v122, v91, v122
v_mul_f32 v123, v91, v123
v_mul_f32 v124, v91, v124
v_mul_f32 v125, v91, v125
v_mul_f32 v126, v91, v126
v_mul_f32 v127, v91, v127
v_cvt_pk_bf16_f32 v16, v96, v97
v_cvt_pk_bf16_f32 v17, v98, v99
v_cvt_pk_bf16_f32 v18, v100, v101
v_cvt_pk_bf16_f32 v19, v102, v103
v_cvt_pk_bf16_f32 v20, v104, v105
v_cvt_pk_bf16_f32 v21, v106, v107
v_cvt_pk_bf16_f32 v22, v108, v109
v_cvt_pk_bf16_f32 v23, v110, v111
v_cvt_pk_bf16_f32 v24, v112, v113
v_cvt_pk_bf16_f32 v25, v114, v115
v_cvt_pk_bf16_f32 v26, v116, v117
v_cvt_pk_bf16_f32 v27, v118, v119
v_cvt_pk_bf16_f32 v28, v120, v121
v_cvt_pk_bf16_f32 v29, v122, v123
v_cvt_pk_bf16_f32 v30, v124, v125
v_cvt_pk_bf16_f32 v31, v126, v127
buffer_store_dwordx4 v[16:19], v12, s[16:19], s32 offen offset:0
buffer_store_dwordx4 v[20:23], v12, s[16:19], s32 offen offset:64
buffer_store_dwordx4 v[24:27], v12, s[16:19], s32 offen offset:128
buffer_store_dwordx4 v[28:31], v12, s[16:19], s32 offen offset:192
s_waitcnt vmcnt(0)
s_add_u32 s44, s44, 1
s_cmp_lt_u32 s44, 8
s_cbranch_scc1 L_sj
s_branch L_end
L_r1:
ds_read_b32 v93, v90
s_waitcnt lgkmcnt(0)
v_cmp_gt_u32 vcc, v92, v93
s_cbranch_vccnz L_r1
s_branch L_b1
L_r2:
ds_read_b32 v93, v90
s_waitcnt lgkmcnt(0)
v_cmp_gt_u32 vcc, v92, v93
s_cbranch_vccnz L_r2
s_branch L_b2
L_r3:
ds_read_b32 v93, v90
s_waitcnt lgkmcnt(0)
v_cmp_gt_u32 vcc, v92, v93
s_cbranch_vccnz L_r3
s_branch L_b3
L_r4:
ds_read_b32 v93, v90
s_waitcnt lgkmcnt(0)
v_cmp_gt_u32 vcc, v92, v93
s_cbranch_vccnz L_r4
s_branch L_b4
L_r5:
ds_read_b32 v93, v90
s_waitcnt lgkmcnt(0)
v_cmp_gt_u32 vcc, v92, v93
s_cbranch_vccnz L_r5
s_branch L_b5
L_r6:
ds_read_b32 v93, v90
s_waitcnt lgkmcnt(0)
v_cmp_gt_u32 vcc, v92, v93
s_cbranch_vccnz L_r6
s_branch L_b6
L_r7:
ds_read_b32 v93, v90
s_waitcnt lgkmcnt(0)
v_cmp_gt_u32 vcc, v92, v93
s_cbranch_vccnz L_r7
s_branch L_b7
L_r8:
ds_read_b32 v93, v90
s_waitcnt lgkmcnt(0)
v_cmp_gt_u32 vcc, v92, v93
s_cbranch_vccnz L_r8
s_branch L_b8
L_r9:
ds_read_b32 v93, v90
s_waitcnt lgkmcnt(0)
v_cmp_gt_u32 vcc, v92, v93
s_cbranch_vccnz L_r9
s_branch L_b9
L_r10:
ds_read_b32 v93, v90
s_waitcnt lgkmcnt(0)
v_cmp_gt_u32 vcc, v92, v93
s_cbranch_vccnz L_r10
s_branch L_b10
L_r11:
ds_read_b32 v93, v90
s_waitcnt lgkmcnt(0)
v_cmp_gt_u32 vcc, v92, v93
s_cbranch_vccnz L_r11
s_branch L_b11
L_r12:
ds_read_b32 v93, v90
s_waitcnt lgkmcnt(0)
v_cmp_gt_u32 vcc, v92, v93
s_cbranch_vccnz L_r12
s_branch L_b12
L_r13:
ds_read_b32 v93, v90
s_waitcnt lgkmcnt(0)
v_cmp_gt_u32 vcc, v92, v93
s_cbranch_vccnz L_r13
s_branch L_b13
L_r14:
ds_read_b32 v93, v90
s_waitcnt lgkmcnt(0)
v_cmp_gt_u32 vcc, v92, v93
s_cbranch_vccnz L_r14
s_branch L_b14
L_r15:
ds_read_b32 v93, v90
s_waitcnt lgkmcnt(0)
v_cmp_gt_u32 vcc, v92, v93
s_cbranch_vccnz L_r15
s_branch L_b15
L_r16:
ds_read_b32 v93, v90
s_waitcnt lgkmcnt(0)
v_cmp_gt_u32 vcc, v92, v93
s_cbranch_vccnz L_r16
s_branch L_b16
L_r18:
ds_read_b32 v93, v90
s_waitcnt lgkmcnt(0)
v_cmp_gt_u32 vcc, v92, v93
s_cbranch_vccnz L_r18
s_branch L_b18
L_r21:
ds_read_b32 v93, v90
s_waitcnt lgkmcnt(0)
v_cmp_gt_u32 vcc, v92, v93
s_cbranch_vccnz L_r21
s_branch L_b21
L_r24:
ds_read_b32 v93, v90
s_waitcnt lgkmcnt(0)
v_cmp_gt_u32 vcc, v92, v93
s_cbranch_vccnz L_r24
s_branch L_b24
L_r26:
ds_read_b32 v93, v90
s_waitcnt lgkmcnt(0)
v_cmp_gt_u32 vcc, v92, v93
s_cbranch_vccnz L_r26
s_branch L_b26
L_r28:
ds_read_b32 v93, v90
s_waitcnt lgkmcnt(0)
v_cmp_gt_u32 vcc, v92, v93
s_cbranch_vccnz L_r28
s_branch L_b28
L_r31:
ds_read_b32 v93, v90
s_waitcnt lgkmcnt(0)
v_cmp_gt_u32 vcc, v92, v93
s_cbranch_vccnz L_r31
s_branch L_b31
L_r34:
ds_read_b32 v93, v90
s_waitcnt lgkmcnt(0)
v_cmp_gt_u32 vcc, v92, v93
s_cbranch_vccnz L_r34
s_branch L_b34
L_end:
s_endpgm
.section .rodata,"a"
.p2align 6
.amdhsa_kernel standalone__gqa_softmax__near_ridge_kernel
  .amdhsa_next_free_vgpr 512
  .amdhsa_next_free_sgpr 102
  .amdhsa_accum_offset 256
  .amdhsa_group_segment_fixed_size 0
  .amdhsa_kernarg_size 48
  .amdhsa_user_sgpr_count 2
  .amdhsa_user_sgpr_kernarg_segment_ptr 1
  .amdhsa_system_sgpr_workgroup_id_x 1
.end_amdhsa_kernel
```
